```python
import torch

def _softmax(x, axis=-1):
    return torch.softmax(x, dim=axis)
def _gelu(x):
    return torch.nn.functional.gelu(x, approximate="tanh")
def _silu(x):
    return torch.nn.functional.silu(x)
def _sigmoid(x):
    return torch.sigmoid(x)
def _layernorm(x, axis=-1, eps=1e-5):
    m = x.mean(dim=axis, keepdim=True)
    v = x.var(dim=axis, keepdim=True, unbiased=False)
    return (x - m) / torch.sqrt(v + eps)
def _scatter_add(tgt, idx, src, axis=0):
    return tgt.clone().index_add_(axis, idx, src)
def _segment_sum(src, seg, n):
    out = torch.zeros((n,) + src.shape[1:], dtype=src.dtype)
    return out.index_add_(0, seg, src)
def _pad(x, pw):
    flat = tuple(v for pair in reversed(pw) for v in pair)
    return torch.nn.functional.pad(x, flat)

kernel_name = 'interleave_layers__softmax_full_mha__glu_gated_swiglu__prompt'

def setup_inputs():

    _w = (lambda a: (lambda t: t.to(torch.bfloat16) if t.is_floating_point() else t)(torch.as_tensor(a)))
    def _A_setup():
        B, S, D = 1, 2048, 512
        return {
            "x": _w((lambda *s: torch.randn(*s, dtype=torch.bfloat16) * 0.05)(B, S, D)),
            "wqkv": _w((lambda *s: torch.randn(*s, dtype=torch.bfloat16) * 0.05)(D, 3 * D)),
            "wo": _w((lambda *s: torch.randn(*s, dtype=torch.bfloat16) * 0.05)(D, D)),
        }
    _A_in = _A_setup()

    def _B_setup():
        B, S, D, F = 1, 2048, 512, 1792
        return {
            "x": _w((lambda *s: torch.randn(*s, dtype=torch.bfloat16) * 0.05)(B, S, D)),
            "w1": _w((lambda *s: torch.randn(*s, dtype=torch.bfloat16) * 0.4)(D, F) * (2.0 / D) ** 0.5),
            "w3": _w((lambda *s: torch.randn(*s, dtype=torch.bfloat16) * 0.4)(D, F) * (2.0 / D) ** 0.5),
            "w2": _w((lambda *s: torch.randn(*s, dtype=torch.bfloat16) * 0.4)(F, D) * (2.0 / F) ** 0.5),
        }
    _B_in = _B_setup()

    return {
        "A_x": _A_in["x"],
        "A_wqkv": _A_in["wqkv"],
        "A_wo": _A_in["wo"],
        "B_x": _B_in["x"],
        "B_w1": _B_in["w1"],
        "B_w3": _B_in["w3"],
        "B_w2": _B_in["w2"],
    }

def reference(A_x, A_wqkv, A_wo, B_x, B_w1, B_w3, B_w2):
    def _A_ref(x, wqkv, wo):
        B, S, D = x.shape
        H = 32; Dh = D // H
        qkv = (lambda x, *d: x.permute(*d))((x @ wqkv).reshape(B, S, 3, H, Dh), 2, 0, 3, 1, 4)
        q, k, v = qkv[0], qkv[1], qkv[2]
        scale = Dh ** -0.5
        scores = torch.einsum("bhqd,bhkd->bhqk", q, k) * scale
        p = _softmax(scores, axis=-1)
        o = torch.einsum("bhqk,bhkd->bhqd", p, v)
        return (lambda x, *d: x.permute(*d))(o, 0, 2, 1, 3).reshape(B, S, D) @ wo

    def _B_ref(x, w1, w3, w2):
        gate = torch.einsum("bsd,df->bsf", x, w1)
        up = torch.einsum("bsd,df->bsf", x, w3)
        h = _silu(gate) * up
        out = torch.einsum("bsf,fd->bsd", h, w2)
        return out

    x = A_x
    x = x + _A_ref(_layernorm(x, axis=-1), A_wqkv, A_wo)
    x = x + _B_ref(_layernorm(x, axis=-1), B_w1, B_w3, B_w2)
    x = x + _A_ref(_layernorm(x, axis=-1), A_wqkv, A_wo)
    x = x + _B_ref(_layernorm(x, axis=-1), B_w1, B_w3, B_w2)
    return x
```

```asm
; @launch grid=(256,1,1) block=(256,1,1) lds=163840
.amdgcn_target "amdgcn-amd-amdhsa--gfx950"
.text
.globl interleave_layers__softmax_full_mha__glu_gated_swiglu__prompt_kernel
.p2align 8
.type interleave_layers__softmax_full_mha__glu_gated_swiglu__prompt_kernel,@function
interleave_layers__softmax_full_mha__glu_gated_swiglu__prompt_kernel:
    s_cmp_ge_u32 s2, 256
    s_cbranch_scc1 interleave_layers__softmax_full_mha__glu_gated_swiglu__prompt_kernel_end
    s_load_dwordx16 s[64:79], s[0:1], 0
    s_load_dwordx4 s[80:83], s[0:1], 64
    s_getpc_b64 s[12:13]
L_pc0:
    v_lshrrev_b32 v2, 6, v0
    v_and_b32 v0, 63, v0
    v_readfirstlane_b32 s20, v2
    v_lshlrev_b32 v1, 4, v0
    s_and_b32 s21, s2, 7
    s_lshr_b32 s22, s2, 3
    s_mov_b32 s14, L_code_end-L_pc0
    s_mov_b32 s15, 0x20000
    s_lshl_b32 s39, s22, 2
    s_add_u32 s39, s39, s20
    s_lshl_b32 s23, s39, 9
    v_lshlrev_b32 v2, 3, v0
    buffer_load_dwordx2 v[8:9], v2, s[12:15], s23 offen
    s_lshr_b32 s26, s21, 1
    s_lshl_b32 s26, s26, 3
    s_lshr_b32 s23, s22, 2
    s_add_u32 s26, s26, s23
    s_and_b32 s25, s21, 1
    s_lshl_b32 s27, s25, 2
    s_and_b32 s23, s22, 3
    s_add_u32 s27, s27, s23
    s_add_u32 s3, s20, s23
    s_and_b32 s3, s3, 3
    s_lshl_b32 s36, s26, 2
    s_add_u32 s36, s36, s3
    s_lshl_b32 s36, s36, 14
    s_add_u32 s37, s36, 8192
    v_lshrrev_b32 v11, 3, v0
    v_and_b32 v12, 0x70, v1
    v_lshl_add_u32 v10, v11, 10, v12
    s_mul_i32 s39, s39, 12288
    s_lshl_b32 s25, s25, 9
    s_add_u32 s39, s39, s25
    v_lshrrev_b32 v13, 4, v0
    v_mul_u32_u24 v13, 3072, v13
    v_bfe_u32 v2, v0, 2, 2
    v_min_u32 v2, 2, v2
    v_lshl_add_u32 v13, v2, 10, v13
    v_and_b32 v2, 3, v0
    v_lshl_add_u32 v13, v2, 7, v13
    s_mov_b32 s18, 1572864
    s_mov_b32 s19, 0x20000
    s_waitcnt lgkmcnt(0)
    s_mov_b32 s12, s64
    s_mov_b32 s13, s65
    s_mov_b32 s14, 2097152
    s_mov_b32 s16, s66
    s_mov_b32 s17, s67
    buffer_load_dwordx4 v[80:83], v10, s[12:15], s36 offen offset:0
    v_lshrrev_b32 v14, 5, v0
    v_lshlrev_b32 v14, 2, v14
    v_bfe_u32 v2, v0, 2, 2
    v_add_u32 v14, v14, v2
    v_mul_u32_u24 v14, 3072, v14
    buffer_load_dwordx4 v[84:87], v10, s[12:15], s36 offen offset:128
    v_bfe_u32 v2, v0, 4, 1
    v_lshl_add_u32 v14, v2, 6, v14
    v_and_b32 v2, 3, v0
    v_lshl_add_u32 v14, v2, 4, v14
    s_mul_i32 s42, s20, 24576
    buffer_load_dwordx4 v[88:91], v10, s[12:15], s36 offen offset:256
    s_lshl_b32 s23, s27, 7
    s_add_u32 s42, s42, s23
    s_mul_i32 s43, s20, 3072
    s_add_u32 s43, s43, 69632
    s_lshr_b32 s23, s20, 1
    buffer_load_dwordx4 v[92:95], v10, s[12:15], s36 offen offset:384
    s_lshl_b32 s23, s23, 8
    s_add_u32 s23, s23, 69632
    v_lshrrev_b32 v15, 5, v0
    v_mul_u32_u24 v15, 3072, v15
    v_bfe_u32 v2, v0, 2, 2
    buffer_load_dwordx4 v[96:99], v10, s[12:15], s36 offen offset:512
    v_lshl_add_u32 v15, v2, 6, v15
    v_bfe_u32 v2, v0, 4, 1
    v_lshl_add_u32 v15, v2, 5, v15
    v_and_b32 v2, 1, v0
    v_lshl_add_u32 v15, v2, 4, v15
    buffer_load_dwordx4 v[100:103], v10, s[12:15], s36 offen offset:640
    v_bfe_u32 v2, v0, 1, 1
    v_lshl_add_u32 v15, v2, 3, v15
    v_add_u32 v15, s23, v15
    v_add_u32 v16, 49152, v15
    s_lshr_b32 s23, s3, 1
    buffer_load_dwordx4 v[104:107], v10, s[12:15], s36 offen offset:768
    s_mul_i32 s23, s23, 33792
    s_and_b32 s25, s3, 1
    s_lshl_b32 s28, s25, 8
    s_and_b32 s25, s20, 1
    s_add_u32 s23, s23, s28
    buffer_load_dwordx4 v[108:111], v10, s[12:15], s36 offen offset:896
    v_and_b32 v17, 7, v0
    v_mul_u32_u24 v17, 528, v17
    v_lshl_add_u32 v17, v11, 4, v17
    v_add_u32 v17, s23, v17
    s_lshl_b32 s23, s3, 6
    buffer_load_dwordx4 v[112:115], v10, s[12:15], s37 offen offset:0
    s_add_u32 s23, s23, 67584
    v_lshl_add_u32 v18, v11, 2, s23
    s_mul_i32 s23, s25, 33792
    v_lshrrev_b32 v19, 5, v0
    v_mul_u32_u24 v19, 528, v19
    buffer_load_dwordx4 v[116:119], v10, s[12:15], s37 offen offset:128
    v_and_b32 v2, 31, v0
    v_lshl_add_u32 v19, v2, 4, v19
    v_add_u32 v19, s23, v19
    s_lshl_b32 s23, s25, 7
    s_add_u32 s23, s23, 67584
    buffer_load_dwordx4 v[120:123], v10, s[12:15], s37 offen offset:256
    v_lshl_add_u32 v21, v2, 2, s23
    v_lshrrev_b32 v22, 5, v0
    v_lshl_add_u32 v22, v22, 4, s23
    s_lshl_b32 s44, s26, 1
    s_add_u32 s44, s44, s25
    buffer_load_dwordx4 v[124:127], v10, s[12:15], s37 offen offset:384
    s_lshl_b32 s45, s27, 1
    s_lshr_b32 s23, s20, 1
    s_add_u32 s45, s45, s23
    s_mov_b32 s46, 0x3f803f80
    s_mov_b32 s47, 0x00003f80
    buffer_load_dwordx4 v[128:131], v10, s[12:15], s37 offen offset:512
    s_mov_b32 s38, 0x3f800000
    s_mov_b32 s4, s82
    s_mov_b32 s5, s83
    s_mov_b32 s6, 268435456
    s_mov_b32 s7, 0x20000
    buffer_load_dwordx4 v[132:135], v10, s[12:15], s37 offen offset:640
    s_mov_b32 s8, s78
    s_mov_b32 s9, s79
    s_mov_b32 s10, 2097152
    s_mov_b32 s11, 0x20000
    s_mov_b32 s48, 0
    buffer_load_dwordx4 v[136:139], v10, s[12:15], s37 offen offset:768
    s_mov_b32 s1, 16
    s_lshr_b32 s57, s22, 3
    s_lshl_b32 s23, s21, 2
    s_add_u32 s57, s57, s23
    s_lshl_b32 s57, s57, 2
    buffer_load_dwordx4 v[140:143], v10, s[12:15], s37 offen offset:896
    s_add_u32 s57, s57, s20
    buffer_load_dword v8, v13, s[16:19], s39 offen
    s_lshr_b32 s23, s20, 1
    s_lshl_b32 s24, s23, 8
    s_add_u32 s24, s24, s2
    s_lshl_b32 s35, s23, 14
    s_and_b32 s32, s20, 1
    s_cmp_ge_u32 s24, 96
    s_movk_i32 s34, 3072
    s_cselect_b32 s34, 3584, s34
    s_cselect_b32 s28, 96, 0
    s_cmp_ge_u32 s24, 208
    s_cselect_b32 s28, 208, s28
    s_cmp_ge_u32 s24, 320
    s_cselect_b32 s34, 1024, s34
    s_cselect_b32 s28, 320, s28
    s_cmp_ge_u32 s24, 352
    s_cselect_b32 s28, 352, s28
    s_sub_u32 s28, s24, s28
    s_lshr_b32 s25, s28, 2
    s_and_b32 s33, s28, 3
    s_and_b32 s29, s28, 7
    s_lshr_b32 s28, s28, 3
    s_cmp_ge_u32 s24, 320
    s_cselect_b32 s25, s29, s25
    s_cselect_b32 s33, s28, s33
    s_cmp_ge_u32 s24, 464
    s_cselect_b32 s86, 0, 1835008
    s_mov_b32 s87, 0x20000
    v_mul_lo_u32 v241, v11, s34
    v_add_u32 v241, v241, v12
    s_lshl_b32 s28, s33, 1
    s_add_u32 s28, s28, s32
    s_lshl_b32 s89, s34, 6
    s_mul_i32 s89, s89, s28
    s_lshl_b32 s28, s25, 7
    s_add_u32 s89, s89, s28
    s_lshl_b32 s97, s34, 3
    s_lshl_b32 s98, s20, 13
    s_cmp_ge_u32 s24, 96
    s_cselect_b64 s[84:85], s[72:73], s[66:67]
    s_cmp_ge_u32 s24, 208
    s_cselect_b64 s[84:85], s[74:75], s[84:85]
    s_cmp_ge_u32 s24, 320
    s_cselect_b64 s[84:85], s[68:69], s[84:85]
    s_cmp_ge_u32 s24, 352
    s_cselect_b64 s[84:85], s[76:77], s[84:85]
    s_lshl_b32 s23, s20, 8
    s_add_u32 s23, s23, s2
    s_and_b32 s28, s2, 15
    s_lshl_b32 s29, s28, 12
    s_add_u32 s29, s29, 60817408
    s_lshl_b32 s28, s28, 2
    s_cmp_ge_u32 s23, 1008
    s_cselect_b32 s40, s28, 1073741824
    s_cbranch_scc0 L_noz
    v_mov_b32 v28, 0
    v_mov_b32 v29, 0
    v_mov_b32 v30, 0
    v_mov_b32 v31, 0
    buffer_store_dwordx4 v[28:31], v1, s[4:7], s29 offen offset:0 sc1
    buffer_store_dwordx4 v[28:31], v1, s[4:7], s29 offen offset:1024 sc1
    buffer_store_dwordx4 v[28:31], v1, s[4:7], s29 offen offset:2048 sc1
    buffer_store_dwordx4 v[28:31], v1, s[4:7], s29 offen offset:3072 sc1
L_noz:
    v_mov_b32 v32, 0
    v_mov_b32 v33, 0
    s_waitcnt vmcnt(16)
    v_dot2c_f32_bf16 v32, s46, v80
    v_dot2c_f32_bf16 v33, v80, v80
    v_dot2c_f32_bf16 v32, s46, v81
    v_dot2c_f32_bf16 v33, v81, v81
    v_dot2c_f32_bf16 v32, s46, v82
    v_dot2c_f32_bf16 v33, v82, v82
    v_dot2c_f32_bf16 v32, s46, v83
    v_dot2c_f32_bf16 v33, v83, v83
    s_waitcnt vmcnt(15)
    v_dot2c_f32_bf16 v32, s46, v84
    v_dot2c_f32_bf16 v33, v84, v84
    v_dot2c_f32_bf16 v32, s46, v85
    v_dot2c_f32_bf16 v33, v85, v85
    v_dot2c_f32_bf16 v32, s46, v86
    v_dot2c_f32_bf16 v33, v86, v86
    v_dot2c_f32_bf16 v32, s46, v87
    v_dot2c_f32_bf16 v33, v87, v87
    s_waitcnt vmcnt(14)
    v_dot2c_f32_bf16 v32, s46, v88
    v_dot2c_f32_bf16 v33, v88, v88
    v_dot2c_f32_bf16 v32, s46, v89
    v_dot2c_f32_bf16 v33, v89, v89
    v_dot2c_f32_bf16 v32, s46, v90
    v_dot2c_f32_bf16 v33, v90, v90
    v_dot2c_f32_bf16 v32, s46, v91
    v_dot2c_f32_bf16 v33, v91, v91
    s_waitcnt vmcnt(13)
    v_dot2c_f32_bf16 v32, s46, v92
    v_dot2c_f32_bf16 v33, v92, v92
    v_dot2c_f32_bf16 v32, s46, v93
    v_dot2c_f32_bf16 v33, v93, v93
    v_dot2c_f32_bf16 v32, s46, v94
    v_dot2c_f32_bf16 v33, v94, v94
    v_dot2c_f32_bf16 v32, s46, v95
    v_dot2c_f32_bf16 v33, v95, v95
    s_waitcnt vmcnt(12)
    v_dot2c_f32_bf16 v32, s46, v96
    v_dot2c_f32_bf16 v33, v96, v96
    v_dot2c_f32_bf16 v32, s46, v97
    v_dot2c_f32_bf16 v33, v97, v97
    v_dot2c_f32_bf16 v32, s46, v98
    v_dot2c_f32_bf16 v33, v98, v98
    v_dot2c_f32_bf16 v32, s46, v99
    v_dot2c_f32_bf16 v33, v99, v99
    s_waitcnt vmcnt(11)
    v_dot2c_f32_bf16 v32, s46, v100
    v_dot2c_f32_bf16 v33, v100, v100
    v_dot2c_f32_bf16 v32, s46, v101
    v_dot2c_f32_bf16 v33, v101, v101
    v_dot2c_f32_bf16 v32, s46, v102
    v_dot2c_f32_bf16 v33, v102, v102
    v_dot2c_f32_bf16 v32, s46, v103
    v_dot2c_f32_bf16 v33, v103, v103
    s_waitcnt vmcnt(10)
    v_dot2c_f32_bf16 v32, s46, v104
    v_dot2c_f32_bf16 v33, v104, v104
    v_dot2c_f32_bf16 v32, s46, v105
    v_dot2c_f32_bf16 v33, v105, v105
    v_dot2c_f32_bf16 v32, s46, v106
    v_dot2c_f32_bf16 v33, v106, v106
    v_dot2c_f32_bf16 v32, s46, v107
    v_dot2c_f32_bf16 v33, v107, v107
    s_waitcnt vmcnt(9)
    v_dot2c_f32_bf16 v32, s46, v108
    v_dot2c_f32_bf16 v33, v108, v108
    v_dot2c_f32_bf16 v32, s46, v109
    v_dot2c_f32_bf16 v33, v109, v109
    v_dot2c_f32_bf16 v32, s46, v110
    v_dot2c_f32_bf16 v33, v110, v110
    v_dot2c_f32_bf16 v32, s46, v111
    v_dot2c_f32_bf16 v33, v111, v111
    s_nop 2
    v_add_f32_dpp v32, v32, v32 quad_perm:[1,0,3,2] row_mask:0xf bank_mask:0xf
    v_add_f32_dpp v33, v33, v33 quad_perm:[1,0,3,2] row_mask:0xf bank_mask:0xf
    s_nop 0
    v_add_f32_dpp v32, v32, v32 quad_perm:[2,3,0,1] row_mask:0xf bank_mask:0xf
    v_add_f32_dpp v33, v33, v33 quad_perm:[2,3,0,1] row_mask:0xf bank_mask:0xf
    s_nop 0
    v_add_f32_dpp v32, v32, v32 row_half_mirror row_mask:0xf bank_mask:0xf
    v_add_f32_dpp v33, v33, v33 row_half_mirror row_mask:0xf bank_mask:0xf
    s_nop 0
    v_mul_f32 v32, 0xbb000000, v32
    v_mul_f32 v33, 0x3b000000, v33
    v_fma_f32 v33, -v32, v32, v33
    v_max_f32 v33, 0, v33
    v_add_f32 v33, 0x3727c5ac, v33
    v_rsq_f32 v33, v33
    v_dot2_f32_bf16 v34, v80, s47, v32
    v_dot2_f32_bf16 v35, v80, s38, v32
    v_dot2_f32_bf16 v36, v81, s47, v32
    v_dot2_f32_bf16 v37, v81, s38, v32
    v_dot2_f32_bf16 v38, v82, s47, v32
    v_dot2_f32_bf16 v39, v82, s38, v32
    v_dot2_f32_bf16 v40, v83, s47, v32
    v_dot2_f32_bf16 v41, v83, s38, v32
    v_cvt_pk_bf16_f32 v80, v34, v35
    v_cvt_pk_bf16_f32 v81, v36, v37
    v_cvt_pk_bf16_f32 v82, v38, v39
    v_cvt_pk_bf16_f32 v83, v40, v41
    ds_write_b128 v17, v[80:83] offset:0
    v_dot2_f32_bf16 v34, v84, s47, v32
    v_dot2_f32_bf16 v35, v84, s38, v32
    v_dot2_f32_bf16 v36, v85, s47, v32
    v_dot2_f32_bf16 v37, v85, s38, v32
    v_dot2_f32_bf16 v38, v86, s47, v32
    v_dot2_f32_bf16 v39, v86, s38, v32
    v_dot2_f32_bf16 v40, v87, s47, v32
    v_dot2_f32_bf16 v41, v87, s38, v32
    v_cvt_pk_bf16_f32 v84, v34, v35
    v_cvt_pk_bf16_f32 v85, v36, v37
    v_cvt_pk_bf16_f32 v86, v38, v39
    v_cvt_pk_bf16_f32 v87, v40, v41
    ds_write_b128 v17, v[84:87] offset:4224
    v_dot2_f32_bf16 v34, v88, s47, v32
    v_dot2_f32_bf16 v35, v88, s38, v32
    v_dot2_f32_bf16 v36, v89, s47, v32
    v_dot2_f32_bf16 v37, v89, s38, v32
    v_dot2_f32_bf16 v38, v90, s47, v32
    v_dot2_f32_bf16 v39, v90, s38, v32
    v_dot2_f32_bf16 v40, v91, s47, v32
    v_dot2_f32_bf16 v41, v91, s38, v32
    v_cvt_pk_bf16_f32 v88, v34, v35
    v_cvt_pk_bf16_f32 v89, v36, v37
    v_cvt_pk_bf16_f32 v90, v38, v39
    v_cvt_pk_bf16_f32 v91, v40, v41
    ds_write_b128 v17, v[88:91] offset:8448
    v_dot2_f32_bf16 v34, v92, s47, v32
    v_dot2_f32_bf16 v35, v92, s38, v32
    v_dot2_f32_bf16 v36, v93, s47, v32
    v_dot2_f32_bf16 v37, v93, s38, v32
    v_dot2_f32_bf16 v38, v94, s47, v32
    v_dot2_f32_bf16 v39, v94, s38, v32
    v_dot2_f32_bf16 v40, v95, s47, v32
    v_dot2_f32_bf16 v41, v95, s38, v32
    v_cvt_pk_bf16_f32 v92, v34, v35
    v_cvt_pk_bf16_f32 v93, v36, v37
    v_cvt_pk_bf16_f32 v94, v38, v39
    v_cvt_pk_bf16_f32 v95, v40, v41
    ds_write_b128 v17, v[92:95] offset:12672
    v_dot2_f32_bf16 v34, v96, s47, v32
    v_dot2_f32_bf16 v35, v96, s38, v32
    v_dot2_f32_bf16 v36, v97, s47, v32
    v_dot2_f32_bf16 v37, v97, s38, v32
    v_dot2_f32_bf16 v38, v98, s47, v32
    v_dot2_f32_bf16 v39, v98, s38, v32
    v_dot2_f32_bf16 v40, v99, s47, v32
    v_dot2_f32_bf16 v41, v99, s38, v32
    v_cvt_pk_bf16_f32 v96, v34, v35
    v_cvt_pk_bf16_f32 v97, v36, v37
    v_cvt_pk_bf16_f32 v98, v38, v39
    v_cvt_pk_bf16_f32 v99, v40, v41
    ds_write_b128 v17, v[96:99] offset:16896
    v_dot2_f32_bf16 v34, v100, s47, v32
    v_dot2_f32_bf16 v35, v100, s38, v32
    v_dot2_f32_bf16 v36, v101, s47, v32
    v_dot2_f32_bf16 v37, v101, s38, v32
    v_dot2_f32_bf16 v38, v102, s47, v32
    v_dot2_f32_bf16 v39, v102, s38, v32
    v_dot2_f32_bf16 v40, v103, s47, v32
    v_dot2_f32_bf16 v41, v103, s38, v32
    v_cvt_pk_bf16_f32 v100, v34, v35
    v_cvt_pk_bf16_f32 v101, v36, v37
    v_cvt_pk_bf16_f32 v102, v38, v39
    v_cvt_pk_bf16_f32 v103, v40, v41
    ds_write_b128 v17, v[100:103] offset:21120
    v_dot2_f32_bf16 v34, v104, s47, v32
    v_dot2_f32_bf16 v35, v104, s38, v32
    v_dot2_f32_bf16 v36, v105, s47, v32
    v_dot2_f32_bf16 v37, v105, s38, v32
    v_dot2_f32_bf16 v38, v106, s47, v32
    v_dot2_f32_bf16 v39, v106, s38, v32
    v_dot2_f32_bf16 v40, v107, s47, v32
    v_dot2_f32_bf16 v41, v107, s38, v32
    v_cvt_pk_bf16_f32 v104, v34, v35
    v_cvt_pk_bf16_f32 v105, v36, v37
    v_cvt_pk_bf16_f32 v106, v38, v39
    v_cvt_pk_bf16_f32 v107, v40, v41
    ds_write_b128 v17, v[104:107] offset:25344
    v_dot2_f32_bf16 v34, v108, s47, v32
    v_dot2_f32_bf16 v35, v108, s38, v32
    v_dot2_f32_bf16 v36, v109, s47, v32
    v_dot2_f32_bf16 v37, v109, s38, v32
    v_dot2_f32_bf16 v38, v110, s47, v32
    v_dot2_f32_bf16 v39, v110, s38, v32
    v_dot2_f32_bf16 v40, v111, s47, v32
    v_dot2_f32_bf16 v41, v111, s38, v32
    v_cvt_pk_bf16_f32 v108, v34, v35
    v_cvt_pk_bf16_f32 v109, v36, v37
    v_cvt_pk_bf16_f32 v110, v38, v39
    v_cvt_pk_bf16_f32 v111, v40, v41
    ds_write_b128 v17, v[108:111] offset:29568
    ds_write_b32 v18, v33 offset:0
    v_mov_b32 v32, 0
    v_mov_b32 v33, 0
    s_waitcnt vmcnt(8)
    v_dot2c_f32_bf16 v32, s46, v112
    v_dot2c_f32_bf16 v33, v112, v112
    s_add_u32 m0, s43, 0
    s_add_u32 s41, s42, 0
    v_dot2c_f32_bf16 v32, s46, v113
    v_dot2c_f32_bf16 v33, v113, v113
    v_dot2c_f32_bf16 v32, s46, v114
    v_dot2c_f32_bf16 v33, v114, v114
    v_dot2c_f32_bf16 v32, s46, v115
    buffer_load_dwordx4 v14, s[16:19], s41 offen offset:0 lds
    v_dot2c_f32_bf16 v33, v115, v115
    s_waitcnt vmcnt(8)
    v_dot2c_f32_bf16 v32, s46, v116
    v_dot2c_f32_bf16 v33, v116, v116
    v_dot2c_f32_bf16 v32, s46, v117
    v_dot2c_f32_bf16 v33, v117, v117
    buffer_load_dwordx4 v14, s[16:19], s41 offen offset:1024 lds
    v_dot2c_f32_bf16 v32, s46, v118
    v_dot2c_f32_bf16 v33, v118, v118
    v_dot2c_f32_bf16 v32, s46, v119
    v_dot2c_f32_bf16 v33, v119, v119
    s_waitcnt vmcnt(8)
    v_dot2c_f32_bf16 v32, s46, v120
    buffer_load_dwordx4 v14, s[16:19], s41 offen offset:2048 lds
    v_dot2c_f32_bf16 v33, v120, v120
    v_dot2c_f32_bf16 v32, s46, v121
    v_dot2c_f32_bf16 v33, v121, v121
    v_dot2c_f32_bf16 v32, s46, v122
    v_dot2c_f32_bf16 v33, v122, v122
    s_add_u32 m0, s43, 12288
    s_add_u32 s41, s42, 98304
    v_dot2c_f32_bf16 v32, s46, v123
    v_dot2c_f32_bf16 v33, v123, v123
    s_waitcnt vmcnt(8)
    v_dot2c_f32_bf16 v32, s46, v124
    v_dot2c_f32_bf16 v33, v124, v124
    v_dot2c_f32_bf16 v32, s46, v125
    buffer_load_dwordx4 v14, s[16:19], s41 offen offset:0 lds
    v_dot2c_f32_bf16 v33, v125, v125
    v_dot2c_f32_bf16 v32, s46, v126
    v_dot2c_f32_bf16 v33, v126, v126
    v_dot2c_f32_bf16 v32, s46, v127
    v_dot2c_f32_bf16 v33, v127, v127
    buffer_load_dwordx4 v14, s[16:19], s41 offen offset:1024 lds
    s_waitcnt vmcnt(9)
    v_dot2c_f32_bf16 v32, s46, v128
    v_dot2c_f32_bf16 v33, v128, v128
    v_dot2c_f32_bf16 v32, s46, v129
    v_dot2c_f32_bf16 v33, v129, v129
    v_dot2c_f32_bf16 v32, s46, v130
    buffer_load_dwordx4 v14, s[16:19], s41 offen offset:2048 lds
    v_dot2c_f32_bf16 v33, v130, v130
    v_dot2c_f32_bf16 v32, s46, v131
    v_dot2c_f32_bf16 v33, v131, v131
    s_waitcnt vmcnt(9)
    v_dot2c_f32_bf16 v32, s46, v132
    v_dot2c_f32_bf16 v33, v132, v132
    s_add_u32 m0, s43, 24576
    s_add_u32 s41, s42, 196608
    v_dot2c_f32_bf16 v32, s46, v133
    v_dot2c_f32_bf16 v33, v133, v133
    v_dot2c_f32_bf16 v32, s46, v134
    v_dot2c_f32_bf16 v33, v134, v134
    v_dot2c_f32_bf16 v32, s46, v135
    buffer_load_dwordx4 v14, s[16:19], s41 offen offset:0 lds
    v_dot2c_f32_bf16 v33, v135, v135
    s_waitcnt vmcnt(9)
    v_dot2c_f32_bf16 v32, s46, v136
    v_dot2c_f32_bf16 v33, v136, v136
    v_dot2c_f32_bf16 v32, s46, v137
    v_dot2c_f32_bf16 v33, v137, v137
    buffer_load_dwordx4 v14, s[16:19], s41 offen offset:1024 lds
    v_dot2c_f32_bf16 v32, s46, v138
    v_dot2c_f32_bf16 v33, v138, v138
    v_dot2c_f32_bf16 v32, s46, v139
    v_dot2c_f32_bf16 v33, v139, v139
    s_waitcnt vmcnt(9)
    v_dot2c_f32_bf16 v32, s46, v140
    buffer_load_dwordx4 v14, s[16:19], s41 offen offset:2048 lds
    v_dot2c_f32_bf16 v33, v140, v140
    v_dot2c_f32_bf16 v32, s46, v141
    v_dot2c_f32_bf16 v33, v141, v141
    v_dot2c_f32_bf16 v32, s46, v142
    v_dot2c_f32_bf16 v33, v142, v142
    s_add_u32 m0, s43, 36864
    s_add_u32 s41, s42, 294912
    v_dot2c_f32_bf16 v32, s46, v143
    v_dot2c_f32_bf16 v33, v143, v143
    s_nop 2
    v_add_f32_dpp v32, v32, v32 quad_perm:[1,0,3,2] row_mask:0xf bank_mask:0xf
    v_add_f32_dpp v33, v33, v33 quad_perm:[1,0,3,2] row_mask:0xf bank_mask:0xf
    s_nop 0
    v_add_f32_dpp v32, v32, v32 quad_perm:[2,3,0,1] row_mask:0xf bank_mask:0xf
    v_add_f32_dpp v33, v33, v33 quad_perm:[2,3,0,1] row_mask:0xf bank_mask:0xf
    s_nop 0
    v_add_f32_dpp v32, v32, v32 row_half_mirror row_mask:0xf bank_mask:0xf
    v_add_f32_dpp v33, v33, v33 row_half_mirror row_mask:0xf bank_mask:0xf
    s_nop 0
    v_mul_f32 v32, 0xbb000000, v32
    v_mul_f32 v33, 0x3b000000, v33
    v_fma_f32 v33, -v32, v32, v33
    v_max_f32 v33, 0, v33
    v_add_f32 v33, 0x3727c5ac, v33
    v_rsq_f32 v33, v33
    v_dot2_f32_bf16 v34, v112, s47, v32
    v_dot2_f32_bf16 v35, v112, s38, v32
    v_dot2_f32_bf16 v36, v113, s47, v32
    buffer_load_dwordx4 v14, s[16:19], s41 offen offset:0 lds
    v_dot2_f32_bf16 v37, v113, s38, v32
    v_dot2_f32_bf16 v38, v114, s47, v32
    v_dot2_f32_bf16 v39, v114, s38, v32
    v_dot2_f32_bf16 v40, v115, s47, v32
    v_dot2_f32_bf16 v41, v115, s38, v32
    buffer_load_dwordx4 v14, s[16:19], s41 offen offset:1024 lds
    v_cvt_pk_bf16_f32 v112, v34, v35
    v_cvt_pk_bf16_f32 v113, v36, v37
    v_cvt_pk_bf16_f32 v114, v38, v39
    v_cvt_pk_bf16_f32 v115, v40, v41
    ds_write_b128 v17, v[112:115] offset:128
    v_dot2_f32_bf16 v34, v116, s47, v32
    v_dot2_f32_bf16 v35, v116, s38, v32
    v_dot2_f32_bf16 v36, v117, s47, v32
    v_dot2_f32_bf16 v37, v117, s38, v32
    v_dot2_f32_bf16 v38, v118, s47, v32
    buffer_load_dwordx4 v14, s[16:19], s41 offen offset:2048 lds
    v_dot2_f32_bf16 v39, v118, s38, v32
    v_dot2_f32_bf16 v40, v119, s47, v32
    v_dot2_f32_bf16 v41, v119, s38, v32
    v_cvt_pk_bf16_f32 v116, v34, v35
    v_cvt_pk_bf16_f32 v117, v36, v37
    v_cvt_pk_bf16_f32 v118, v38, v39
    v_cvt_pk_bf16_f32 v119, v40, v41
    ds_write_b128 v17, v[116:119] offset:4352
    v_dot2_f32_bf16 v34, v120, s47, v32
    v_dot2_f32_bf16 v35, v120, s38, v32
    buffer_load_dwordx4 a[224:227], v241, s[84:87], s89 offen
    s_add_u32 s89, s89, s97
    v_dot2_f32_bf16 v36, v121, s47, v32
    v_dot2_f32_bf16 v37, v121, s38, v32
    v_dot2_f32_bf16 v38, v122, s47, v32
    v_dot2_f32_bf16 v39, v122, s38, v32
    v_dot2_f32_bf16 v40, v123, s47, v32
    buffer_load_dwordx4 a[228:231], v241, s[84:87], s89 offen
    s_add_u32 s89, s89, s97
    v_dot2_f32_bf16 v41, v123, s38, v32
    v_cvt_pk_bf16_f32 v120, v34, v35
    v_cvt_pk_bf16_f32 v121, v36, v37
    v_cvt_pk_bf16_f32 v122, v38, v39
    v_cvt_pk_bf16_f32 v123, v40, v41
    ds_write_b128 v17, v[120:123] offset:8576
    v_dot2_f32_bf16 v34, v124, s47, v32
    v_dot2_f32_bf16 v35, v124, s38, v32
    v_dot2_f32_bf16 v36, v125, s47, v32
    v_dot2_f32_bf16 v37, v125, s38, v32
    buffer_load_dwordx4 a[232:235], v241, s[84:87], s89 offen
    s_add_u32 s89, s89, s97
    v_dot2_f32_bf16 v38, v126, s47, v32
    v_dot2_f32_bf16 v39, v126, s38, v32
    v_dot2_f32_bf16 v40, v127, s47, v32
    v_dot2_f32_bf16 v41, v127, s38, v32
    v_cvt_pk_bf16_f32 v124, v34, v35
    v_cvt_pk_bf16_f32 v125, v36, v37
    v_cvt_pk_bf16_f32 v126, v38, v39
    v_cvt_pk_bf16_f32 v127, v40, v41
    ds_write_b128 v17, v[124:127] offset:12800
    v_dot2_f32_bf16 v34, v128, s47, v32
    buffer_load_dwordx4 a[236:239], v241, s[84:87], s89 offen
    s_add_u32 s89, s89, s97
    v_dot2_f32_bf16 v35, v128, s38, v32
    v_dot2_f32_bf16 v36, v129, s47, v32
    v_dot2_f32_bf16 v37, v129, s38, v32
    v_dot2_f32_bf16 v38, v130, s47, v32
    v_dot2_f32_bf16 v39, v130, s38, v32
    buffer_load_dwordx4 a[240:243], v241, s[84:87], s89 offen
    s_add_u32 s89, s89, s97
    v_dot2_f32_bf16 v40, v131, s47, v32
    v_dot2_f32_bf16 v41, v131, s38, v32
    v_cvt_pk_bf16_f32 v128, v34, v35
    v_cvt_pk_bf16_f32 v129, v36, v37
    v_cvt_pk_bf16_f32 v130, v38, v39
    v_cvt_pk_bf16_f32 v131, v40, v41
    ds_write_b128 v17, v[128:131] offset:17024
    v_dot2_f32_bf16 v34, v132, s47, v32
    v_dot2_f32_bf16 v35, v132, s38, v32
    v_dot2_f32_bf16 v36, v133, s47, v32
    buffer_load_dwordx4 a[244:247], v241, s[84:87], s89 offen
    s_add_u32 s89, s89, s97
    v_dot2_f32_bf16 v37, v133, s38, v32
    v_dot2_f32_bf16 v38, v134, s47, v32
    v_dot2_f32_bf16 v39, v134, s38, v32
    v_dot2_f32_bf16 v40, v135, s47, v32
    v_dot2_f32_bf16 v41, v135, s38, v32
    buffer_load_dwordx4 a[248:251], v241, s[84:87], s89 offen
    s_add_u32 s89, s89, s97
    v_cvt_pk_bf16_f32 v132, v34, v35
    v_cvt_pk_bf16_f32 v133, v36, v37
    v_cvt_pk_bf16_f32 v134, v38, v39
    v_cvt_pk_bf16_f32 v135, v40, v41
    ds_write_b128 v17, v[132:135] offset:21248
    v_dot2_f32_bf16 v34, v136, s47, v32
    v_dot2_f32_bf16 v35, v136, s38, v32
    v_dot2_f32_bf16 v36, v137, s47, v32
    v_dot2_f32_bf16 v37, v137, s38, v32
    v_dot2_f32_bf16 v38, v138, s47, v32
    buffer_load_dwordx4 a[252:255], v241, s[84:87], s89 offen
    v_dot2_f32_bf16 v39, v138, s38, v32
    v_dot2_f32_bf16 v40, v139, s47, v32
    v_dot2_f32_bf16 v41, v139, s38, v32
    v_cvt_pk_bf16_f32 v136, v34, v35
    v_cvt_pk_bf16_f32 v137, v36, v37
    v_cvt_pk_bf16_f32 v138, v38, v39
    v_cvt_pk_bf16_f32 v139, v40, v41
    ds_write_b128 v17, v[136:139] offset:25472
    v_dot2_f32_bf16 v34, v140, s47, v32
    v_dot2_f32_bf16 v35, v140, s38, v32
    v_dot2_f32_bf16 v36, v141, s47, v32
    v_dot2_f32_bf16 v37, v141, s38, v32
    v_dot2_f32_bf16 v38, v142, s47, v32
    v_dot2_f32_bf16 v39, v142, s38, v32
    v_dot2_f32_bf16 v40, v143, s47, v32
    v_dot2_f32_bf16 v41, v143, s38, v32
    v_cvt_pk_bf16_f32 v140, v34, v35
    v_cvt_pk_bf16_f32 v141, v36, v37
    v_cvt_pk_bf16_f32 v142, v38, v39
    v_cvt_pk_bf16_f32 v143, v40, v41
    ds_write_b128 v17, v[140:143] offset:29696
    ds_write_b32 v18, v33 offset:32
    s_waitcnt vmcnt(14) lgkmcnt(0)
    s_barrier
    ds_read_b128 a[0:3], v19 offset:0
    ds_read_b128 a[4:7], v19 offset:1056
    ds_read_b64_tr_b16 v[168:169], v15 offset:0
    ds_read_b64_tr_b16 v[170:171], v15 offset:512
    ds_read_b128 a[8:11], v19 offset:2112
    ds_read_b64_tr_b16 v[172:173], v15 offset:1024
    ds_read_b64_tr_b16 v[174:175], v15 offset:1536
    ds_read_b128 a[12:15], v19 offset:3168
    ds_read_b64_tr_b16 v[176:177], v15 offset:2048
    ds_read_b64_tr_b16 v[178:179], v15 offset:2560
    ds_read_b64_tr_b16 v[180:181], v15 offset:6144
    ds_read_b64_tr_b16 v[182:183], v15 offset:6656
    ds_read_b128 a[16:19], v19 offset:4224
    ds_read_b64_tr_b16 v[184:185], v15 offset:7168
    ds_read_b64_tr_b16 v[186:187], v15 offset:7680
    ds_read_b128 a[20:23], v19 offset:5280
    s_waitcnt lgkmcnt(12)
    v_mfma_f32_32x32x16_bf16 v[32:47], v[168:171], a[0:3], 0
    ds_read_b64_tr_b16 v[188:189], v15 offset:8192
    ds_read_b64_tr_b16 v[190:191], v15 offset:8704
    s_waitcnt lgkmcnt(11)
    s_add_u32 m0, s43, 49152
    s_add_u32 s41, s42, 393216
    v_mfma_f32_32x32x16_bf16 v[48:63], v[172:175], a[0:3], 0
    ds_read_b64_tr_b16 v[192:193], v15 offset:12288
    ds_read_b64_tr_b16 v[194:195], v15 offset:12800
    ds_read_b128 a[24:27], v19 offset:6336
    s_waitcnt lgkmcnt(11)
    buffer_load_dwordx4 v14, s[16:19], s41 offen offset:0 lds
    v_mfma_f32_32x32x16_bf16 v[64:79], a[0:3], v[176:179], 0
    ds_read_b64_tr_b16 v[196:197], v15 offset:13312
    ds_read_b64_tr_b16 v[198:199], v15 offset:13824
    ds_read_b128 a[28:31], v19 offset:7392
    s_waitcnt lgkmcnt(12)
    buffer_load_dwordx4 v14, s[16:19], s41 offen offset:1024 lds
    s_lshl_b32 s30, s45, 7
    s_add_u32 s30, s30, s44
    v_mfma_f32_32x32x16_bf16 v[32:47], v[180:183], a[4:7], v[32:47]
    ds_read_b64_tr_b16 v[168:169], v15 offset:14336
    ds_read_b64_tr_b16 v[170:171], v15 offset:14848
    s_waitcnt lgkmcnt(11)
    buffer_load_dwordx4 v14, s[16:19], s41 offen offset:2048 lds
    s_lshl_b32 s31, s30, 11
    s_lshl_b32 s30, s30, 10
    v_mfma_f32_32x32x16_bf16 v[48:63], v[184:187], a[4:7], v[48:63]
    ds_read_b64_tr_b16 v[172:173], v15 offset:18432
    ds_read_b64_tr_b16 v[174:175], v15 offset:18944
    ds_read_b128 a[32:35], v19 offset:8448
    s_waitcnt lgkmcnt(11)
    s_add_u32 m0, s43, 61440
    s_add_u32 s41, s42, 491520
    s_add_u32 s30, s30, s48
    s_add_u32 s31, s31, s48
    v_mfma_f32_32x32x16_bf16 v[64:79], a[4:7], v[188:191], v[64:79]
    ds_read_b64_tr_b16 v[176:177], v15 offset:19456
    ds_read_b64_tr_b16 v[178:179], v15 offset:19968
    ds_read_b128 a[36:39], v19 offset:9504
    s_waitcnt lgkmcnt(12)
    buffer_load_dwordx4 v14, s[16:19], s41 offen offset:0 lds
    s_add_u32 s30, s30, 5242880
    s_add_u32 s31, s31, 7340032
    v_mfma_f32_32x32x16_bf16 v[32:47], v[192:195], a[8:11], v[32:47]
    ds_read_b64_tr_b16 v[180:181], v15 offset:20480
    ds_read_b64_tr_b16 v[182:183], v15 offset:20992
    s_waitcnt lgkmcnt(11)
    buffer_load_dwordx4 v14, s[16:19], s41 offen offset:1024 lds
    s_add_u32 s32, s30, 65536
    s_add_u32 s33, s31, 131072
    v_mfma_f32_32x32x16_bf16 v[48:63], v[196:199], a[8:11], v[48:63]
    s_waitcnt vmcnt(13)
    s_barrier
    ds_read_b64_tr_b16 v[184:185], v15 offset:24576
    ds_read_b64_tr_b16 v[186:187], v15 offset:25088
    ds_read_b128 a[40:43], v19 offset:10560
    s_waitcnt lgkmcnt(11)
    buffer_load_dwordx4 v14, s[16:19], s41 offen offset:2048 lds
    v_and_b32 v24, 0x33, v0
    v_bfe_u32 v26, v0, 2, 1
    v_mfma_f32_32x32x16_bf16 v[64:79], a[8:11], v[168:171], v[64:79]
    ds_read_b64_tr_b16 v[188:189], v15 offset:25600
    ds_read_b64_tr_b16 v[190:191], v15 offset:26112
    ds_read_b128 a[44:47], v19 offset:11616
    s_waitcnt lgkmcnt(12)
    s_add_u32 m0, s43, 73728
    s_add_u32 s41, s42, 589824
    v_lshl_add_u32 v24, v26, 3, v24
    v_bfe_u32 v26, v0, 3, 1
    v_mfma_f32_32x32x16_bf16 v[32:47], v[172:175], a[12:15], v[32:47]
    ds_read_b64_tr_b16 v[192:193], v15 offset:26624
    ds_read_b64_tr_b16 v[194:195], v15 offset:27136
    s_waitcnt lgkmcnt(11)
    buffer_load_dwordx4 v14, s[16:19], s41 offen offset:0 lds
    v_lshl_add_u32 v24, v26, 2, v24
    v_lshlrev_b32 v24, 4, v24
    v_mfma_f32_32x32x16_bf16 v[48:63], v[176:179], a[12:15], v[48:63]
    ds_read_b64_tr_b16 v[196:197], v15 offset:30720
    ds_read_b64_tr_b16 v[198:199], v15 offset:31232
    ds_read_b128 a[48:51], v19 offset:12672
    s_waitcnt lgkmcnt(11)
    buffer_load_dwordx4 v14, s[16:19], s41 offen offset:1024 lds
    v_and_b32 v25, 15, v0
    v_lshlrev_b32 v25, 4, v25
    v_mfma_f32_32x32x16_bf16 v[64:79], a[12:15], v[180:183], v[64:79]
    ds_read_b64_tr_b16 v[168:169], v15 offset:31744
    ds_read_b64_tr_b16 v[170:171], v15 offset:32256
    ds_read_b128 a[52:55], v19 offset:13728
    s_waitcnt lgkmcnt(12)
    buffer_load_dwordx4 v14, s[16:19], s41 offen offset:2048 lds
    v_lshrrev_b32 v26, 5, v0
    v_lshl_add_u32 v25, v26, 8, v25
    v_mfma_f32_32x32x16_bf16 v[32:47], v[184:187], a[16:19], v[32:47]
    ds_read_b64_tr_b16 v[172:173], v15 offset:32768
    ds_read_b64_tr_b16 v[174:175], v15 offset:33280
    s_waitcnt lgkmcnt(11)
    s_mov_b32 s12, s80
    s_mov_b32 s13, s81
    s_mov_b32 s14, 256
    v_mov_b32 v2, 1
    s_mov_b64 exec, 1
    buffer_store_dword v2, off, s[12:15], s40 sc1
    s_mov_b64 exec, -1
    v_bfe_u32 v26, v0, 4, 1
    v_lshl_add_u32 v25, v26, 17, v25
    v_mfma_f32_32x32x16_bf16 v[48:63], v[188:191], a[16:19], v[48:63]
    ds_read_b64_tr_b16 v[176:177], v15 offset:36864
    ds_read_b64_tr_b16 v[178:179], v15 offset:37376
    ds_read_b128 a[56:59], v19 offset:14784
    s_waitcnt lgkmcnt(11)
    s_add_u32 m0, s43, 0
    s_add_u32 s41, s42, 688128
    v_mfma_f32_32x32x16_bf16 v[64:79], a[16:19], v[192:195], v[64:79]
    ds_read_b64_tr_b16 v[180:181], v15 offset:37888
    ds_read_b64_tr_b16 v[182:183], v15 offset:38400
    ds_read_b128 a[60:63], v19 offset:15840
    s_waitcnt lgkmcnt(12)
    buffer_load_dwordx4 v14, s[16:19], s41 offen offset:0 lds
    v_mfma_f32_32x32x16_bf16 v[32:47], v[196:199], a[20:23], v[32:47]
    ds_read_b64_tr_b16 v[184:185], v15 offset:38912
    ds_read_b64_tr_b16 v[186:187], v15 offset:39424
    s_waitcnt lgkmcnt(11)
    buffer_load_dwordx4 v14, s[16:19], s41 offen offset:1024 lds
    v_mfma_f32_32x32x16_bf16 v[48:63], v[168:171], a[20:23], v[48:63]
    ds_read_b64_tr_b16 v[188:189], v15 offset:43008
    ds_read_b64_tr_b16 v[190:191], v15 offset:43520
    ds_read_b128 a[64:67], v19 offset:16896
    s_waitcnt lgkmcnt(11)
    buffer_load_dwordx4 v14, s[16:19], s41 offen offset:2048 lds
    v_mfma_f32_32x32x16_bf16 v[64:79], a[20:23], v[172:175], v[64:79]
    ds_read_b64_tr_b16 v[192:193], v15 offset:44032
    ds_read_b64_tr_b16 v[194:195], v15 offset:44544
    ds_read_b128 a[68:71], v19 offset:17952
    s_waitcnt lgkmcnt(12)
    v_mfma_f32_32x32x16_bf16 v[32:47], v[176:179], a[24:27], v[32:47]
    ds_read_b64_tr_b16 v[196:197], v15 offset:45056
    ds_read_b64_tr_b16 v[198:199], v15 offset:45568
    s_waitcnt lgkmcnt(11)
    v_mfma_f32_32x32x16_bf16 v[48:63], v[180:183], a[24:27], v[48:63]
    s_waitcnt vmcnt(7)
    s_barrier
    ds_read_b64_tr_b16 v[168:169], v16 offset:0
    ds_read_b64_tr_b16 v[170:171], v16 offset:512
    ds_read_b128 a[72:75], v19 offset:19008
    s_waitcnt lgkmcnt(11)
    s_add_u32 m0, s43, 12288
    s_add_u32 s41, s42, 786432
    v_mfma_f32_32x32x16_bf16 v[64:79], a[24:27], v[184:187], v[64:79]
    ds_read_b64_tr_b16 v[172:173], v16 offset:1024
    ds_read_b64_tr_b16 v[174:175], v16 offset:1536
    ds_read_b128 a[76:79], v19 offset:20064
    s_waitcnt lgkmcnt(12)
    buffer_load_dwordx4 v14, s[16:19], s41 offen offset:0 lds
    v_mfma_f32_32x32x16_bf16 v[32:47], v[188:191], a[28:31], v[32:47]
    ds_read_b64_tr_b16 v[176:177], v16 offset:2048
    ds_read_b64_tr_b16 v[178:179], v16 offset:2560
    s_waitcnt lgkmcnt(11)
    buffer_load_dwordx4 v14, s[16:19], s41 offen offset:1024 lds
    v_mfma_f32_32x32x16_bf16 v[48:63], v[192:195], a[28:31], v[48:63]
    ds_read_b64_tr_b16 v[180:181], v16 offset:6144
    ds_read_b64_tr_b16 v[182:183], v16 offset:6656
    ds_read_b128 a[80:83], v19 offset:21120
    s_waitcnt lgkmcnt(11)
    buffer_load_dwordx4 v14, s[16:19], s41 offen offset:2048 lds
    v_mfma_f32_32x32x16_bf16 v[64:79], a[28:31], v[196:199], v[64:79]
    ds_read_b64_tr_b16 v[184:185], v16 offset:7168
    ds_read_b64_tr_b16 v[186:187], v16 offset:7680
    ds_read_b128 a[84:87], v19 offset:22176
    s_waitcnt lgkmcnt(12)
    s_add_u32 m0, s43, 24576
    s_add_u32 s41, s42, 884736
    v_mfma_f32_32x32x16_bf16 v[32:47], v[168:171], a[32:35], v[32:47]
    ds_read_b64_tr_b16 v[188:189], v16 offset:8192
    ds_read_b64_tr_b16 v[190:191], v16 offset:8704
    s_waitcnt lgkmcnt(11)
    buffer_load_dwordx4 v14, s[16:19], s41 offen offset:0 lds
    v_mfma_f32_32x32x16_bf16 v[48:63], v[172:175], a[32:35], v[48:63]
    ds_read_b64_tr_b16 v[192:193], v16 offset:12288
    ds_read_b64_tr_b16 v[194:195], v16 offset:12800
    ds_read_b128 a[88:91], v19 offset:23232
    s_waitcnt lgkmcnt(11)
    buffer_load_dwordx4 v14, s[16:19], s41 offen offset:1024 lds
    v_mfma_f32_32x32x16_bf16 v[64:79], a[32:35], v[176:179], v[64:79]
    ds_read_b64_tr_b16 v[196:197], v16 offset:13312
    ds_read_b64_tr_b16 v[198:199], v16 offset:13824
    ds_read_b128 a[92:95], v19 offset:24288
    s_waitcnt lgkmcnt(12)
    buffer_load_dwordx4 v14, s[16:19], s41 offen offset:2048 lds
    v_mfma_f32_32x32x16_bf16 v[32:47], v[180:183], a[36:39], v[32:47]
    ds_read_b64_tr_b16 v[168:169], v16 offset:14336
    ds_read_b64_tr_b16 v[170:171], v16 offset:14848
    s_waitcnt lgkmcnt(11)
    v_mfma_f32_32x32x16_bf16 v[48:63], v[184:187], a[36:39], v[48:63]
    ds_read_b64_tr_b16 v[172:173], v16 offset:18432
    ds_read_b64_tr_b16 v[174:175], v16 offset:18944
    ds_read_b128 a[96:99], v19 offset:25344
    s_waitcnt lgkmcnt(11)
    v_mfma_f32_32x32x16_bf16 v[64:79], a[36:39], v[188:191], v[64:79]
    ds_read_b64_tr_b16 v[176:177], v16 offset:19456
    ds_read_b64_tr_b16 v[178:179], v16 offset:19968
    ds_read_b128 a[100:103], v19 offset:26400
    s_waitcnt lgkmcnt(12)
    v_mfma_f32_32x32x16_bf16 v[32:47], v[192:195], a[40:43], v[32:47]
    ds_read_b64_tr_b16 v[180:181], v16 offset:20480
    ds_read_b64_tr_b16 v[182:183], v16 offset:20992
    s_waitcnt lgkmcnt(11)
    v_mfma_f32_32x32x16_bf16 v[48:63], v[196:199], a[40:43], v[48:63]
    s_waitcnt vmcnt(6)
    s_barrier
    ds_read_b64_tr_b16 v[184:185], v16 offset:24576
    ds_read_b64_tr_b16 v[186:187], v16 offset:25088
    ds_read_b128 a[104:107], v19 offset:27456
    s_waitcnt lgkmcnt(11)
    s_add_u32 m0, s43, 36864
    s_add_u32 s41, s42, 983040
    v_mfma_f32_32x32x16_bf16 v[64:79], a[40:43], v[168:171], v[64:79]
    ds_read_b64_tr_b16 v[188:189], v16 offset:25600
    ds_read_b64_tr_b16 v[190:191], v16 offset:26112
    ds_read_b128 a[108:111], v19 offset:28512
    s_waitcnt lgkmcnt(12)
    buffer_load_dwordx4 v14, s[16:19], s41 offen offset:0 lds
    v_mfma_f32_32x32x16_bf16 v[32:47], v[172:175], a[44:47], v[32:47]
    ds_read_b64_tr_b16 v[192:193], v16 offset:26624
    ds_read_b64_tr_b16 v[194:195], v16 offset:27136
    s_waitcnt lgkmcnt(11)
    buffer_load_dwordx4 v14, s[16:19], s41 offen offset:1024 lds
    v_mfma_f32_32x32x16_bf16 v[48:63], v[176:179], a[44:47], v[48:63]
    ds_read_b64_tr_b16 v[196:197], v16 offset:30720
    ds_read_b64_tr_b16 v[198:199], v16 offset:31232
    ds_read_b128 a[112:115], v19 offset:29568
    s_waitcnt lgkmcnt(11)
    buffer_load_dwordx4 v14, s[16:19], s41 offen offset:2048 lds
    v_mfma_f32_32x32x16_bf16 v[64:79], a[44:47], v[180:183], v[64:79]
    ds_read_b64_tr_b16 v[168:169], v16 offset:31744
    ds_read_b64_tr_b16 v[170:171], v16 offset:32256
    ds_read_b128 a[116:119], v19 offset:30624
    s_waitcnt lgkmcnt(12)
    s_add_u32 m0, s43, 49152
    s_add_u32 s41, s42, 1081344
    v_mfma_f32_32x32x16_bf16 v[32:47], v[184:187], a[48:51], v[32:47]
    ds_read_b64_tr_b16 v[172:173], v16 offset:32768
    ds_read_b64_tr_b16 v[174:175], v16 offset:33280
    s_waitcnt lgkmcnt(11)
    buffer_load_dwordx4 v14, s[16:19], s41 offen offset:0 lds
    v_mfma_f32_32x32x16_bf16 v[48:63], v[188:191], a[48:51], v[48:63]
    ds_read_b64_tr_b16 v[176:177], v15 offset:0
    ds_read_b64_tr_b16 v[178:179], v15 offset:512
    ds_read_b128 a[120:123], v19 offset:31680
    s_waitcnt lgkmcnt(11)
    buffer_load_dwordx4 v14, s[16:19], s41 offen offset:1024 lds
    v_mfma_f32_32x32x16_bf16 v[64:79], a[48:51], v[192:195], v[64:79]
    ds_read_b64_tr_b16 v[180:181], v15 offset:1024
    ds_read_b64_tr_b16 v[182:183], v15 offset:1536
    ds_read_b128 a[124:127], v19 offset:32736
    s_waitcnt lgkmcnt(12)
    buffer_load_dwordx4 v14, s[16:19], s41 offen offset:2048 lds
    v_mfma_f32_32x32x16_bf16 v[32:47], v[196:199], a[52:55], v[32:47]
    ds_read_b64_tr_b16 v[184:185], v15 offset:2048
    ds_read_b64_tr_b16 v[186:187], v15 offset:2560
    s_waitcnt lgkmcnt(11)
    v_mfma_f32_32x32x16_bf16 v[48:63], v[168:171], a[52:55], v[48:63]
    ds_read_b64_tr_b16 v[188:189], v15 offset:6144
    ds_read_b64_tr_b16 v[190:191], v15 offset:6656
    s_waitcnt lgkmcnt(10)
    ds_read_b32 v20, v21
    v_mfma_f32_32x32x16_bf16 v[64:79], a[52:55], v[172:175], v[64:79]
    ds_read_b64_tr_b16 v[192:193], v15 offset:7168
    ds_read_b64_tr_b16 v[194:195], v15 offset:7680
    s_waitcnt lgkmcnt(11)
    ds_read_b128 v[128:131], v22 offset:0
    v_mfma_f32_32x32x16_bf16 v[32:47], v[176:179], a[56:59], v[32:47]
    ds_read_b64_tr_b16 v[196:197], v15 offset:8192
    ds_read_b64_tr_b16 v[198:199], v15 offset:8704
    s_waitcnt lgkmcnt(11)
    ds_read_b128 v[132:135], v22 offset:32
    v_mfma_f32_32x32x16_bf16 v[48:63], v[180:183], a[56:59], v[48:63]
    s_waitcnt vmcnt(6)
    s_barrier
    ds_read_b64_tr_b16 v[168:169], v15 offset:12288
    ds_read_b64_tr_b16 v[170:171], v15 offset:12800
    s_waitcnt lgkmcnt(11)
    s_add_u32 m0, s43, 61440
    s_add_u32 s41, s42, 1179648
    ds_read_b128 v[136:139], v22 offset:64
    v_mfma_f32_32x32x16_bf16 v[64:79], a[56:59], v[184:187], v[64:79]
    ds_read_b64_tr_b16 v[172:173], v15 offset:13312
    ds_read_b64_tr_b16 v[174:175], v15 offset:13824
    s_waitcnt lgkmcnt(12)
    buffer_load_dwordx4 v14, s[16:19], s41 offen offset:0 lds
    ds_read_b128 v[140:143], v22 offset:96
    v_mfma_f32_32x32x16_bf16 v[32:47], v[188:191], a[60:63], v[32:47]
    ds_read_b64_tr_b16 v[176:177], v15 offset:14336
    ds_read_b64_tr_b16 v[178:179], v15 offset:14848
    s_waitcnt lgkmcnt(12)
    buffer_load_dwordx4 v14, s[16:19], s41 offen offset:1024 lds
    v_mfma_f32_32x32x16_bf16 v[48:63], v[192:195], a[60:63], v[48:63]
    ds_read_b64_tr_b16 v[180:181], v15 offset:18432
    ds_read_b64_tr_b16 v[182:183], v15 offset:18944
    s_waitcnt lgkmcnt(11)
    buffer_load_dwordx4 v14, s[16:19], s41 offen offset:2048 lds
    v_mfma_f32_32x32x16_bf16 v[64:79], a[60:63], v[196:199], v[64:79]
    ds_read_b64_tr_b16 v[184:185], v15 offset:19456
    ds_read_b64_tr_b16 v[186:187], v15 offset:19968
    s_waitcnt lgkmcnt(10)
    s_add_u32 m0, s43, 73728
    s_add_u32 s41, s42, 1277952
    v_mfma_f32_32x32x16_bf16 v[32:47], v[168:171], a[64:67], v[32:47]
    ds_read_b64_tr_b16 v[188:189], v15 offset:20480
    ds_read_b64_tr_b16 v[190:191], v15 offset:20992
    s_waitcnt lgkmcnt(9)
    buffer_load_dwordx4 v14, s[16:19], s41 offen offset:0 lds
    v_mfma_f32_32x32x16_bf16 v[48:63], v[172:175], a[64:67], v[48:63]
    ds_read_b64_tr_b16 v[192:193], v15 offset:24576
    ds_read_b64_tr_b16 v[194:195], v15 offset:25088
    s_waitcnt lgkmcnt(8)
    buffer_load_dwordx4 v14, s[16:19], s41 offen offset:1024 lds
    v_mfma_f32_32x32x16_bf16 v[64:79], a[64:67], v[176:179], v[64:79]
    ds_read_b64_tr_b16 v[196:197], v15 offset:25600
    ds_read_b64_tr_b16 v[198:199], v15 offset:26112
    s_waitcnt lgkmcnt(8)
    buffer_load_dwordx4 v14, s[16:19], s41 offen offset:2048 lds
    v_mul_f32 v23, 0x3eb8aa3b, v20
    v_mfma_f32_32x32x16_bf16 v[32:47], v[180:183], a[68:71], v[32:47]
    ds_read_b64_tr_b16 v[168:169], v15 offset:26624
    ds_read_b64_tr_b16 v[170:171], v15 offset:27136
    s_waitcnt lgkmcnt(8)
    v_mfma_f32_32x32x16_bf16 v[48:63], v[184:187], a[68:71], v[48:63]
    ds_read_b64_tr_b16 v[172:173], v15 offset:30720
    ds_read_b64_tr_b16 v[174:175], v15 offset:31232
    s_waitcnt lgkmcnt(8)
    v_mfma_f32_32x32x16_bf16 v[64:79], a[68:71], v[188:191], v[64:79]
    ds_read_b64_tr_b16 v[176:177], v15 offset:31744
    ds_read_b64_tr_b16 v[178:179], v15 offset:32256
    s_waitcnt lgkmcnt(8)
    v_mfma_f32_32x32x16_bf16 v[32:47], v[192:195], a[72:75], v[32:47]
    ds_read_b64_tr_b16 v[180:181], v15 offset:32768
    ds_read_b64_tr_b16 v[182:183], v15 offset:33280
    s_waitcnt lgkmcnt(8)
    v_mfma_f32_32x32x16_bf16 v[48:63], v[196:199], a[72:75], v[48:63]
    s_waitcnt vmcnt(6)
    s_barrier
    ds_read_b64_tr_b16 v[184:185], v15 offset:36864
    ds_read_b64_tr_b16 v[186:187], v15 offset:37376
    s_waitcnt lgkmcnt(8)
    s_add_u32 m0, s43, 0
    s_add_u32 s41, s42, 1376256
    v_mfma_f32_32x32x16_bf16 v[64:79], a[72:75], v[168:171], v[64:79]
    ds_read_b64_tr_b16 v[188:189], v15 offset:37888
    ds_read_b64_tr_b16 v[190:191], v15 offset:38400
    s_waitcnt lgkmcnt(8)
    buffer_load_dwordx4 v14, s[16:19], s41 offen offset:0 lds
    v_mfma_f32_32x32x16_bf16 v[32:47], v[172:175], a[76:79], v[32:47]
    ds_read_b64_tr_b16 v[192:193], v15 offset:38912
    ds_read_b64_tr_b16 v[194:195], v15 offset:39424
    s_waitcnt lgkmcnt(8)
    buffer_load_dwordx4 v14, s[16:19], s41 offen offset:1024 lds
    v_mfma_f32_32x32x16_bf16 v[48:63], v[176:179], a[76:79], v[48:63]
    ds_read_b64_tr_b16 v[196:197], v15 offset:43008
    ds_read_b64_tr_b16 v[198:199], v15 offset:43520
    s_waitcnt lgkmcnt(8)
    buffer_load_dwordx4 v14, s[16:19], s41 offen offset:2048 lds
    v_mfma_f32_32x32x16_bf16 v[64:79], a[76:79], v[180:183], v[64:79]
    ds_read_b64_tr_b16 v[168:169], v15 offset:44032
    ds_read_b64_tr_b16 v[170:171], v15 offset:44544
    s_waitcnt lgkmcnt(8)
    s_add_u32 m0, s43, 12288
    s_add_u32 s41, s42, 1474560
    v_mfma_f32_32x32x16_bf16 v[32:47], v[184:187], a[80:83], v[32:47]
    ds_read_b64_tr_b16 v[172:173], v15 offset:45056
    ds_read_b64_tr_b16 v[174:175], v15 offset:45568
    s_waitcnt lgkmcnt(8)
    buffer_load_dwordx4 v14, s[16:19], s41 offen offset:0 lds
    v_mfma_f32_32x32x16_bf16 v[48:63], v[188:191], a[80:83], v[48:63]
    ds_read_b64_tr_b16 v[176:177], v16 offset:0
    ds_read_b64_tr_b16 v[178:179], v16 offset:512
    s_waitcnt lgkmcnt(8)
    buffer_load_dwordx4 v14, s[16:19], s41 offen offset:1024 lds
    v_mfma_f32_32x32x16_bf16 v[64:79], a[80:83], v[192:195], v[64:79]
    ds_read_b64_tr_b16 v[180:181], v16 offset:1024
    ds_read_b64_tr_b16 v[182:183], v16 offset:1536
    s_waitcnt lgkmcnt(8)
    buffer_load_dwordx4 v14, s[16:19], s41 offen offset:2048 lds
    v_mfma_f32_32x32x16_bf16 v[32:47], v[196:199], a[84:87], v[32:47]
    ds_read_b64_tr_b16 v[184:185], v16 offset:2048
    ds_read_b64_tr_b16 v[186:187], v16 offset:2560
    s_waitcnt lgkmcnt(8)
    s_lshl_b32 s28, s57, 14
    s_and_b32 s23, s22, 7
    s_lshl_b32 s23, s23, 7
    s_add_u32 s28, s28, s23
    v_and_b32 v2, 15, v0
    v_lshrrev_b32 v3, 4, v0
    v_lshlrev_b32 v7, 10, v2
    v_lshl_add_u32 v7, v3, 4, v7
    s_add_u32 s28, s64, s28
    s_addc_u32 s29, s65, 0
    global_load_dwordx4 v[248:251], v7, s[28:29] offset:0
    global_load_dwordx4 v[252:255], v7, s[28:29] offset:64
    v_mfma_f32_32x32x16_bf16 v[48:63], v[168:171], a[84:87], v[48:63]
    ds_read_b64_tr_b16 v[188:189], v16 offset:6144
    ds_read_b64_tr_b16 v[190:191], v16 offset:6656
    s_waitcnt lgkmcnt(8)
    v_mfma_f32_32x32x16_bf16 v[64:79], a[84:87], v[172:175], v[64:79]
    ds_read_b64_tr_b16 v[192:193], v16 offset:7168
    ds_read_b64_tr_b16 v[194:195], v16 offset:7680
    s_waitcnt lgkmcnt(8)
    v_mfma_f32_32x32x16_bf16 v[32:47], v[176:179], a[88:91], v[32:47]
    ds_read_b64_tr_b16 v[196:197], v16 offset:8192
    ds_read_b64_tr_b16 v[198:199], v16 offset:8704
    s_waitcnt lgkmcnt(8)
    v_mfma_f32_32x32x16_bf16 v[48:63], v[180:183], a[88:91], v[48:63]
    s_waitcnt vmcnt(8)
    s_barrier
    ds_read_b64_tr_b16 v[168:169], v16 offset:12288
    ds_read_b64_tr_b16 v[170:171], v16 offset:12800
    s_waitcnt lgkmcnt(8)
    v_mfma_f32_32x32x16_bf16 v[64:79], a[88:91], v[184:187], v[64:79]
    ds_read_b64_tr_b16 v[172:173], v16 offset:13312
    ds_read_b64_tr_b16 v[174:175], v16 offset:13824
    s_waitcnt lgkmcnt(8)
    v_mfma_f32_32x32x16_bf16 v[32:47], v[188:191], a[92:95], v[32:47]
    ds_read_b64_tr_b16 v[176:177], v16 offset:14336
    ds_read_b64_tr_b16 v[178:179], v16 offset:14848
    s_waitcnt lgkmcnt(8)
    v_mfma_f32_32x32x16_bf16 v[48:63], v[192:195], a[92:95], v[48:63]
    ds_read_b64_tr_b16 v[180:181], v16 offset:18432
    ds_read_b64_tr_b16 v[182:183], v16 offset:18944
    s_waitcnt lgkmcnt(8)
    v_mfma_f32_32x32x16_bf16 v[64:79], a[92:95], v[196:199], v[64:79]
    ds_read_b64_tr_b16 v[184:185], v16 offset:19456
    ds_read_b64_tr_b16 v[186:187], v16 offset:19968
    s_waitcnt lgkmcnt(8)
    v_mfma_f32_32x32x16_bf16 v[32:47], v[168:171], a[96:99], v[32:47]
    ds_read_b64_tr_b16 v[188:189], v16 offset:20480
    ds_read_b64_tr_b16 v[190:191], v16 offset:20992
    s_waitcnt lgkmcnt(8)
    v_mfma_f32_32x32x16_bf16 v[48:63], v[172:175], a[96:99], v[48:63]
    ds_read_b64_tr_b16 v[192:193], v16 offset:24576
    ds_read_b64_tr_b16 v[194:195], v16 offset:25088
    s_waitcnt lgkmcnt(8)
    v_mfma_f32_32x32x16_bf16 v[64:79], a[96:99], v[176:179], v[64:79]
    ds_read_b64_tr_b16 v[196:197], v16 offset:25600
    ds_read_b64_tr_b16 v[198:199], v16 offset:26112
    s_waitcnt lgkmcnt(8)
    v_mfma_f32_32x32x16_bf16 v[32:47], v[180:183], a[100:103], v[32:47]
    ds_read_b64_tr_b16 v[168:169], v16 offset:26624
    ds_read_b64_tr_b16 v[170:171], v16 offset:27136
    s_waitcnt lgkmcnt(8)
    v_mfma_f32_32x32x16_bf16 v[48:63], v[184:187], a[100:103], v[48:63]
    ds_read_b64_tr_b16 v[172:173], v16 offset:30720
    ds_read_b64_tr_b16 v[174:175], v16 offset:31232
    s_waitcnt lgkmcnt(8)
    v_mfma_f32_32x32x16_bf16 v[64:79], a[100:103], v[188:191], v[64:79]
    ds_read_b64_tr_b16 v[176:177], v16 offset:31744
    ds_read_b64_tr_b16 v[178:179], v16 offset:32256
    s_waitcnt lgkmcnt(8)
    v_mfma_f32_32x32x16_bf16 v[32:47], v[192:195], a[104:107], v[32:47]
    ds_read_b64_tr_b16 v[180:181], v16 offset:32768
    ds_read_b64_tr_b16 v[182:183], v16 offset:33280
    s_waitcnt lgkmcnt(8)
    v_mfma_f32_32x32x16_bf16 v[48:63], v[196:199], a[104:107], v[48:63]
    s_waitcnt vmcnt(2)
    s_barrier
    ds_read_b64_tr_b16 v[184:185], v15 offset:0
    ds_read_b64_tr_b16 v[186:187], v15 offset:512
    s_waitcnt lgkmcnt(8)
    v_mfma_f32_32x32x16_bf16 v[64:79], a[104:107], v[168:171], v[64:79]
    ds_read_b64_tr_b16 v[188:189], v15 offset:1024
    ds_read_b64_tr_b16 v[190:191], v15 offset:1536
    s_waitcnt lgkmcnt(8)
    v_mfma_f32_32x32x16_bf16 v[32:47], v[172:175], a[108:111], v[32:47]
    ds_read_b64_tr_b16 v[192:193], v15 offset:2048
    ds_read_b64_tr_b16 v[194:195], v15 offset:2560
    s_waitcnt lgkmcnt(8)
    v_mfma_f32_32x32x16_bf16 v[48:63], v[176:179], a[108:111], v[48:63]
    ds_read_b64_tr_b16 v[196:197], v15 offset:6144
    ds_read_b64_tr_b16 v[198:199], v15 offset:6656
    s_waitcnt lgkmcnt(8)
    v_mfma_f32_32x32x16_bf16 v[64:79], a[108:111], v[180:183], v[64:79]
    ds_read_b64_tr_b16 v[168:169], v15 offset:7168
    ds_read_b64_tr_b16 v[170:171], v15 offset:7680
    s_waitcnt lgkmcnt(8)
    v_mfma_f32_32x32x16_bf16 v[32:47], v[184:187], a[112:115], v[32:47]
    ds_read_b64_tr_b16 v[172:173], v15 offset:8192
    ds_read_b64_tr_b16 v[174:175], v15 offset:8704
    s_waitcnt lgkmcnt(8)
    v_mfma_f32_32x32x16_bf16 v[48:63], v[188:191], a[112:115], v[48:63]
    ds_read_b64_tr_b16 v[176:177], v15 offset:12288
    ds_read_b64_tr_b16 v[178:179], v15 offset:12800
    s_waitcnt lgkmcnt(8)
    v_mfma_f32_32x32x16_bf16 v[64:79], a[112:115], v[192:195], v[64:79]
    ds_read_b64_tr_b16 v[180:181], v15 offset:13312
    ds_read_b64_tr_b16 v[182:183], v15 offset:13824
    s_waitcnt lgkmcnt(8)
    v_mfma_f32_32x32x16_bf16 v[32:47], v[196:199], a[116:119], v[32:47]
    ds_read_b64_tr_b16 v[184:185], v15 offset:14336
    ds_read_b64_tr_b16 v[186:187], v15 offset:14848
    s_waitcnt lgkmcnt(8)
    v_mfma_f32_32x32x16_bf16 v[48:63], v[168:171], a[116:119], v[48:63]
    ds_read_b64_tr_b16 v[188:189], v15 offset:18432
    ds_read_b64_tr_b16 v[190:191], v15 offset:18944
    s_waitcnt lgkmcnt(8)
    v_mfma_f32_32x32x16_bf16 v[64:79], a[116:119], v[172:175], v[64:79]
    ds_read_b64_tr_b16 v[192:193], v15 offset:19456
    ds_read_b64_tr_b16 v[194:195], v15 offset:19968
    s_waitcnt lgkmcnt(8)
    v_mfma_f32_32x32x16_bf16 v[32:47], v[176:179], a[120:123], v[32:47]
    ds_read_b64_tr_b16 v[196:197], v15 offset:20480
    ds_read_b64_tr_b16 v[198:199], v15 offset:20992
    s_waitcnt lgkmcnt(8)
    v_mfma_f32_32x32x16_bf16 v[48:63], v[180:183], a[120:123], v[48:63]
    s_waitcnt lgkmcnt(6)
    v_mfma_f32_32x32x16_bf16 v[64:79], a[120:123], v[184:187], v[64:79]
    s_waitcnt lgkmcnt(4)
    v_mfma_f32_32x32x16_bf16 v[32:47], v[188:191], a[124:127], v[32:47]
    s_waitcnt lgkmcnt(2)
    v_mfma_f32_32x32x16_bf16 v[48:63], v[192:195], a[124:127], v[48:63]
    s_waitcnt lgkmcnt(0)
    v_mfma_f32_32x32x16_bf16 v[64:79], a[124:127], v[196:199], v[64:79]
    s_nop 10
    v_mul_f32 v48, v20, v48
    v_mul_f32 v49, v20, v49
    v_mul_f32 v50, v20, v50
    v_mul_f32 v51, v20, v51
    v_mul_f32 v52, v20, v52
    v_mul_f32 v53, v20, v53
    v_mul_f32 v54, v20, v54
    v_mul_f32 v55, v20, v55
    v_cvt_pk_bf16_f32 v152, v48, v49
    v_cvt_pk_bf16_f32 v153, v50, v51
    v_cvt_pk_bf16_f32 v154, v52, v53
    v_cvt_pk_bf16_f32 v155, v54, v55
    buffer_store_dwordx4 v[152:155], v24, s[4:7], s31 offen sc1
    v_mul_f32 v56, v20, v56
    v_mul_f32 v57, v20, v57
    v_mul_f32 v58, v20, v58
    v_mul_f32 v59, v20, v59
    v_mul_f32 v60, v20, v60
    v_mul_f32 v61, v20, v61
    v_mul_f32 v62, v20, v62
    v_mul_f32 v63, v20, v63
    v_cvt_pk_bf16_f32 v156, v56, v57
    v_cvt_pk_bf16_f32 v157, v58, v59
    v_cvt_pk_bf16_f32 v158, v60, v61
    v_cvt_pk_bf16_f32 v159, v62, v63
    buffer_store_dwordx4 v[156:159], v24, s[4:7], s33 offen sc1
    v_mul_f32 v64, v128, v64
    v_mul_f32 v65, v129, v65
    v_mul_f32 v66, v130, v66
    v_mul_f32 v67, v131, v67
    v_mul_f32 v68, v132, v68
    v_mul_f32 v69, v133, v69
    v_mul_f32 v70, v134, v70
    v_mul_f32 v71, v135, v71
    v_cvt_pk_bf16_f32 v160, v64, v65
    v_cvt_pk_bf16_f32 v161, v66, v67
    v_cvt_pk_bf16_f32 v162, v68, v69
    v_cvt_pk_bf16_f32 v163, v70, v71
    buffer_store_dwordx4 v[160:163], v25, s[4:7], s31 offen offset:1024 sc1
    v_mul_f32 v72, v136, v72
    v_mul_f32 v73, v137, v73
    v_mul_f32 v74, v138, v74
    v_mul_f32 v75, v139, v75
    v_mul_f32 v76, v140, v76
    v_mul_f32 v77, v141, v77
    v_mul_f32 v78, v142, v78
    v_mul_f32 v79, v143, v79
    v_cvt_pk_bf16_f32 v164, v72, v73
    v_cvt_pk_bf16_f32 v165, v74, v75
    v_cvt_pk_bf16_f32 v166, v76, v77
    v_cvt_pk_bf16_f32 v167, v78, v79
    buffer_store_dwordx4 v[164:167], v25, s[4:7], s31 offen offset:1536 sc1
    v_mul_f32 v32, v23, v32
    v_mul_f32 v33, v23, v33
    v_mul_f32 v34, v23, v34
    v_mul_f32 v35, v23, v35
    v_mul_f32 v36, v23, v36
    v_mul_f32 v37, v23, v37
    v_mul_f32 v38, v23, v38
    v_mul_f32 v39, v23, v39
    v_cvt_pk_bf16_f32 v144, v32, v33
    v_cvt_pk_bf16_f32 v145, v34, v35
    v_cvt_pk_bf16_f32 v146, v36, v37
    v_cvt_pk_bf16_f32 v147, v38, v39
    buffer_store_dwordx4 v[144:147], v1, s[4:7], s30 offen sc1
    v_mul_f32 v40, v23, v40
    v_mul_f32 v41, v23, v41
    v_mul_f32 v42, v23, v42
    v_mul_f32 v43, v23, v43
    v_mul_f32 v44, v23, v44
    v_mul_f32 v45, v23, v45
    v_mul_f32 v46, v23, v46
    v_mul_f32 v47, v23, v47
    v_cvt_pk_bf16_f32 v148, v40, v41
    v_cvt_pk_bf16_f32 v149, v42, v43
    v_cvt_pk_bf16_f32 v150, v44, v45
    v_cvt_pk_bf16_f32 v151, v46, v47
    buffer_store_dwordx4 v[148:151], v1, s[4:7], s32 offen sc1
    s_getpc_b64 s[16:17]
L_pc1:
    s_add_u32 s16, s16, L_p3-L_pc1
    s_addc_u32 s17, s17, 0
    s_mov_b32 s18, L_code_end-L_p3
    s_lshl_b32 s99, s22, 2
    s_add_u32 s99, s99, s20
    s_lshl_b32 s99, s99, 8
    v_add_u32 v2, s98, v1
    ds_write_b128 v2, a[224:227] offset:0
    ds_write_b128 v2, a[228:231] offset:1024
    ds_write_b128 v2, a[232:235] offset:2048
    ds_write_b128 v2, a[236:239] offset:3072
    ds_write_b128 v2, a[240:243] offset:4096
    ds_write_b128 v2, a[244:247] offset:5120
    ds_write_b128 v2, a[248:251] offset:6144
    ds_write_b128 v2, a[252:255] offset:7168
    s_and_b32 s100, s21, 7
    s_mul_i32 s100, s100, 4
    s_and_b32 s23, s22, 3
    s_add_u32 s100, s100, s23
    s_and_b32 s101, s21, 0
    s_lshr_b32 s23, s22, 2
    s_add_u32 s101, s101, s23
    s_lshr_b32 s58, s22, 4
    s_lshl_b32 s23, s21, 1
    s_add_u32 s58, s58, s23
    s_lshr_b32 s57, s22, 3
    s_lshl_b32 s23, s21, 2
    s_add_u32 s57, s57, s23
    s_lshl_b32 s57, s57, 2
    s_add_u32 s57, s57, s20
    s_mov_b32 s48, 0
    s_mov_b32 s88, 0
    s_lshl_b32 s55, s21, 5
    s_add_u32 s55, s55, s22
    s_mul_i32 s55, s55, 128
    s_add_u32 s55, s55, 60817408
    s_cmp_eq_u32 s20, 0
    s_cselect_b32 s55, s55, 1073741824
    s_mov_b32 s61, 0
    s_lshl_b32 s49, s20, 12
    s_and_b32 s23, s22, 7
    s_and_b32 s24, s22, 15
    s_mul_i32 s50, s23, 65536
    s_mul_i32 s52, s23, 229376
    s_mul_i32 s51, s24, 237568
    s_mul_i32 s53, s24, 102400
    s_add_u32 s50, s50, s49
    s_add_u32 s50, s50, 56623104
    s_add_u32 s52, s52, s49
    s_add_u32 s52, s52, 57671680
    s_add_u32 s51, s51, s49
    s_add_u32 s51, s51, 52428800
    s_add_u32 s53, s53, s49
    s_add_u32 s53, s53, 50331648
    s_lshl_b32 s56, s58, 2
    s_add_u32 s56, s56, s20
    v_add_u32 v4, 65536, v1
    v_add_u32 v5, 131072, v1
    v_add_u32 v243, s49, v1
    v_add_u32 v244, s49, v4
    v_add_u32 v245, s49, v5
    s_lshr_b32 s35, s100, 4
    s_lshl_b32 s35, s35, 5
    s_bfe_u32 s23, s100, 0x20002
    s_add_u32 s35, s35, s23
    s_mul_i32 s35, s35, 128
    s_add_u32 s35, s35, 60817408
    v_lshrrev_b32 v240, 3, v0
    v_lshlrev_b32 v240, 6, v240
    v_and_b32 v2, 7, v0
    v_lshl_add_u32 v240, v2, 2, v240
    v_mul_u32_u24 v240, 128, v240
    s_cmp_lg_u32 s20, 1
    s_cbranch_scc1 L_rdy
    s_load_dwordx16 s[64:79], s[80:81], 0
    s_waitcnt lgkmcnt(0)
    s_and_b64 s[64:65], s[64:65], s[66:67]
    s_and_b64 s[68:69], s[68:69], s[70:71]
    s_and_b64 s[72:73], s[72:73], s[74:75]
    s_and_b64 s[76:77], s[76:77], s[78:79]
    s_and_b64 s[64:65], s[64:65], s[68:69]
    s_and_b64 s[72:73], s[72:73], s[76:77]
    s_and_b64 s[64:65], s[64:65], s[72:73]
    s_and_b32 s64, s64, s65
    s_cbranch_scc1 L_rdy
    s_mov_b32 s60, 0
    v_and_b32 v3, 15, v0
    v_lshlrev_b32 v3, 2, v3
L_rdy_loop:
    buffer_load_dword v2, v3, s[12:15], 0 offen sc1
    s_add_u32 s60, s60, 1
    s_waitcnt vmcnt(0)
    v_cmp_eq_u32 vcc, 0, v2
    s_cbranch_vccz L_rdy
    s_sleep 4
    s_cmp_lt_u32 s60, 0x8000
    s_cbranch_scc1 L_rdy_loop
L_rdy:
    s_waitcnt lgkmcnt(0)
    s_add_u32 s61, s61, 1
    s_add_u32 s34, s55, 32768
    v_mov_b32 v2, s61
    s_waitcnt vmcnt(0)
    s_barrier
    s_mov_b64 exec, 1
    buffer_store_dword v2, off, s[4:7], s55 sc1
    s_mov_b64 exec, -1
    s_lshr_b32 s23, s20, 1
    s_lshl_b32 s24, s23, 8
    s_add_u32 s24, s24, s2
    s_lshl_b32 s67, s23, 14
    s_and_b32 s32, s20, 1
    s_cmp_ge_u32 s24, 96
    s_movk_i32 s68, 3072
    s_cselect_b32 s68, 3584, s68
    s_cselect_b32 s65, 96, 0
    s_cmp_ge_u32 s24, 208
    s_cselect_b32 s65, 208, s65
    s_cmp_ge_u32 s24, 320
    s_cselect_b32 s68, 1024, s68
    s_cselect_b32 s65, 320, s65
    s_cmp_ge_u32 s24, 352
    s_cselect_b32 s65, 352, s65
    s_sub_u32 s65, s24, s65
    s_lshr_b32 s64, s65, 2
    s_and_b32 s33, s65, 3
    s_and_b32 s66, s65, 7
    s_lshr_b32 s65, s65, 3
    s_cmp_ge_u32 s24, 320
    s_cselect_b32 s64, s66, s64
    s_cselect_b32 s33, s65, s33
    v_mov_b32 v224, 1073741824
    v_mov_b32 v225, 1024
    v_mov_b32 v226, 1073741824
    v_mov_b32 v227, 0
    v_mov_b32 v233, 0
    s_mov_b32 s62, 0
    s_mov_b32 s63, 0
    s_cmp_lt_u32 s24, 96
    s_cbranch_scc1 L_bi_qkv
    s_cmp_lt_u32 s24, 320
    s_cbranch_scc1 L_bi_w13
    s_cmp_lt_u32 s24, 464
    s_cbranch_scc0 L_bi_end
    s_cmp_lt_u32 s24, 352
    s_cselect_b32 s23, 64, 224
    s_mul_i32 s63, s64, s23
    s_cselect_b32 s23, 0, 1024
    s_add_u32 s63, s63, s23
    s_lshl_b32 s63, s63, 10
    s_add_u32 s63, s63, 56623104
    s_lshl_b32 s23, s33, 14
    s_add_u32 s63, s63, s23
    s_lshl_b32 s23, s32, 13
    s_add_u32 s63, s63, s23
    s_mov_b32 s62, 2
    v_add_u32 v224, s63, v1
    v_lshrrev_b32 v227, 4, v0
    v_lshlrev_b32 v227, 10, v227
    v_bfe_u32 v2, v0, 2, 2
    v_lshl_add_u32 v227, v2, 7, v227
    v_and_b32 v2, 3, v0
    v_lshl_add_u32 v227, v2, 4, v227
    v_add_u32 v227, s98, v227
    s_branch L_bi_end
L_bi_qkv:
    s_lshr_b32 s23, s64, 3
    s_lshl_b32 s65, s64, 1
    s_and_b32 s65, s65, 15
    s_add_u32 s65, s65, s32
    s_mul_i32 s65, s65, 102400
    s_sub_u32 s66, s23, 1
    s_cmp_eq_u32 s23, 0
    s_cselect_b32 s30, 2, s66
    s_cselect_b32 s31, 58, s66
    s_cselect_b32 s66, 1, 2
    s_cselect_b32 s23, 0, 4294967272
    s_add_u32 s31, s31, 8
    s_cmp_lt_u32 s33, 1
    s_cselect_b32 s30, s30, s31
    s_cselect_b32 s66, 3, s66
    s_cselect_b32 s63, s23, 0
    s_lshl_b32 s63, s63, 10
    s_lshl_b32 s30, s30, 10
    s_lshl_b32 s66, s66, 10
    s_add_u32 s65, s65, s30
    s_add_u32 s65, s65, 50331648
    v_add_u32 v224, s65, v1
    v_mov_b32 v225, s66
    s_branch L_bi_t32
L_bi_w13:
    s_cmp_lt_u32 s24, 208
    s_cselect_b32 s66, 0, 256
    s_lshl_b32 s23, s64, 1
    s_add_u32 s23, s23, s32
    s_lshl_b32 s23, s23, 1
    s_add_u32 s66, s66, 52428800
    v_bfe_u32 v232, v0, 4, 1
    v_lshrrev_b32 v233, 5, v0
    v_lshlrev_b32 v233, 9, v233
    v_and_b32 v234, 15, v0
    v_lshl_add_u32 v233, v234, 4, v233
    v_add_u32 v233, s66, v233
    v_add_u32 v234, s23, v232
    v_mul_u32_u24 v235, 171, v234
    v_lshrrev_b32 v235, 9, v235
    v_mul_u32_u24 v236, 3, v235
    v_sub_u32 v236, v234, v236
    v_subrev_u32 v237, 48, v234
    v_bfe_u32 v238, v237, 5, 1
    v_lshlrev_b32 v238, 1, v238
    v_and_b32 v232, 1, v237
    v_add3_u32 v238, v238, v232, 3
    v_cmp_gt_u32 vcc, 48, v234
    v_bfe_u32 v237, v237, 1, 4
    s_nop 0
    v_cndmask_b32 v235, v237, v235, vcc
    v_cndmask_b32 v234, v238, v236, vcc
    v_mul_u32_u24 v235, 237568, v235
    v_mul_u32_u24 v236, 33, v234
    v_cmp_gt_u32 vcc, 3, v234
    v_mov_b32 v237, 1024
    v_mov_b32 v238, 3072
    v_cndmask_b32 v236, v236, v234, vcc
    v_cndmask_b32 v225, v237, v238, vcc
    v_lshl_add_u32 v236, v236, 10, v235
    v_add_u32 v224, v236, v233
L_bi_t32:
    s_lshl_b32 s23, s32, 6
    s_add_u32 s23, s23, s67
    v_lshrrev_b32 v227, 5, v0
    v_lshlrev_b32 v227, 10, v227
    v_bfe_u32 v2, v0, 2, 2
    v_lshl_add_u32 v227, v2, 7, v227
    v_bfe_u32 v2, v0, 4, 1
    v_lshl_add_u32 v227, v2, 5, v227
    v_and_b32 v2, 1, v0
    v_lshl_add_u32 v227, v2, 4, v227
    v_bfe_u32 v2, v0, 1, 1
    v_lshl_add_u32 v227, v2, 3, v227
    v_add_u32 v227, s23, v227
    s_mov_b32 s62, 1
    s_lshr_b32 s65, s33, 1
    s_lshl_b32 s65, s65, 9
    s_add_u32 s63, s63, s65
    s_and_b32 s65, s33, 1
    s_lshl_b32 s65, s65, 3
    s_add_u32 s63, s63, s65
    s_mov_b32 exec_hi, 0
    v_lshl_add_u32 v226, v225, 5, v224
    v_add_u32 v226, s63, v226
    s_mov_b64 exec, -1
    s_lshl_b32 s65, s33, 3
    v_mad_u32_u24 v224, v225, s65, v224
L_bi_end:
    s_cmp_eq_u32 s62, 1
    s_cbranch_scc1 L_bp_t32
    ds_read_b64_tr_b16 a[224:225], v227 offset:0
    ds_read_b64_tr_b16 a[226:227], v227 offset:512
    ds_read_b64_tr_b16 a[228:229], v227 offset:8
    ds_read_b64_tr_b16 a[230:231], v227 offset:520
    ds_read_b64_tr_b16 a[232:233], v227 offset:64
    ds_read_b64_tr_b16 a[234:235], v227 offset:576
    ds_read_b64_tr_b16 a[236:237], v227 offset:72
    ds_read_b64_tr_b16 a[238:239], v227 offset:584
    ds_read_b64_tr_b16 a[240:241], v227 offset:4096
    ds_read_b64_tr_b16 a[242:243], v227 offset:4608
    ds_read_b64_tr_b16 a[244:245], v227 offset:4104
    ds_read_b64_tr_b16 a[246:247], v227 offset:4616
    ds_read_b64_tr_b16 a[248:249], v227 offset:4160
    ds_read_b64_tr_b16 a[250:251], v227 offset:4672
    ds_read_b64_tr_b16 a[252:253], v227 offset:4168
    ds_read_b64_tr_b16 a[254:255], v227 offset:4680
    s_waitcnt lgkmcnt(0)
    s_branch L_bp_end
L_bp_t32:
    ds_read_b64_tr_b16 a[224:225], v227 offset:0
    ds_read_b64_tr_b16 a[226:227], v227 offset:512
    ds_read_b64_tr_b16 a[228:229], v227 offset:2048
    ds_read_b64_tr_b16 a[230:231], v227 offset:2560
    ds_read_b64_tr_b16 a[232:233], v227 offset:4096
    ds_read_b64_tr_b16 a[234:235], v227 offset:4608
    ds_read_b64_tr_b16 a[236:237], v227 offset:6144
    ds_read_b64_tr_b16 a[238:239], v227 offset:6656
    ds_read_b64_tr_b16 a[240:241], v227 offset:8192
    ds_read_b64_tr_b16 a[242:243], v227 offset:8704
    ds_read_b64_tr_b16 a[244:245], v227 offset:10240
    ds_read_b64_tr_b16 a[246:247], v227 offset:10752
    ds_read_b64_tr_b16 a[248:249], v227 offset:12288
    ds_read_b64_tr_b16 a[250:251], v227 offset:12800
    ds_read_b64_tr_b16 a[252:253], v227 offset:14336
    ds_read_b64_tr_b16 a[254:255], v227 offset:14848
    v_mov_b32 v208, 0x3f803f80
    v_mov_b32 v209, 0x3f803f80
    v_mov_b32 v210, 0x3f803f80
    v_mov_b32 v211, 0x3f803f80
    s_nop 0
    s_waitcnt lgkmcnt(14)
    v_mfma_f32_32x32x16_bf16 v[192:207], v[208:211], a[224:227], 0
    s_waitcnt lgkmcnt(12)
    v_mfma_f32_32x32x16_bf16 v[192:207], v[208:211], a[228:231], v[192:207]
    s_waitcnt lgkmcnt(10)
    v_mfma_f32_32x32x16_bf16 v[192:207], v[208:211], a[232:235], v[192:207]
    s_waitcnt lgkmcnt(8)
    v_mfma_f32_32x32x16_bf16 v[192:207], v[208:211], a[236:239], v[192:207]
    s_waitcnt lgkmcnt(6)
    v_mfma_f32_32x32x16_bf16 v[192:207], v[208:211], a[240:243], v[192:207]
    s_waitcnt lgkmcnt(4)
    v_mfma_f32_32x32x16_bf16 v[192:207], v[208:211], a[244:247], v[192:207]
    s_waitcnt lgkmcnt(2)
    v_mfma_f32_32x32x16_bf16 v[192:207], v[208:211], a[248:251], v[192:207]
    s_waitcnt lgkmcnt(0)
    v_mfma_f32_32x32x16_bf16 v[192:207], v[208:211], a[252:255], v[192:207]
    s_nop 11
    v_cvt_pk_bf16_f32 v228, v192, v192
    v_and_b32 v212, 0xffff0000, v228
    v_sub_f32 v212, v192, v212
    v_mov_b32 v213, 0
    v_cvt_pk_bf16_f32 v229, v212, v213
L_bp_end:
    s_cmp_lg_u32 s20, 1
    s_cbranch_scc1 L_go1
    s_mov_b32 exec_lo, 0xffffffff
    s_mov_b32 exec_hi, 0
    buffer_load_dword v241, v240, s[4:7], s35 offen sc1
    s_mov_b64 exec, -1
L_go1:
    s_lshl_b32 s25, s100, 6
    s_lshl_b32 s26, s101, 3
    s_add_u32 s25, s25, s26
    s_lshl_b32 s25, s25, 10
    s_add_u32 s25, s25, s48
    s_add_u32 s25, s25, 5242880
    s_lshl_b32 s36, s100, 17
    s_add_u32 s36, s36, s48
    s_add_u32 s36, s36, 7340032
    s_lshl_b32 s26, s20, 15
    s_add_u32 s26, s26, s36
    s_add_u32 s26, s26, 4096
    s_add_u32 s86, s4, s26
    s_addc_u32 s87, s5, 0
    s_lshl_b32 s28, s101, 3
    s_lshl_b32 s29, s20, 1
    s_add_u32 s28, s28, s29
    s_lshl_b32 s28, s28, 15
    s_lshl_b32 s29, s100, 10
    s_add_u32 s28, s28, s29
    s_add_u32 s28, s28, s48
    s_add_u32 s28, s28, 11534336
    s_add_u32 s29, s28, 32768
    s_mov_b32 s40, 0x0000ffff
    s_mov_b32 s41, 0x0000ffff
    v_and_b32 v7, 15, v0
    v_lshlrev_b32 v7, 4, v7
    v_lshrrev_b32 v2, 5, v0
    v_lshl_add_u32 v7, v2, 8, v7
    v_mov_b32 v3, 0xdddddddd
    v_and_b32 v2, 27, v0
    v_cmp_eq_u32 vcc, 16, v2
    v_mov_b32 v2, 0
    v_mov_b32 v6, 0x3f803f80
    v_cndmask_b32 v2, v2, v6, vcc
    s_add_u32 s42, s20, 1
    s_and_b32 s42, s42, 3
    s_mul_i32 s37, s42, 13824
    s_add_u32 s37, s37, 106496
    v_add_u32 v8, s37, v1
    v_lshl_add_u32 v9, v0, 2, s37
    s_lshl_b32 s42, s42, 11
    s_add_u32 s42, s42, s25
    s_add_u32 s43, s20, 2
    s_and_b32 s43, s43, 3
    s_mul_i32 s37, s43, 13824
    s_add_u32 s37, s37, 111104
    v_add_u32 v10, s37, v1
    v_lshl_add_u32 v11, v0, 2, s37
    s_lshl_b32 s43, s43, 11
    s_add_u32 s43, s43, s25
    s_add_u32 s44, s20, 3
    s_and_b32 s44, s44, 3
    s_mul_i32 s37, s44, 13824
    s_add_u32 s37, s37, 115712
    v_add_u32 v12, s37, v1
    v_lshl_add_u32 v13, v0, 2, s37
    s_lshl_b32 s44, s44, 11
    s_add_u32 s44, s44, s25
    s_add_u32 s45, s20, 4
    s_and_b32 s45, s45, 3
    s_mul_i32 s37, s20, 13824
    s_add_u32 s37, s37, 106496
    v_add_u32 v14, s37, v1
    v_lshl_add_u32 v15, v0, 2, s37
    s_lshl_b32 s45, s45, 11
    s_add_u32 s45, s45, s25
    v_mov_b32 v16, 0x3afe3f80
    v_mov_b32 v17, 0
    v_mov_b32 v18, 0
    v_mov_b32 v19, 0
    v_mov_b32 v20, 0
    v_mov_b32 v21, 0
    v_cndmask_b32 v16, v17, v16, vcc
    v_cmp_gt_u32 vcc, 32, v0
    v_mov_b32 v22, 0
    v_mov_b32 v23, 0
    v_mov_b32 v24, 0
    v_cndmask_b32 v20, v17, v6, vcc
    v_mov_b32 v25, 0
    v_mov_b32 v26, 0
    v_mov_b32 v27, 0
    s_nop 0
    v_mfma_f32_32x32x16_bf16 a[32:47], v[20:23], v[16:19], 0
    v_mfma_f32_32x32x16_bf16 a[48:63], v[20:23], v[16:19], 0
    v_mfma_f32_32x32x16_bf16 a[64:79], v[20:23], v[16:19], 0
    v_mfma_f32_32x32x16_bf16 v[64:79], v[24:27], v[24:27], 0
    v_mfma_f32_32x32x16_bf16 v[80:95], v[24:27], v[24:27], 0
    v_mfma_f32_32x32x16_bf16 v[96:111], v[24:27], v[24:27], 0
    v_mfma_f32_32x32x16_bf16 v[112:127], v[24:27], v[24:27], 0
    v_mfma_f32_32x32x16_bf16 v[128:143], v[24:27], v[24:27], 0
    v_mfma_f32_32x32x16_bf16 v[144:159], v[24:27], v[24:27], 0
    v_mfma_f32_32x32x16_bf16 v[160:175], v[24:27], v[24:27], 0
    v_mfma_f32_32x32x16_bf16 v[176:191], v[24:27], v[24:27], 0
    s_cmp_lg_u32 s20, 1
    s_cbranch_scc1 L_go2
    s_mov_b32 exec_lo, 0xffffffff
    s_mov_b32 exec_hi, 0
    s_mov_b32 s60, 0
    s_add_u32 s34, s35, 32768
    s_waitcnt vmcnt(0)
    v_cmp_gt_u32 vcc, s61, v241
    s_cbranch_vccz L_done2
    s_mov_b64 exec, vcc
L_poll2:
    buffer_load_dword v2, v240, s[4:7], s35 offen sc1
    s_add_u32 s60, s60, 1
    s_waitcnt vmcnt(0)
    v_cmp_gt_u32 vcc, s61, v2
    s_cbranch_vccz L_done2
    s_mov_b64 exec, vcc
    s_cmp_lt_u32 s60, 0x20000
    s_cbranch_scc1 L_poll2
L_done2:
    s_mov_b64 exec, -1
L_go2:
    s_barrier
L_attn:
    global_load_dwordx4 a[32:35], v1, s[86:87] offset:-4096 sc1
    buffer_load_dwordx4 a[0:3], v1, s[4:7], s42 offen offset:0 sc1
    buffer_load_dwordx4 a[4:7], v1, s[4:7], s42 offen offset:1024 sc1
    s_mov_b64 exec, s[40:41]
    global_load_dwordx4 a[36:39], v7, s[86:87] offset:-3072 sc1
    global_load_dwordx4 a[40:43], v7, s[86:87] offset:-2560 sc1
    s_mov_b64 exec, -1
    s_waitcnt vmcnt(3)
    v_mfma_f32_32x32x16_bf16 v[32:47], a[32:35], a[0:3], 0
    buffer_load_dwordx4 a[8:11], v1, s[4:7], s43 offen offset:0 sc1
    buffer_load_dwordx4 a[12:15], v1, s[4:7], s43 offen offset:1024 sc1
    buffer_load_dwordx4 a[16:19], v1, s[4:7], s44 offen offset:0 sc1
    buffer_load_dwordx4 a[20:23], v1, s[4:7], s44 offen offset:1024 sc1
    s_nop 7
    v_exp_f32 v32, v32
    v_exp_f32 v33, v33
    s_waitcnt vmcnt(6)
    v_exp_f32 v34, v34
    v_exp_f32 v35, v35
    v_exp_f32 v36, v36
    v_mfma_f32_32x32x16_bf16 v[48:63], a[32:35], a[4:7], 0
    s_waitcnt vmcnt(4)
    v_exp_f32 v37, v37
    v_exp_f32 v38, v38
    v_exp_f32 v39, v39
    v_exp_f32 v40, v40
    v_exp_f32 v41, v41
    v_smfmac_f32_32x32x32_bf16 v[64:79], a[36:39], v[32:39], v3
    buffer_load_dwordx4 a[24:27], v1, s[4:7], s45 offen offset:0 sc1
    buffer_load_dwordx4 a[28:31], v1, s[4:7], s45 offen offset:1024 sc1
    v_exp_f32 v42, v42
    v_exp_f32 v43, v43
    v_exp_f32 v44, v44
    v_exp_f32 v45, v45
    v_exp_f32 v46, v46
    v_exp_f32 v47, v47
    v_exp_f32 v48, v48
    v_exp_f32 v49, v49
    v_smfmac_f32_32x32x32_bf16 v[64:79], a[40:43], v[40:47], v3
    s_waitcnt vmcnt(5)
    v_exp_f32 v50, v50
    v_exp_f32 v51, v51
    v_exp_f32 v52, v52
    v_mfma_f32_32x32x16_bf16 v[32:47], a[32:35], a[8:11], 0
    v_exp_f32 v53, v53
    v_exp_f32 v54, v54
    v_exp_f32 v55, v55
    v_exp_f32 v56, v56
    v_exp_f32 v57, v57
    v_smfmac_f32_32x32x32_bf16 v[80:95], a[36:39], v[48:55], v3
    global_load_dwordx4 a[44:47], v1, s[86:87] offset:-2048 sc1
    s_mov_b64 exec, s[40:41]
    global_load_dwordx4 a[48:51], v7, s[86:87] offset:-1024 sc1
    global_load_dwordx4 a[52:55], v7, s[86:87] offset:-512 sc1
    s_mov_b64 exec, -1
    v_exp_f32 v58, v58
    v_exp_f32 v59, v59
    v_exp_f32 v60, v60
    v_exp_f32 v61, v61
    v_exp_f32 v62, v62
    v_exp_f32 v63, v63
    v_exp_f32 v32, v32
    v_exp_f32 v33, v33
    v_smfmac_f32_32x32x32_bf16 v[80:95], a[40:43], v[56:63], v3
    s_waitcnt vmcnt(7)
    v_exp_f32 v34, v34
    v_exp_f32 v35, v35
    v_exp_f32 v36, v36
    v_mfma_f32_32x32x16_bf16 v[48:63], a[32:35], a[12:15], 0
    v_exp_f32 v37, v37
    v_exp_f32 v38, v38
    v_exp_f32 v39, v39
    v_exp_f32 v40, v40
    v_exp_f32 v41, v41
    v_smfmac_f32_32x32x32_bf16 v[96:111], a[36:39], v[32:39], v3
    v_exp_f32 v42, v42
    v_exp_f32 v43, v43
    v_exp_f32 v44, v44
    v_exp_f32 v45, v45
    v_exp_f32 v46, v46
    v_exp_f32 v47, v47
    v_exp_f32 v48, v48
    v_exp_f32 v49, v49
    v_smfmac_f32_32x32x32_bf16 v[96:111], a[40:43], v[40:47], v3
    s_waitcnt vmcnt(6)
    s_mov_b64 exec, s[40:41]
    global_load_dwordx4 a[60:63], v7, s[86:87] offset:1024 sc1
    global_load_dwordx4 a[64:67], v7, s[86:87] offset:1536 sc1
    s_mov_b64 exec, -1
    global_load_dwordx4 a[56:59], v1, s[86:87] offset:0 sc1
    v_exp_f32 v50, v50
    v_exp_f32 v51, v51
    v_exp_f32 v52, v52
    v_mfma_f32_32x32x16_bf16 v[32:47], a[32:35], a[16:19], 0
    v_exp_f32 v53, v53
    v_exp_f32 v54, v54
    v_exp_f32 v55, v55
    v_exp_f32 v56, v56
    v_exp_f32 v57, v57
    v_smfmac_f32_32x32x32_bf16 v[112:127], a[36:39], v[48:55], v3
    v_exp_f32 v58, v58
    v_exp_f32 v59, v59
    v_exp_f32 v60, v60
    v_exp_f32 v61, v61
    v_exp_f32 v62, v62
    v_exp_f32 v63, v63
    v_exp_f32 v32, v32
    v_exp_f32 v33, v33
    v_smfmac_f32_32x32x32_bf16 v[112:127], a[40:43], v[56:63], v3
    s_waitcnt vmcnt(8)
    buffer_store_dwordx4 a[224:227], v224, s[4:7], 0 offen sc1
    v_add_u32 v224, v224, v225
    v_exp_f32 v34, v34
    v_exp_f32 v35, v35
    v_exp_f32 v36, v36
    v_mfma_f32_32x32x16_bf16 v[48:63], a[32:35], a[20:23], 0
    v_exp_f32 v37, v37
    v_exp_f32 v38, v38
    v_exp_f32 v39, v39
    v_exp_f32 v40, v40
    v_exp_f32 v41, v41
    v_smfmac_f32_32x32x32_bf16 v[128:143], a[36:39], v[32:39], v3
    v_exp_f32 v42, v42
    v_exp_f32 v43, v43
    v_exp_f32 v44, v44
    v_exp_f32 v45, v45
    v_exp_f32 v46, v46
    v_exp_f32 v47, v47
    v_exp_f32 v48, v48
    v_exp_f32 v49, v49
    v_smfmac_f32_32x32x32_bf16 v[128:143], a[40:43], v[40:47], v3
    s_waitcnt vmcnt(8)
    buffer_store_dwordx4 a[228:231], v224, s[4:7], 0 offen sc1
    v_add_u32 v224, v224, v225
    v_exp_f32 v50, v50
    v_exp_f32 v51, v51
    v_exp_f32 v52, v52
    v_mfma_f32_32x32x16_bf16 v[32:47], a[32:35], a[24:27], 0
    v_exp_f32 v53, v53
    v_exp_f32 v54, v54
    v_exp_f32 v55, v55
    v_exp_f32 v56, v56
    v_exp_f32 v57, v57
    v_smfmac_f32_32x32x32_bf16 v[144:159], a[36:39], v[48:55], v3
    v_exp_f32 v58, v58
    v_exp_f32 v59, v59
    v_exp_f32 v60, v60
    v_exp_f32 v61, v61
    v_exp_f32 v62, v62
    v_exp_f32 v63, v63
    v_exp_f32 v32, v32
    v_exp_f32 v33, v33
    v_smfmac_f32_32x32x32_bf16 v[144:159], a[40:43], v[56:63], v3
    s_waitcnt vmcnt(8)
    s_mov_b64 exec, s[40:41]
    global_load_dwordx4 a[72:75], v7, s[86:87] offset:3072 sc1
    global_load_dwordx4 a[76:79], v7, s[86:87] offset:3584 sc1
    s_mov_b64 exec, -1
    global_load_dwordx4 a[68:71], v1, s[86:87] offset:2048 sc1
    v_exp_f32 v34, v34
    v_exp_f32 v35, v35
    v_exp_f32 v36, v36
    v_mfma_f32_32x32x16_bf16 v[48:63], a[32:35], a[28:31], 0
    v_exp_f32 v37, v37
    v_exp_f32 v38, v38
    v_exp_f32 v39, v39
    v_exp_f32 v40, v40
    v_exp_f32 v41, v41
    v_smfmac_f32_32x32x32_bf16 v[160:175], a[36:39], v[32:39], v3
    s_add_u32 s86, s86, 8192
    s_addc_u32 s87, s87, 0
    v_exp_f32 v42, v42
    v_exp_f32 v43, v43
    v_exp_f32 v44, v44
    v_exp_f32 v45, v45
    v_exp_f32 v46, v46
    v_exp_f32 v47, v47
    v_exp_f32 v48, v48
    v_exp_f32 v49, v49
    v_smfmac_f32_32x32x32_bf16 v[160:175], a[40:43], v[40:47], v3
    s_waitcnt vmcnt(10)
    v_exp_f32 v50, v50
    v_exp_f32 v51, v51
    v_exp_f32 v52, v52
    v_mfma_f32_32x32x16_bf16 v[32:47], a[44:47], a[0:3], 0
    v_exp_f32 v53, v53
    v_exp_f32 v54, v54
    v_exp_f32 v55, v55
    v_exp_f32 v56, v56
    v_exp_f32 v57, v57
    v_smfmac_f32_32x32x32_bf16 v[176:191], a[36:39], v[48:55], v3
    v_exp_f32 v58, v58
    v_exp_f32 v59, v59
    v_exp_f32 v60, v60
    v_exp_f32 v61, v61
    v_exp_f32 v62, v62
    v_exp_f32 v63, v63
    v_exp_f32 v32, v32
    v_exp_f32 v33, v33
    v_smfmac_f32_32x32x32_bf16 v[176:191], a[40:43], v[56:63], v3
    buffer_store_dwordx4 a[232:235], v224, s[4:7], 0 offen sc1
    v_add_u32 v224, v224, v225
    v_exp_f32 v34, v34
    v_exp_f32 v35, v35
    v_exp_f32 v36, v36
    v_mfma_f32_32x32x16_bf16 v[48:63], a[44:47], a[4:7], 0
    s_waitcnt vmcnt(9)
    v_exp_f32 v37, v37
    v_exp_f32 v38, v38
    v_exp_f32 v39, v39
    v_exp_f32 v40, v40
    v_exp_f32 v41, v41
    v_smfmac_f32_32x32x32_bf16 v[64:79], a[48:51], v[32:39], v3
    v_exp_f32 v42, v42
    v_exp_f32 v43, v43
    v_exp_f32 v44, v44
    v_exp_f32 v45, v45
    v_exp_f32 v46, v46
    v_exp_f32 v47, v47
    v_exp_f32 v48, v48
    v_exp_f32 v49, v49
    v_smfmac_f32_32x32x32_bf16 v[64:79], a[52:55], v[40:47], v3
    s_mov_b64 exec, s[40:41]
    global_load_dwordx4 a[36:39], v7, s[86:87] offset:-3072 sc1
    global_load_dwordx4 a[40:43], v7, s[86:87] offset:-2560 sc1
    s_mov_b64 exec, -1
    global_load_dwordx4 a[32:35], v1, s[86:87] offset:-4096 sc1
    v_exp_f32 v50, v50
    v_exp_f32 v51, v51
    v_exp_f32 v52, v52
    v_mfma_f32_32x32x16_bf16 v[32:47], a[44:47], a[8:11], 0
    v_exp_f32 v53, v53
    v_exp_f32 v54, v54
    v_exp_f32 v55, v55
    v_exp_f32 v56, v56
    v_exp_f32 v57, v57
    v_smfmac_f32_32x32x32_bf16 v[80:95], a[48:51], v[48:55], v3
    v_exp_f32 v58, v58
    v_exp_f32 v59, v59
    v_exp_f32 v60, v60
    v_exp_f32 v61, v61
    v_exp_f32 v62, v62
    v_exp_f32 v63, v63
    v_exp_f32 v32, v32
    v_exp_f32 v33, v33
    v_smfmac_f32_32x32x32_bf16 v[80:95], a[52:55], v[56:63], v3
    buffer_store_dwordx4 a[236:239], v224, s[4:7], 0 offen sc1
    v_add_u32 v224, v224, v225
    v_exp_f32 v34, v34
    v_exp_f32 v35, v35
    v_exp_f32 v36, v36
    v_mfma_f32_32x32x16_bf16 v[48:63], a[44:47], a[12:15], 0
    v_exp_f32 v37, v37
    v_exp_f32 v38, v38
    v_exp_f32 v39, v39
    v_exp_f32 v40, v40
    v_exp_f32 v41, v41
    v_smfmac_f32_32x32x32_bf16 v[96:111], a[48:51], v[32:39], v3
    v_exp_f32 v42, v42
    v_exp_f32 v43, v43
    v_exp_f32 v44, v44
    v_exp_f32 v45, v45
    v_exp_f32 v46, v46
    v_exp_f32 v47, v47
    v_exp_f32 v48, v48
    v_exp_f32 v49, v49
    v_smfmac_f32_32x32x32_bf16 v[96:111], a[52:55], v[40:47], v3
    buffer_store_dwordx4 a[240:243], v224, s[4:7], 0 offen sc1
    v_add_u32 v224, v224, v225
    v_exp_f32 v50, v50
    v_exp_f32 v51, v51
    v_exp_f32 v52, v52
    v_mfma_f32_32x32x16_bf16 v[32:47], a[44:47], a[16:19], 0
    v_exp_f32 v53, v53
    v_exp_f32 v54, v54
    v_exp_f32 v55, v55
    v_exp_f32 v56, v56
    v_exp_f32 v57, v57
    v_smfmac_f32_32x32x32_bf16 v[112:127], a[48:51], v[48:55], v3
    v_exp_f32 v58, v58
    v_exp_f32 v59, v59
    v_exp_f32 v60, v60
    v_exp_f32 v61, v61
    v_exp_f32 v62, v62
    v_exp_f32 v63, v63
    v_exp_f32 v32, v32
    v_exp_f32 v33, v33
    v_smfmac_f32_32x32x32_bf16 v[112:127], a[52:55], v[56:63], v3
    buffer_store_dwordx4 a[244:247], v224, s[4:7], 0 offen sc1
    v_add_u32 v224, v224, v225
    v_exp_f32 v34, v34
    v_exp_f32 v35, v35
    v_exp_f32 v36, v36
    v_mfma_f32_32x32x16_bf16 v[48:63], a[44:47], a[20:23], 0
    v_exp_f32 v37, v37
    v_exp_f32 v38, v38
    v_exp_f32 v39, v39
    v_exp_f32 v40, v40
    v_exp_f32 v41, v41
    v_smfmac_f32_32x32x32_bf16 v[128:143], a[48:51], v[32:39], v3
    v_exp_f32 v42, v42
    v_exp_f32 v43, v43
    v_exp_f32 v44, v44
    v_exp_f32 v45, v45
    v_exp_f32 v46, v46
    v_exp_f32 v47, v47
    v_exp_f32 v48, v48
    v_exp_f32 v49, v49
    v_smfmac_f32_32x32x32_bf16 v[128:143], a[52:55], v[40:47], v3
    buffer_store_dwordx4 a[248:251], v224, s[4:7], 0 offen sc1
    v_add_u32 v224, v224, v225
    v_exp_f32 v50, v50
    v_exp_f32 v51, v51
    v_exp_f32 v52, v52
    v_mfma_f32_32x32x16_bf16 v[32:47], a[44:47], a[24:27], 0
    v_exp_f32 v53, v53
    v_exp_f32 v54, v54
    v_exp_f32 v55, v55
    v_exp_f32 v56, v56
    v_exp_f32 v57, v57
    v_smfmac_f32_32x32x32_bf16 v[144:159], a[48:51], v[48:55], v3
    v_exp_f32 v58, v58
    v_exp_f32 v59, v59
    v_exp_f32 v60, v60
    v_exp_f32 v61, v61
    v_exp_f32 v62, v62
    v_exp_f32 v63, v63
    v_exp_f32 v32, v32
    v_exp_f32 v33, v33
    v_smfmac_f32_32x32x32_bf16 v[144:159], a[52:55], v[56:63], v3
    buffer_store_dwordx4 a[252:255], v224, s[4:7], 0 offen sc1
    v_add_u32 v224, v224, v225
    v_exp_f32 v34, v34
    v_exp_f32 v35, v35
    v_exp_f32 v36, v36
    v_mfma_f32_32x32x16_bf16 v[48:63], a[44:47], a[28:31], 0
    v_exp_f32 v37, v37
    v_exp_f32 v38, v38
    v_exp_f32 v39, v39
    v_exp_f32 v40, v40
    v_exp_f32 v41, v41
    v_smfmac_f32_32x32x32_bf16 v[160:175], a[48:51], v[32:39], v3
    v_exp_f32 v42, v42
    v_exp_f32 v43, v43
    v_exp_f32 v44, v44
    v_exp_f32 v45, v45
    v_exp_f32 v46, v46
    v_exp_f32 v47, v47
    v_exp_f32 v48, v48
    v_exp_f32 v49, v49
    v_smfmac_f32_32x32x32_bf16 v[160:175], a[52:55], v[40:47], v3
    s_waitcnt vmcnt(14)
    v_exp_f32 v50, v50
    v_exp_f32 v51, v51
    v_exp_f32 v52, v52
    v_mfma_f32_32x32x16_bf16 v[32:47], a[56:59], a[0:3], 0
    v_exp_f32 v53, v53
    v_exp_f32 v54, v54
    v_exp_f32 v55, v55
    v_exp_f32 v56, v56
    v_exp_f32 v57, v57
    v_smfmac_f32_32x32x32_bf16 v[176:191], a[48:51], v[48:55], v3
    v_exp_f32 v58, v58
    v_exp_f32 v59, v59
    v_exp_f32 v60, v60
    v_exp_f32 v61, v61
    v_exp_f32 v62, v62
    v_exp_f32 v63, v63
    v_exp_f32 v32, v32
    v_exp_f32 v33, v33
    v_smfmac_f32_32x32x32_bf16 v[176:191], a[52:55], v[56:63], v3
    buffer_store_dwordx2 v[228:229], v226, s[4:7], 0 offen sc1
    v_exp_f32 v34, v34
    v_exp_f32 v35, v35
    v_exp_f32 v36, v36
    v_mfma_f32_32x32x16_bf16 v[48:63], a[56:59], a[4:7], 0
    v_exp_f32 v37, v37
    v_exp_f32 v38, v38
    v_exp_f32 v39, v39
    v_exp_f32 v40, v40
    v_exp_f32 v41, v41
    v_smfmac_f32_32x32x32_bf16 v[64:79], a[60:63], v[32:39], v3
    v_exp_f32 v42, v42
    v_exp_f32 v43, v43
    v_exp_f32 v44, v44
    v_exp_f32 v45, v45
    v_exp_f32 v46, v46
    v_exp_f32 v47, v47
    v_exp_f32 v48, v48
    v_exp_f32 v49, v49
    v_smfmac_f32_32x32x32_bf16 v[64:79], a[64:67], v[40:47], v3
    s_mov_b64 exec, s[40:41]
    global_load_dwordx4 a[48:51], v7, s[86:87] offset:-1024 sc1
    global_load_dwordx4 a[52:55], v7, s[86:87] offset:-512 sc1
    s_mov_b64 exec, -1
    global_load_dwordx4 a[44:47], v1, s[86:87] offset:-2048 sc1
    v_exp_f32 v50, v50
    v_exp_f32 v51, v51
    v_exp_f32 v52, v52
    v_mfma_f32_32x32x16_bf16 v[32:47], a[56:59], a[8:11], 0
    v_exp_f32 v53, v53
    v_exp_f32 v54, v54
    v_exp_f32 v55, v55
    v_exp_f32 v56, v56
    v_exp_f32 v57, v57
    v_smfmac_f32_32x32x32_bf16 v[80:95], a[60:63], v[48:55], v3
    v_exp_f32 v58, v58
    v_exp_f32 v59, v59
    v_exp_f32 v60, v60
    v_exp_f32 v61, v61
    v_exp_f32 v62, v62
    v_exp_f32 v63, v63
    v_exp_f32 v32, v32
    v_exp_f32 v33, v33
    v_smfmac_f32_32x32x32_bf16 v[80:95], a[64:67], v[56:63], v3
    v_exp_f32 v34, v34
    v_exp_f32 v35, v35
    v_exp_f32 v36, v36
    v_mfma_f32_32x32x16_bf16 v[48:63], a[56:59], a[12:15], 0
    v_exp_f32 v37, v37
    v_exp_f32 v38, v38
    v_exp_f32 v39, v39
    v_exp_f32 v40, v40
    v_exp_f32 v41, v41
    v_smfmac_f32_32x32x32_bf16 v[96:111], a[60:63], v[32:39], v3
    v_exp_f32 v42, v42
    v_exp_f32 v43, v43
    v_exp_f32 v44, v44
    v_exp_f32 v45, v45
    v_exp_f32 v46, v46
    v_exp_f32 v47, v47
    v_exp_f32 v48, v48
    v_exp_f32 v49, v49
    v_smfmac_f32_32x32x32_bf16 v[96:111], a[64:67], v[40:47], v3
    v_exp_f32 v50, v50
    v_exp_f32 v51, v51
    v_exp_f32 v52, v52
    v_mfma_f32_32x32x16_bf16 v[32:47], a[56:59], a[16:19], 0
    v_exp_f32 v53, v53
    v_exp_f32 v54, v54
    v_exp_f32 v55, v55
    v_exp_f32 v56, v56
    v_exp_f32 v57, v57
    v_smfmac_f32_32x32x32_bf16 v[112:127], a[60:63], v[48:55], v3
    v_exp_f32 v58, v58
    v_exp_f32 v59, v59
    v_exp_f32 v60, v60
    v_exp_f32 v61, v61
    v_exp_f32 v62, v62
    v_exp_f32 v63, v63
    v_exp_f32 v32, v32
    v_exp_f32 v33, v33
    v_smfmac_f32_32x32x32_bf16 v[112:127], a[64:67], v[56:63], v3
    v_exp_f32 v34, v34
    v_exp_f32 v35, v35
    v_exp_f32 v36, v36
    v_mfma_f32_32x32x16_bf16 v[48:63], a[56:59], a[20:23], 0
    v_exp_f32 v37, v37
    v_exp_f32 v38, v38
    v_exp_f32 v39, v39
    v_exp_f32 v40, v40
    v_exp_f32 v41, v41
    v_smfmac_f32_32x32x32_bf16 v[128:143], a[60:63], v[32:39], v3
    v_exp_f32 v42, v42
    v_exp_f32 v43, v43
    v_exp_f32 v44, v44
    v_exp_f32 v45, v45
    v_exp_f32 v46, v46
    v_exp_f32 v47, v47
    v_exp_f32 v48, v48
    v_exp_f32 v49, v49
    v_smfmac_f32_32x32x32_bf16 v[128:143], a[64:67], v[40:47], v3
    v_exp_f32 v50, v50
    v_exp_f32 v51, v51
    v_exp_f32 v52, v52
    v_mfma_f32_32x32x16_bf16 v[32:47], a[56:59], a[24:27], 0
    v_exp_f32 v53, v53
    v_exp_f32 v54, v54
    v_exp_f32 v55, v55
    v_exp_f32 v56, v56
    v_exp_f32 v57, v57
    v_smfmac_f32_32x32x32_bf16 v[144:159], a[60:63], v[48:55], v3
    v_exp_f32 v58, v58
    v_exp_f32 v59, v59
    v_exp_f32 v60, v60
    v_exp_f32 v61, v61
    v_exp_f32 v62, v62
    v_exp_f32 v63, v63
    v_exp_f32 v32, v32
    v_exp_f32 v33, v33
    v_smfmac_f32_32x32x32_bf16 v[144:159], a[64:67], v[56:63], v3
    v_exp_f32 v34, v34
    v_exp_f32 v35, v35
    v_exp_f32 v36, v36
    v_mfma_f32_32x32x16_bf16 v[48:63], a[56:59], a[28:31], 0
    v_exp_f32 v37, v37
    v_exp_f32 v38, v38
    v_exp_f32 v39, v39
    v_exp_f32 v40, v40
    v_exp_f32 v41, v41
    v_smfmac_f32_32x32x32_bf16 v[160:175], a[60:63], v[32:39], v3
    v_exp_f32 v42, v42
    v_exp_f32 v43, v43
    v_exp_f32 v44, v44
    v_exp_f32 v45, v45
    v_exp_f32 v46, v46
    v_exp_f32 v47, v47
    v_exp_f32 v48, v48
    v_exp_f32 v49, v49
    v_smfmac_f32_32x32x32_bf16 v[160:175], a[64:67], v[40:47], v3
    s_waitcnt vmcnt(13)
    v_exp_f32 v50, v50
    v_exp_f32 v51, v51
    v_exp_f32 v52, v52
    v_mfma_f32_32x32x16_bf16 v[32:47], a[68:71], a[0:3], 0
    v_exp_f32 v53, v53
    v_exp_f32 v54, v54
    v_exp_f32 v55, v55
    v_exp_f32 v56, v56
    v_exp_f32 v57, v57
    v_smfmac_f32_32x32x32_bf16 v[176:191], a[60:63], v[48:55], v3
    s_cmp_eq_u32 s88, 0
    s_cbranch_scc1 L_bsig
L_bsig_ret:
    v_exp_f32 v58, v58
    v_exp_f32 v59, v59
    v_exp_f32 v60, v60
    v_exp_f32 v61, v61
    v_exp_f32 v62, v62
    v_exp_f32 v63, v63
    v_exp_f32 v32, v32
    v_exp_f32 v33, v33
    v_smfmac_f32_32x32x32_bf16 v[176:191], a[64:67], v[56:63], v3
    v_exp_f32 v34, v34
    v_exp_f32 v35, v35
    v_exp_f32 v36, v36
    v_mfma_f32_32x32x16_bf16 v[48:63], a[68:71], a[4:7], 0
    v_exp_f32 v37, v37
    v_exp_f32 v38, v38
    v_exp_f32 v39, v39
    v_exp_f32 v40, v40
    v_exp_f32 v41, v41
    v_smfmac_f32_32x32x32_bf16 v[64:79], a[72:75], v[32:39], v3
    v_exp_f32 v42, v42
    v_exp_f32 v43, v43
    v_exp_f32 v44, v44
    v_exp_f32 v45, v45
    v_exp_f32 v46, v46
    v_exp_f32 v47, v47
    v_exp_f32 v48, v48
    v_exp_f32 v49, v49
    v_smfmac_f32_32x32x32_bf16 v[64:79], a[76:79], v[40:47], v3
    s_mov_b64 exec, s[40:41]
    global_load_dwordx4 a[60:63], v7, s[86:87] offset:1024 sc1
    global_load_dwordx4 a[64:67], v7, s[86:87] offset:1536 sc1
    s_mov_b64 exec, -1
    global_load_dwordx4 a[56:59], v1, s[86:87] offset:0 sc1
    v_exp_f32 v50, v50
    v_exp_f32 v51, v51
    v_exp_f32 v52, v52
    v_mfma_f32_32x32x16_bf16 v[32:47], a[68:71], a[8:11], 0
    v_exp_f32 v53, v53
    v_exp_f32 v54, v54
    v_exp_f32 v55, v55
    v_exp_f32 v56, v56
    v_exp_f32 v57, v57
    v_smfmac_f32_32x32x32_bf16 v[80:95], a[72:75], v[48:55], v3
    v_exp_f32 v58, v58
    v_exp_f32 v59, v59
    v_exp_f32 v60, v60
    v_exp_f32 v61, v61
    v_exp_f32 v62, v62
    v_exp_f32 v63, v63
    v_exp_f32 v32, v32
    v_exp_f32 v33, v33
    v_smfmac_f32_32x32x32_bf16 v[80:95], a[76:79], v[56:63], v3
    v_exp_f32 v34, v34
    v_exp_f32 v35, v35
    v_exp_f32 v36, v36
    v_mfma_f32_32x32x16_bf16 v[48:63], a[68:71], a[12:15], 0
    v_exp_f32 v37, v37
    v_exp_f32 v38, v38
    v_exp_f32 v39, v39
    v_exp_f32 v40, v40
    v_exp_f32 v41, v41
    v_smfmac_f32_32x32x32_bf16 v[96:111], a[72:75], v[32:39], v3
    v_exp_f32 v42, v42
    v_exp_f32 v43, v43
    v_exp_f32 v44, v44
    v_exp_f32 v45, v45
    v_exp_f32 v46, v46
    v_exp_f32 v47, v47
    v_exp_f32 v48, v48
    v_exp_f32 v49, v49
    v_smfmac_f32_32x32x32_bf16 v[96:111], a[76:79], v[40:47], v3
    v_exp_f32 v50, v50
    v_exp_f32 v51, v51
    v_exp_f32 v52, v52
    v_mfma_f32_32x32x16_bf16 v[32:47], a[68:71], a[16:19], 0
    v_exp_f32 v53, v53
    v_exp_f32 v54, v54
    v_exp_f32 v55, v55
    v_exp_f32 v56, v56
    v_exp_f32 v57, v57
    v_smfmac_f32_32x32x32_bf16 v[112:127], a[72:75], v[48:55], v3
    v_exp_f32 v58, v58
    v_exp_f32 v59, v59
    v_exp_f32 v60, v60
    v_exp_f32 v61, v61
    v_exp_f32 v62, v62
    v_exp_f32 v63, v63
    v_exp_f32 v32, v32
    v_exp_f32 v33, v33
    v_smfmac_f32_32x32x32_bf16 v[112:127], a[76:79], v[56:63], v3
    v_exp_f32 v34, v34
    v_exp_f32 v35, v35
    v_exp_f32 v36, v36
    v_mfma_f32_32x32x16_bf16 v[48:63], a[68:71], a[20:23], 0
    v_exp_f32 v37, v37
    v_exp_f32 v38, v38
    v_exp_f32 v39, v39
    v_exp_f32 v40, v40
    v_exp_f32 v41, v41
    v_smfmac_f32_32x32x32_bf16 v[128:143], a[72:75], v[32:39], v3
    s_cmp_eq_u32 s88, 0
    s_cbranch_scc1 L_bld
L_bld_ret:
    v_exp_f32 v42, v42
    v_exp_f32 v43, v43
    v_exp_f32 v44, v44
    v_exp_f32 v45, v45
    v_exp_f32 v46, v46
    v_exp_f32 v47, v47
    v_exp_f32 v48, v48
    v_exp_f32 v49, v49
    v_smfmac_f32_32x32x32_bf16 v[128:143], a[76:79], v[40:47], v3
    v_exp_f32 v50, v50
    v_exp_f32 v51, v51
    v_exp_f32 v52, v52
    v_mfma_f32_32x32x16_bf16 v[32:47], a[68:71], a[24:27], 0
    v_exp_f32 v53, v53
    v_exp_f32 v54, v54
    v_exp_f32 v55, v55
    v_exp_f32 v56, v56
    v_exp_f32 v57, v57
    v_smfmac_f32_32x32x32_bf16 v[144:159], a[72:75], v[48:55], v3
    v_exp_f32 v58, v58
    v_exp_f32 v59, v59
    v_exp_f32 v60, v60
    v_exp_f32 v61, v61
    v_exp_f32 v62, v62
    v_exp_f32 v63, v63
    v_exp_f32 v32, v32
    v_exp_f32 v33, v33
    v_smfmac_f32_32x32x32_bf16 v[144:159], a[76:79], v[56:63], v3
    v_exp_f32 v34, v34
    v_exp_f32 v35, v35
    v_exp_f32 v36, v36
    v_mfma_f32_32x32x16_bf16 v[48:63], a[68:71], a[28:31], 0
    v_exp_f32 v37, v37
    v_exp_f32 v38, v38
    v_exp_f32 v39, v39
    v_exp_f32 v40, v40
    v_exp_f32 v41, v41
    v_smfmac_f32_32x32x32_bf16 v[160:175], a[72:75], v[32:39], v3
    v_exp_f32 v42, v42
    v_exp_f32 v43, v43
    v_exp_f32 v44, v44
    v_exp_f32 v45, v45
    v_exp_f32 v46, v46
    v_exp_f32 v47, v47
    v_exp_f32 v48, v48
    v_exp_f32 v49, v49
    v_smfmac_f32_32x32x32_bf16 v[160:175], a[76:79], v[40:47], v3
    s_waitcnt vmcnt(12)
    v_exp_f32 v50, v50
    v_exp_f32 v51, v51
    v_exp_f32 v52, v52
    v_mfma_f32_32x32x16_bf16 v[32:47], a[32:35], a[0:3], 0
    v_exp_f32 v53, v53
    v_exp_f32 v54, v54
    v_exp_f32 v55, v55
    v_exp_f32 v56, v56
    v_exp_f32 v57, v57
    v_smfmac_f32_32x32x32_bf16 v[176:191], a[72:75], v[48:55], v3
    v_exp_f32 v58, v58
    v_exp_f32 v59, v59
    v_exp_f32 v60, v60
    v_exp_f32 v61, v61
    v_exp_f32 v62, v62
    v_exp_f32 v63, v63
    v_exp_f32 v32, v32
    v_exp_f32 v33, v33
    v_smfmac_f32_32x32x32_bf16 v[176:191], a[76:79], v[56:63], v3
    v_exp_f32 v34, v34
    v_exp_f32 v35, v35
    v_exp_f32 v36, v36
    v_mfma_f32_32x32x16_bf16 v[48:63], a[32:35], a[4:7], 0
    v_exp_f32 v37, v37
    v_exp_f32 v38, v38
    v_exp_f32 v39, v39
    v_exp_f32 v40, v40
    v_exp_f32 v41, v41
    v_smfmac_f32_32x32x32_bf16 v[64:79], a[36:39], v[32:39], v3
    v_exp_f32 v42, v42
    v_exp_f32 v43, v43
    v_exp_f32 v44, v44
    v_exp_f32 v45, v45
    v_exp_f32 v46, v46
    v_exp_f32 v47, v47
    v_exp_f32 v48, v48
    v_exp_f32 v49, v49
    v_smfmac_f32_32x32x32_bf16 v[64:79], a[40:43], v[40:47], v3
    s_mov_b64 exec, s[40:41]
    global_load_dwordx4 a[72:75], v7, s[86:87] offset:3072 sc1
    global_load_dwordx4 a[76:79], v7, s[86:87] offset:3584 sc1
    s_mov_b64 exec, -1
    global_load_dwordx4 a[68:71], v1, s[86:87] offset:2048 sc1
    v_exp_f32 v50, v50
    v_exp_f32 v51, v51
    v_exp_f32 v52, v52
    v_mfma_f32_32x32x16_bf16 v[32:47], a[32:35], a[8:11], 0
    v_exp_f32 v53, v53
    v_exp_f32 v54, v54
    v_exp_f32 v55, v55
    v_exp_f32 v56, v56
    v_exp_f32 v57, v57
    v_smfmac_f32_32x32x32_bf16 v[80:95], a[36:39], v[48:55], v3
    s_add_u32 s86, s86, 8192
    s_addc_u32 s87, s87, 0
    v_exp_f32 v58, v58
    v_exp_f32 v59, v59
    v_exp_f32 v60, v60
    v_exp_f32 v61, v61
    v_exp_f32 v62, v62
    v_exp_f32 v63, v63
    v_exp_f32 v32, v32
    v_exp_f32 v33, v33
    v_smfmac_f32_32x32x32_bf16 v[80:95], a[40:43], v[56:63], v3
    v_exp_f32 v34, v34
    v_exp_f32 v35, v35
    v_exp_f32 v36, v36
    v_mfma_f32_32x32x16_bf16 v[48:63], a[32:35], a[12:15], 0
    v_exp_f32 v37, v37
    v_exp_f32 v38, v38
    v_exp_f32 v39, v39
    v_exp_f32 v40, v40
    v_exp_f32 v41, v41
    v_smfmac_f32_32x32x32_bf16 v[96:111], a[36:39], v[32:39], v3
    s_cmp_eq_u32 s88, 0
    s_cbranch_scc1 L_bchk
L_bchk_ret:
    v_exp_f32 v42, v42
    v_exp_f32 v43, v43
    v_exp_f32 v44, v44
    v_exp_f32 v45, v45
    v_exp_f32 v46, v46
    v_exp_f32 v47, v47
    v_exp_f32 v48, v48
    v_exp_f32 v49, v49
    v_smfmac_f32_32x32x32_bf16 v[96:111], a[40:43], v[40:47], v3
    s_add_u32 s84, s4, s50
    s_addc_u32 s85, s5, 0
    v_exp_f32 v50, v50
    v_exp_f32 v51, v51
    v_exp_f32 v52, v52
    v_mfma_f32_32x32x16_bf16 v[32:47], a[32:35], a[16:19], 0
    s_add_u32 m0, s49, 0
    v_exp_f32 v53, v53
    v_exp_f32 v54, v54
    v_exp_f32 v55, v55
    v_exp_f32 v56, v56
    v_exp_f32 v57, v57
    v_smfmac_f32_32x32x32_bf16 v[112:127], a[36:39], v[48:55], v3
    global_load_lds_dwordx4 v1, s[84:85] offset:0 sc1
    global_load_lds_dwordx4 v1, s[84:85] offset:1024 sc1
    global_load_lds_dwordx4 v1, s[84:85] offset:2048 sc1
    global_load_lds_dwordx4 v1, s[84:85] offset:3072 sc1
    v_exp_f32 v58, v58
    v_exp_f32 v59, v59
    v_exp_f32 v60, v60
    v_exp_f32 v61, v61
    v_exp_f32 v62, v62
    v_exp_f32 v63, v63
    v_exp_f32 v32, v32
    v_exp_f32 v33, v33
    v_smfmac_f32_32x32x32_bf16 v[112:127], a[40:43], v[56:63], v3
    s_add_u32 s84, s84, 16384
    s_addc_u32 s85, s85, 0
    v_exp_f32 v34, v34
    v_exp_f32 v35, v35
    v_exp_f32 v36, v36
    v_mfma_f32_32x32x16_bf16 v[48:63], a[32:35], a[20:23], 0
    s_add_u32 m0, s49, 16384
    v_exp_f32 v37, v37
    v_exp_f32 v38, v38
    v_exp_f32 v39, v39
    v_exp_f32 v40, v40
    v_exp_f32 v41, v41
    v_smfmac_f32_32x32x32_bf16 v[128:143], a[36:39], v[32:39], v3
    global_load_lds_dwordx4 v1, s[84:85] offset:0 sc1
    global_load_lds_dwordx4 v1, s[84:85] offset:1024 sc1
    global_load_lds_dwordx4 v1, s[84:85] offset:2048 sc1
    global_load_lds_dwordx4 v1, s[84:85] offset:3072 sc1
    v_exp_f32 v42, v42
    v_exp_f32 v43, v43
    v_exp_f32 v44, v44
    v_exp_f32 v45, v45
    v_exp_f32 v46, v46
    v_exp_f32 v47, v47
    v_exp_f32 v48, v48
    v_exp_f32 v49, v49
    v_smfmac_f32_32x32x32_bf16 v[128:143], a[40:43], v[40:47], v3
    v_exp_f32 v50, v50
    v_exp_f32 v51, v51
    v_exp_f32 v52, v52
    v_mfma_f32_32x32x16_bf16 v[32:47], a[32:35], a[24:27], 0
    v_exp_f32 v53, v53
    v_exp_f32 v54, v54
    v_exp_f32 v55, v55
    v_exp_f32 v56, v56
    v_exp_f32 v57, v57
    v_smfmac_f32_32x32x32_bf16 v[144:159], a[36:39], v[48:55], v3
    v_exp_f32 v58, v58
    v_exp_f32 v59, v59
    v_exp_f32 v60, v60
    v_exp_f32 v61, v61
    v_exp_f32 v62, v62
    v_exp_f32 v63, v63
    v_exp_f32 v32, v32
    v_exp_f32 v33, v33
    v_smfmac_f32_32x32x32_bf16 v[144:159], a[40:43], v[56:63], v3
    s_add_u32 s84, s84, 16384
    s_addc_u32 s85, s85, 0
    v_exp_f32 v34, v34
    v_exp_f32 v35, v35
    v_exp_f32 v36, v36
    v_mfma_f32_32x32x16_bf16 v[48:63], a[32:35], a[28:31], 0
    s_add_u32 m0, s49, 32768
    v_exp_f32 v37, v37
    v_exp_f32 v38, v38
    v_exp_f32 v39, v39
    v_exp_f32 v40, v40
    v_exp_f32 v41, v41
    v_smfmac_f32_32x32x32_bf16 v[160:175], a[36:39], v[32:39], v3
    global_load_lds_dwordx4 v1, s[84:85] offset:0 sc1
    global_load_lds_dwordx4 v1, s[84:85] offset:1024 sc1
    global_load_lds_dwordx4 v1, s[84:85] offset:2048 sc1
    global_load_lds_dwordx4 v1, s[84:85] offset:3072 sc1
    v_exp_f32 v42, v42
    v_exp_f32 v43, v43
    v_exp_f32 v44, v44
    v_exp_f32 v45, v45
    v_exp_f32 v46, v46
    v_exp_f32 v47, v47
    v_exp_f32 v48, v48
    v_exp_f32 v49, v49
    v_smfmac_f32_32x32x32_bf16 v[160:175], a[40:43], v[40:47], v3
    s_waitcnt vmcnt(18)
    v_exp_f32 v50, v50
    v_exp_f32 v51, v51
    v_exp_f32 v52, v52
    v_mfma_f32_32x32x16_bf16 v[32:47], a[44:47], a[0:3], 0
    v_exp_f32 v53, v53
    v_exp_f32 v54, v54
    v_exp_f32 v55, v55
    v_exp_f32 v56, v56
    v_exp_f32 v57, v57
    v_smfmac_f32_32x32x32_bf16 v[176:191], a[36:39], v[48:55], v3
    v_exp_f32 v58, v58
    v_exp_f32 v59, v59
    v_exp_f32 v60, v60
    v_exp_f32 v61, v61
    v_exp_f32 v62, v62
    v_exp_f32 v63, v63
    v_exp_f32 v32, v32
    v_exp_f32 v33, v33
    v_smfmac_f32_32x32x32_bf16 v[176:191], a[40:43], v[56:63], v3
    v_exp_f32 v34, v34
    v_exp_f32 v35, v35
    v_exp_f32 v36, v36
    v_mfma_f32_32x32x16_bf16 v[48:63], a[44:47], a[4:7], 0
    v_exp_f32 v37, v37
    v_exp_f32 v38, v38
    v_exp_f32 v39, v39
    v_exp_f32 v40, v40
    v_exp_f32 v41, v41
    v_smfmac_f32_32x32x32_bf16 v[64:79], a[48:51], v[32:39], v3
    v_exp_f32 v42, v42
    v_exp_f32 v43, v43
    v_exp_f32 v44, v44
    v_exp_f32 v45, v45
    v_exp_f32 v46, v46
    v_exp_f32 v47, v47
    v_exp_f32 v48, v48
    v_exp_f32 v49, v49
    v_smfmac_f32_32x32x32_bf16 v[64:79], a[52:55], v[40:47], v3
    s_mov_b64 exec, s[40:41]
    global_load_dwordx4 a[36:39], v7, s[86:87] offset:-3072 sc1
    global_load_dwordx4 a[40:43], v7, s[86:87] offset:-2560 sc1
    s_mov_b64 exec, -1
    global_load_dwordx4 a[32:35], v1, s[86:87] offset:-4096 sc1
    v_exp_f32 v50, v50
    v_exp_f32 v51, v51
    v_exp_f32 v52, v52
    v_mfma_f32_32x32x16_bf16 v[32:47], a[44:47], a[8:11], 0
    v_exp_f32 v53, v53
    v_exp_f32 v54, v54
    v_exp_f32 v55, v55
    v_exp_f32 v56, v56
    v_exp_f32 v57, v57
    v_smfmac_f32_32x32x32_bf16 v[80:95], a[48:51], v[48:55], v3
    v_exp_f32 v58, v58
    v_exp_f32 v59, v59
    v_exp_f32 v60, v60
    v_exp_f32 v61, v61
    v_exp_f32 v62, v62
    v_exp_f32 v63, v63
    v_exp_f32 v32, v32
    v_exp_f32 v33, v33
    v_smfmac_f32_32x32x32_bf16 v[80:95], a[52:55], v[56:63], v3
    v_exp_f32 v34, v34
    v_exp_f32 v35, v35
    v_exp_f32 v36, v36
    v_mfma_f32_32x32x16_bf16 v[48:63], a[44:47], a[12:15], 0
    v_exp_f32 v37, v37
    v_exp_f32 v38, v38
    v_exp_f32 v39, v39
    v_exp_f32 v40, v40
    v_exp_f32 v41, v41
    v_smfmac_f32_32x32x32_bf16 v[96:111], a[48:51], v[32:39], v3
    v_exp_f32 v42, v42
    v_exp_f32 v43, v43
    v_exp_f32 v44, v44
    v_exp_f32 v45, v45
    v_exp_f32 v46, v46
    v_exp_f32 v47, v47
    v_exp_f32 v48, v48
    v_exp_f32 v49, v49
    v_smfmac_f32_32x32x32_bf16 v[96:111], a[52:55], v[40:47], v3
    s_add_u32 s84, s84, 16384
    s_addc_u32 s85, s85, 0
    v_exp_f32 v50, v50
    v_exp_f32 v51, v51
    v_exp_f32 v52, v52
    v_mfma_f32_32x32x16_bf16 v[32:47], a[44:47], a[16:19], 0
    s_add_u32 m0, s49, 49152
    v_exp_f32 v53, v53
    v_exp_f32 v54, v54
    v_exp_f32 v55, v55
    v_exp_f32 v56, v56
    v_exp_f32 v57, v57
    v_smfmac_f32_32x32x32_bf16 v[112:127], a[48:51], v[48:55], v3
    global_load_lds_dwordx4 v1, s[84:85] offset:0 sc1
    global_load_lds_dwordx4 v1, s[84:85] offset:1024 sc1
    global_load_lds_dwordx4 v1, s[84:85] offset:2048 sc1
    global_load_lds_dwordx4 v1, s[84:85] offset:3072 sc1
    v_exp_f32 v58, v58
    v_exp_f32 v59, v59
    v_exp_f32 v60, v60
    v_exp_f32 v61, v61
    v_exp_f32 v62, v62
    v_exp_f32 v63, v63
    v_exp_f32 v32, v32
    v_exp_f32 v33, v33
    v_smfmac_f32_32x32x32_bf16 v[112:127], a[52:55], v[56:63], v3
    v_exp_f32 v34, v34
    v_exp_f32 v35, v35
    v_exp_f32 v36, v36
    v_mfma_f32_32x32x16_bf16 v[48:63], a[44:47], a[20:23], 0
    v_exp_f32 v37, v37
    v_exp_f32 v38, v38
    v_exp_f32 v39, v39
    v_exp_f32 v40, v40
    v_exp_f32 v41, v41
    v_smfmac_f32_32x32x32_bf16 v[128:143], a[48:51], v[32:39], v3
    v_exp_f32 v42, v42
    v_exp_f32 v43, v43
    v_exp_f32 v44, v44
    v_exp_f32 v45, v45
    v_exp_f32 v46, v46
    v_exp_f32 v47, v47
    v_exp_f32 v48, v48
    v_exp_f32 v49, v49
    v_smfmac_f32_32x32x32_bf16 v[128:143], a[52:55], v[40:47], v3
    s_add_u32 s84, s4, s51
    s_addc_u32 s85, s5, 0
    v_exp_f32 v50, v50
    v_exp_f32 v51, v51
    v_exp_f32 v52, v52
    v_mfma_f32_32x32x16_bf16 v[32:47], a[44:47], a[24:27], 0
    s_add_u32 m0, s49, 65536
    v_exp_f32 v53, v53
    v_exp_f32 v54, v54
    v_exp_f32 v55, v55
    v_exp_f32 v56, v56
    v_exp_f32 v57, v57
    v_smfmac_f32_32x32x32_bf16 v[144:159], a[48:51], v[48:55], v3
    global_load_lds_dwordx4 v1, s[84:85] offset:0 sc1
    global_load_lds_dwordx4 v1, s[84:85] offset:1024 sc1
    global_load_lds_dwordx4 v1, s[84:85] offset:2048 sc1
    global_load_lds_dwordx4 v1, s[84:85] offset:3072 sc1
    v_exp_f32 v58, v58
    v_exp_f32 v59, v59
    v_exp_f32 v60, v60
    v_exp_f32 v61, v61
    v_exp_f32 v62, v62
    v_exp_f32 v63, v63
    v_exp_f32 v32, v32
    v_exp_f32 v33, v33
    v_smfmac_f32_32x32x32_bf16 v[144:159], a[52:55], v[56:63], v3
    v_exp_f32 v34, v34
    v_exp_f32 v35, v35
    v_exp_f32 v36, v36
    v_mfma_f32_32x32x16_bf16 v[48:63], a[44:47], a[28:31], 0
    v_exp_f32 v37, v37
    v_exp_f32 v38, v38
    v_exp_f32 v39, v39
    v_exp_f32 v40, v40
    v_exp_f32 v41, v41
    v_smfmac_f32_32x32x32_bf16 v[160:175], a[48:51], v[32:39], v3
    v_exp_f32 v42, v42
    v_exp_f32 v43, v43
    v_exp_f32 v44, v44
    v_exp_f32 v45, v45
    v_exp_f32 v46, v46
    v_exp_f32 v47, v47
    v_exp_f32 v48, v48
    v_exp_f32 v49, v49
    v_smfmac_f32_32x32x32_bf16 v[160:175], a[52:55], v[40:47], v3
    s_waitcnt vmcnt(26)
    v_exp_f32 v50, v50
    v_exp_f32 v51, v51
    v_exp_f32 v52, v52
    v_mfma_f32_32x32x16_bf16 v[32:47], a[56:59], a[0:3], 0
    v_exp_f32 v53, v53
    v_exp_f32 v54, v54
    v_exp_f32 v55, v55
    v_exp_f32 v56, v56
    v_exp_f32 v57, v57
    v_smfmac_f32_32x32x32_bf16 v[176:191], a[48:51], v[48:55], v3
    v_exp_f32 v58, v58
    v_exp_f32 v59, v59
    v_exp_f32 v60, v60
    v_exp_f32 v61, v61
    v_exp_f32 v62, v62
    v_exp_f32 v63, v63
    v_exp_f32 v32, v32
    v_exp_f32 v33, v33
    v_smfmac_f32_32x32x32_bf16 v[176:191], a[52:55], v[56:63], v3
    v_exp_f32 v34, v34
    v_exp_f32 v35, v35
    v_exp_f32 v36, v36
    v_mfma_f32_32x32x16_bf16 v[48:63], a[56:59], a[4:7], 0
    v_exp_f32 v37, v37
    v_exp_f32 v38, v38
    v_exp_f32 v39, v39
    v_exp_f32 v40, v40
    v_exp_f32 v41, v41
    v_smfmac_f32_32x32x32_bf16 v[64:79], a[60:63], v[32:39], v3
    v_exp_f32 v42, v42
    v_exp_f32 v43, v43
    v_exp_f32 v44, v44
    v_exp_f32 v45, v45
    v_exp_f32 v46, v46
    v_exp_f32 v47, v47
    v_exp_f32 v48, v48
    v_exp_f32 v49, v49
    v_smfmac_f32_32x32x32_bf16 v[64:79], a[64:67], v[40:47], v3
    s_mov_b64 exec, s[40:41]
    global_load_dwordx4 a[48:51], v7, s[86:87] offset:-1024 sc1
    global_load_dwordx4 a[52:55], v7, s[86:87] offset:-512 sc1
    s_mov_b64 exec, -1
    global_load_dwordx4 a[44:47], v1, s[86:87] offset:-2048 sc1
    v_exp_f32 v50, v50
    v_exp_f32 v51, v51
    v_exp_f32 v52, v52
    v_mfma_f32_32x32x16_bf16 v[32:47], a[56:59], a[8:11], 0
    v_exp_f32 v53, v53
    v_exp_f32 v54, v54
    v_exp_f32 v55, v55
    v_exp_f32 v56, v56
    v_exp_f32 v57, v57
    v_smfmac_f32_32x32x32_bf16 v[80:95], a[60:63], v[48:55], v3
    v_exp_f32 v58, v58
    v_exp_f32 v59, v59
    v_exp_f32 v60, v60
    v_exp_f32 v61, v61
    v_exp_f32 v62, v62
    v_exp_f32 v63, v63
    v_exp_f32 v32, v32
    v_exp_f32 v33, v33
    v_smfmac_f32_32x32x32_bf16 v[80:95], a[64:67], v[56:63], v3
    v_exp_f32 v34, v34
    v_exp_f32 v35, v35
    v_exp_f32 v36, v36
    v_mfma_f32_32x32x16_bf16 v[48:63], a[56:59], a[12:15], 0
    v_exp_f32 v37, v37
    v_exp_f32 v38, v38
    v_exp_f32 v39, v39
    v_exp_f32 v40, v40
    v_exp_f32 v41, v41
    v_smfmac_f32_32x32x32_bf16 v[96:111], a[60:63], v[32:39], v3
    v_exp_f32 v42, v42
    v_exp_f32 v43, v43
    v_exp_f32 v44, v44
    v_exp_f32 v45, v45
    v_exp_f32 v46, v46
    v_exp_f32 v47, v47
    v_exp_f32 v48, v48
    v_exp_f32 v49, v49
    v_smfmac_f32_32x32x32_bf16 v[96:111], a[64:67], v[40:47], v3
    s_add_u32 s84, s84, 16384
    s_addc_u32 s85, s85, 0
    v_exp_f32 v50, v50
    v_exp_f32 v51, v51
    v_exp_f32 v52, v52
    v_mfma_f32_32x32x16_bf16 v[32:47], a[56:59], a[16:19], 0
    s_add_u32 m0, s49, 81920
    v_exp_f32 v53, v53
    v_exp_f32 v54, v54
    v_exp_f32 v55, v55
    v_exp_f32 v56, v56
    v_exp_f32 v57, v57
    v_smfmac_f32_32x32x32_bf16 v[112:127], a[60:63], v[48:55], v3
    global_load_lds_dwordx4 v1, s[84:85] offset:0 sc1
    global_load_lds_dwordx4 v1, s[84:85] offset:1024 sc1
    global_load_lds_dwordx4 v1, s[84:85] offset:2048 sc1
    global_load_lds_dwordx4 v1, s[84:85] offset:3072 sc1
    v_exp_f32 v58, v58
    v_exp_f32 v59, v59
    v_exp_f32 v60, v60
    v_exp_f32 v61, v61
    v_exp_f32 v62, v62
    v_exp_f32 v63, v63
    v_exp_f32 v32, v32
    v_exp_f32 v33, v33
    v_smfmac_f32_32x32x32_bf16 v[112:127], a[64:67], v[56:63], v3
    v_exp_f32 v34, v34
    v_exp_f32 v35, v35
    v_exp_f32 v36, v36
    v_mfma_f32_32x32x16_bf16 v[48:63], a[56:59], a[20:23], 0
    v_exp_f32 v37, v37
    v_exp_f32 v38, v38
    v_exp_f32 v39, v39
    v_exp_f32 v40, v40
    v_exp_f32 v41, v41
    v_smfmac_f32_32x32x32_bf16 v[128:143], a[60:63], v[32:39], v3
    v_exp_f32 v42, v42
    v_exp_f32 v43, v43
    v_exp_f32 v44, v44
    v_exp_f32 v45, v45
    v_exp_f32 v46, v46
    v_exp_f32 v47, v47
    v_exp_f32 v48, v48
    v_exp_f32 v49, v49
    v_smfmac_f32_32x32x32_bf16 v[128:143], a[64:67], v[40:47], v3
    v_exp_f32 v50, v50
    v_exp_f32 v51, v51
    v_exp_f32 v52, v52
    v_mfma_f32_32x32x16_bf16 v[32:47], a[56:59], a[24:27], 0
    v_exp_f32 v53, v53
    v_exp_f32 v54, v54
    v_exp_f32 v55, v55
    v_exp_f32 v56, v56
    v_exp_f32 v57, v57
    v_smfmac_f32_32x32x32_bf16 v[144:159], a[60:63], v[48:55], v3
    v_exp_f32 v58, v58
    v_exp_f32 v59, v59
    v_exp_f32 v60, v60
    v_exp_f32 v61, v61
    v_exp_f32 v62, v62
    v_exp_f32 v63, v63
    v_exp_f32 v32, v32
    v_exp_f32 v33, v33
    v_smfmac_f32_32x32x32_bf16 v[144:159], a[64:67], v[56:63], v3
    v_exp_f32 v34, v34
    v_exp_f32 v35, v35
    v_exp_f32 v36, v36
    v_mfma_f32_32x32x16_bf16 v[48:63], a[56:59], a[28:31], 0
    v_exp_f32 v37, v37
    v_exp_f32 v38, v38
    v_exp_f32 v39, v39
    v_exp_f32 v40, v40
    v_exp_f32 v41, v41
    v_smfmac_f32_32x32x32_bf16 v[160:175], a[60:63], v[32:39], v3
    v_exp_f32 v42, v42
    v_exp_f32 v43, v43
    v_exp_f32 v44, v44
    v_exp_f32 v45, v45
    v_exp_f32 v46, v46
    v_exp_f32 v47, v47
    v_exp_f32 v48, v48
    v_exp_f32 v49, v49
    v_smfmac_f32_32x32x32_bf16 v[160:175], a[64:67], v[40:47], v3
    s_waitcnt vmcnt(30)
    v_exp_f32 v50, v50
    v_exp_f32 v51, v51
    v_exp_f32 v52, v52
    v_mfma_f32_32x32x16_bf16 v[32:47], a[68:71], a[0:3], 0
    v_exp_f32 v53, v53
    v_exp_f32 v54, v54
    v_exp_f32 v55, v55
    v_exp_f32 v56, v56
    v_exp_f32 v57, v57
    v_smfmac_f32_32x32x32_bf16 v[176:191], a[60:63], v[48:55], v3
    v_exp_f32 v58, v58
    v_exp_f32 v59, v59
    v_exp_f32 v60, v60
    v_exp_f32 v61, v61
    v_exp_f32 v62, v62
    v_exp_f32 v63, v63
    v_exp_f32 v32, v32
    v_exp_f32 v33, v33
    v_smfmac_f32_32x32x32_bf16 v[176:191], a[64:67], v[56:63], v3
    v_exp_f32 v34, v34
    v_exp_f32 v35, v35
    v_exp_f32 v36, v36
    v_mfma_f32_32x32x16_bf16 v[48:63], a[68:71], a[4:7], 0
    v_exp_f32 v37, v37
    v_exp_f32 v38, v38
    v_exp_f32 v39, v39
    v_exp_f32 v40, v40
    v_exp_f32 v41, v41
    v_smfmac_f32_32x32x32_bf16 v[64:79], a[72:75], v[32:39], v3
    v_exp_f32 v42, v42
    v_exp_f32 v43, v43
    v_exp_f32 v44, v44
    v_exp_f32 v45, v45
    v_exp_f32 v46, v46
    v_exp_f32 v47, v47
    v_exp_f32 v48, v48
    v_exp_f32 v49, v49
    v_smfmac_f32_32x32x32_bf16 v[64:79], a[76:79], v[40:47], v3
    s_mov_b64 exec, s[40:41]
    global_load_dwordx4 a[60:63], v7, s[86:87] offset:1024 sc1
    global_load_dwordx4 a[64:67], v7, s[86:87] offset:1536 sc1
    s_mov_b64 exec, -1
    global_load_dwordx4 a[56:59], v1, s[86:87] offset:0 sc1
    v_exp_f32 v50, v50
    v_exp_f32 v51, v51
    v_exp_f32 v52, v52
    v_mfma_f32_32x32x16_bf16 v[32:47], a[68:71], a[8:11], 0
    v_exp_f32 v53, v53
    v_exp_f32 v54, v54
    v_exp_f32 v55, v55
    v_exp_f32 v56, v56
    v_exp_f32 v57, v57
    v_smfmac_f32_32x32x32_bf16 v[80:95], a[72:75], v[48:55], v3
    v_exp_f32 v58, v58
    v_exp_f32 v59, v59
    v_exp_f32 v60, v60
    v_exp_f32 v61, v61
    v_exp_f32 v62, v62
    v_exp_f32 v63, v63
    v_exp_f32 v32, v32
    v_exp_f32 v33, v33
    v_smfmac_f32_32x32x32_bf16 v[80:95], a[76:79], v[56:63], v3
    s_add_u32 s84, s84, 16384
    s_addc_u32 s85, s85, 0
    v_exp_f32 v34, v34
    v_exp_f32 v35, v35
    v_exp_f32 v36, v36
    v_mfma_f32_32x32x16_bf16 v[48:63], a[68:71], a[12:15], 0
    v_exp_f32 v37, v37
    v_exp_f32 v38, v38
    v_exp_f32 v39, v39
    v_exp_f32 v40, v40
    v_exp_f32 v41, v41
    v_smfmac_f32_32x32x32_bf16 v[96:111], a[72:75], v[32:39], v3
    global_load_dwordx4 a[80:83], v1, s[84:85] offset:0 sc1
    global_load_dwordx4 a[84:87], v1, s[84:85] offset:1024 sc1
    global_load_dwordx4 a[88:91], v1, s[84:85] offset:2048 sc1
    global_load_dwordx4 a[92:95], v1, s[84:85] offset:3072 sc1
    v_exp_f32 v42, v42
    v_exp_f32 v43, v43
    v_exp_f32 v44, v44
    v_exp_f32 v45, v45
    v_exp_f32 v46, v46
    v_exp_f32 v47, v47
    v_exp_f32 v48, v48
    v_exp_f32 v49, v49
    v_smfmac_f32_32x32x32_bf16 v[96:111], a[76:79], v[40:47], v3
    v_exp_f32 v50, v50
    v_exp_f32 v51, v51
    v_exp_f32 v52, v52
    v_mfma_f32_32x32x16_bf16 v[32:47], a[68:71], a[16:19], 0
    v_exp_f32 v53, v53
    v_exp_f32 v54, v54
    v_exp_f32 v55, v55
    v_exp_f32 v56, v56
    v_exp_f32 v57, v57
    v_smfmac_f32_32x32x32_bf16 v[112:127], a[72:75], v[48:55], v3
    v_exp_f32 v58, v58
    v_exp_f32 v59, v59
    v_exp_f32 v60, v60
    v_exp_f32 v61, v61
    v_exp_f32 v62, v62
    v_exp_f32 v63, v63
    v_exp_f32 v32, v32
    v_exp_f32 v33, v33
    v_smfmac_f32_32x32x32_bf16 v[112:127], a[76:79], v[56:63], v3
    v_exp_f32 v34, v34
    v_exp_f32 v35, v35
    v_exp_f32 v36, v36
    v_mfma_f32_32x32x16_bf16 v[48:63], a[68:71], a[20:23], 0
    v_exp_f32 v37, v37
    v_exp_f32 v38, v38
    v_exp_f32 v39, v39
    v_exp_f32 v40, v40
    v_exp_f32 v41, v41
    v_smfmac_f32_32x32x32_bf16 v[128:143], a[72:75], v[32:39], v3
    v_exp_f32 v42, v42
    v_exp_f32 v43, v43
    v_exp_f32 v44, v44
    v_exp_f32 v45, v45
    v_exp_f32 v46, v46
    v_exp_f32 v47, v47
    v_exp_f32 v48, v48
    v_exp_f32 v49, v49
    v_smfmac_f32_32x32x32_bf16 v[128:143], a[76:79], v[40:47], v3
    s_add_u32 s84, s84, 16384
    s_addc_u32 s85, s85, 0
    v_exp_f32 v50, v50
    v_exp_f32 v51, v51
    v_exp_f32 v52, v52
    v_mfma_f32_32x32x16_bf16 v[32:47], a[68:71], a[24:27], 0
    v_exp_f32 v53, v53
    v_exp_f32 v54, v54
    v_exp_f32 v55, v55
    v_exp_f32 v56, v56
    v_exp_f32 v57, v57
    v_smfmac_f32_32x32x32_bf16 v[144:159], a[72:75], v[48:55], v3
    global_load_dwordx4 a[96:99], v1, s[84:85] offset:0 sc1
    global_load_dwordx4 a[100:103], v1, s[84:85] offset:1024 sc1
    global_load_dwordx4 a[104:107], v1, s[84:85] offset:2048 sc1
    global_load_dwordx4 a[108:111], v1, s[84:85] offset:3072 sc1
    v_exp_f32 v58, v58
    v_exp_f32 v59, v59
    v_exp_f32 v60, v60
    v_exp_f32 v61, v61
    v_exp_f32 v62, v62
    v_exp_f32 v63, v63
    v_exp_f32 v32, v32
    v_exp_f32 v33, v33
    v_smfmac_f32_32x32x32_bf16 v[144:159], a[76:79], v[56:63], v3
    v_exp_f32 v34, v34
    v_exp_f32 v35, v35
    v_exp_f32 v36, v36
    v_mfma_f32_32x32x16_bf16 v[48:63], a[68:71], a[28:31], 0
    v_exp_f32 v37, v37
    v_exp_f32 v38, v38
    v_exp_f32 v39, v39
    v_exp_f32 v40, v40
    v_exp_f32 v41, v41
    v_smfmac_f32_32x32x32_bf16 v[160:175], a[72:75], v[32:39], v3
    v_exp_f32 v42, v42
    v_exp_f32 v43, v43
    v_exp_f32 v44, v44
    v_exp_f32 v45, v45
    v_exp_f32 v46, v46
    v_exp_f32 v47, v47
    v_exp_f32 v48, v48
    v_exp_f32 v49, v49
    v_smfmac_f32_32x32x32_bf16 v[160:175], a[76:79], v[40:47], v3
    s_waitcnt vmcnt(26)
    v_exp_f32 v50, v50
    v_exp_f32 v51, v51
    v_exp_f32 v52, v52
    v_mfma_f32_32x32x16_bf16 v[32:47], a[32:35], a[0:3], 0
    v_exp_f32 v53, v53
    v_exp_f32 v54, v54
    v_exp_f32 v55, v55
    v_exp_f32 v56, v56
    v_exp_f32 v57, v57
    v_smfmac_f32_32x32x32_bf16 v[176:191], a[72:75], v[48:55], v3
    v_exp_f32 v58, v58
    v_exp_f32 v59, v59
    v_exp_f32 v60, v60
    v_exp_f32 v61, v61
    v_exp_f32 v62, v62
    v_exp_f32 v63, v63
    v_exp_f32 v32, v32
    v_exp_f32 v33, v33
    v_smfmac_f32_32x32x32_bf16 v[176:191], a[76:79], v[56:63], v3
    v_exp_f32 v34, v34
    v_exp_f32 v35, v35
    v_exp_f32 v36, v36
    v_mfma_f32_32x32x16_bf16 v[48:63], a[32:35], a[4:7], 0
    v_exp_f32 v37, v37
    v_exp_f32 v38, v38
    v_exp_f32 v39, v39
    v_exp_f32 v40, v40
    v_exp_f32 v41, v41
    v_smfmac_f32_32x32x32_bf16 v[64:79], a[36:39], v[32:39], v3
    v_exp_f32 v42, v42
    v_exp_f32 v43, v43
    v_exp_f32 v44, v44
    v_exp_f32 v45, v45
    v_exp_f32 v46, v46
    v_exp_f32 v47, v47
    v_exp_f32 v48, v48
    v_exp_f32 v49, v49
    v_smfmac_f32_32x32x32_bf16 v[64:79], a[40:43], v[40:47], v3
    s_mov_b64 exec, s[40:41]
    global_load_dwordx4 a[72:75], v7, s[86:87] offset:3072 sc1
    global_load_dwordx4 a[76:79], v7, s[86:87] offset:3584 sc1
    s_mov_b64 exec, -1
    global_load_dwordx4 a[68:71], v1, s[86:87] offset:2048 sc1
    v_exp_f32 v50, v50
    v_exp_f32 v51, v51
    v_exp_f32 v52, v52
    v_mfma_f32_32x32x16_bf16 v[32:47], a[32:35], a[8:11], 0
    v_exp_f32 v53, v53
    v_exp_f32 v54, v54
    v_exp_f32 v55, v55
    v_exp_f32 v56, v56
    v_exp_f32 v57, v57
    v_smfmac_f32_32x32x32_bf16 v[80:95], a[36:39], v[48:55], v3
    s_add_u32 s86, s86, 8192
    s_addc_u32 s87, s87, 0
    v_exp_f32 v58, v58
    v_exp_f32 v59, v59
    v_exp_f32 v60, v60
    v_exp_f32 v61, v61
    v_exp_f32 v62, v62
    v_exp_f32 v63, v63
    v_exp_f32 v32, v32
    v_exp_f32 v33, v33
    v_smfmac_f32_32x32x32_bf16 v[80:95], a[40:43], v[56:63], v3
    v_exp_f32 v34, v34
    v_exp_f32 v35, v35
    v_exp_f32 v36, v36
    v_mfma_f32_32x32x16_bf16 v[48:63], a[32:35], a[12:15], 0
    v_exp_f32 v37, v37
    v_exp_f32 v38, v38
    v_exp_f32 v39, v39
    v_exp_f32 v40, v40
    v_exp_f32 v41, v41
    v_smfmac_f32_32x32x32_bf16 v[96:111], a[36:39], v[32:39], v3
    v_exp_f32 v42, v42
    v_exp_f32 v43, v43
    v_exp_f32 v44, v44
    v_exp_f32 v45, v45
    v_exp_f32 v46, v46
    v_exp_f32 v47, v47
    v_exp_f32 v48, v48
    v_exp_f32 v49, v49
    v_smfmac_f32_32x32x32_bf16 v[96:111], a[40:43], v[40:47], v3
    v_exp_f32 v50, v50
    v_exp_f32 v51, v51
    v_exp_f32 v52, v52
    v_mfma_f32_32x32x16_bf16 v[32:47], a[32:35], a[16:19], 0
    v_exp_f32 v53, v53
    v_exp_f32 v54, v54
    v_exp_f32 v55, v55
    v_exp_f32 v56, v56
    v_exp_f32 v57, v57
    v_smfmac_f32_32x32x32_bf16 v[112:127], a[36:39], v[48:55], v3
    v_exp_f32 v58, v58
    v_exp_f32 v59, v59
    v_exp_f32 v60, v60
    v_exp_f32 v61, v61
    v_exp_f32 v62, v62
    v_exp_f32 v63, v63
    v_exp_f32 v32, v32
    v_exp_f32 v33, v33
    v_smfmac_f32_32x32x32_bf16 v[112:127], a[40:43], v[56:63], v3
    s_add_u32 s84, s84, 16384
    s_addc_u32 s85, s85, 0
    v_exp_f32 v34, v34
    v_exp_f32 v35, v35
    v_exp_f32 v36, v36
    v_mfma_f32_32x32x16_bf16 v[48:63], a[32:35], a[20:23], 0
    v_exp_f32 v37, v37
    v_exp_f32 v38, v38
    v_exp_f32 v39, v39
    v_exp_f32 v40, v40
    v_exp_f32 v41, v41
    v_smfmac_f32_32x32x32_bf16 v[128:143], a[36:39], v[32:39], v3
    global_load_dwordx4 a[112:115], v1, s[84:85] offset:0 sc1
    global_load_dwordx4 a[116:119], v1, s[84:85] offset:1024 sc1
    global_load_dwordx4 a[120:123], v1, s[84:85] offset:2048 sc1
    global_load_dwordx4 a[124:127], v1, s[84:85] offset:3072 sc1
    v_exp_f32 v42, v42
    v_exp_f32 v43, v43
    v_exp_f32 v44, v44
    v_exp_f32 v45, v45
    v_exp_f32 v46, v46
    v_exp_f32 v47, v47
    v_exp_f32 v48, v48
    v_exp_f32 v49, v49
    v_smfmac_f32_32x32x32_bf16 v[128:143], a[40:43], v[40:47], v3
    v_exp_f32 v50, v50
    v_exp_f32 v51, v51
    v_exp_f32 v52, v52
    v_mfma_f32_32x32x16_bf16 v[32:47], a[32:35], a[24:27], 0
    v_exp_f32 v53, v53
    v_exp_f32 v54, v54
    v_exp_f32 v55, v55
    v_exp_f32 v56, v56
    v_exp_f32 v57, v57
    v_smfmac_f32_32x32x32_bf16 v[144:159], a[36:39], v[48:55], v3
    v_exp_f32 v58, v58
    v_exp_f32 v59, v59
    v_exp_f32 v60, v60
    v_exp_f32 v61, v61
    v_exp_f32 v62, v62
    v_exp_f32 v63, v63
    v_exp_f32 v32, v32
    v_exp_f32 v33, v33
    v_smfmac_f32_32x32x32_bf16 v[144:159], a[40:43], v[56:63], v3
    v_exp_f32 v34, v34
    v_exp_f32 v35, v35
    v_exp_f32 v36, v36
    v_mfma_f32_32x32x16_bf16 v[48:63], a[32:35], a[28:31], 0
    v_exp_f32 v37, v37
    v_exp_f32 v38, v38
    v_exp_f32 v39, v39
    v_exp_f32 v40, v40
    v_exp_f32 v41, v41
    v_smfmac_f32_32x32x32_bf16 v[160:175], a[36:39], v[32:39], v3
    v_exp_f32 v42, v42
    v_exp_f32 v43, v43
    v_exp_f32 v44, v44
    v_exp_f32 v45, v45
    v_exp_f32 v46, v46
    v_exp_f32 v47, v47
    v_exp_f32 v48, v48
    v_exp_f32 v49, v49
    v_smfmac_f32_32x32x32_bf16 v[160:175], a[40:43], v[40:47], v3
    s_waitcnt vmcnt(22)
    v_exp_f32 v50, v50
    v_exp_f32 v51, v51
    v_exp_f32 v52, v52
    v_mfma_f32_32x32x16_bf16 v[32:47], a[44:47], a[0:3], 0
    v_exp_f32 v53, v53
    v_exp_f32 v54, v54
    v_exp_f32 v55, v55
    v_exp_f32 v56, v56
    v_exp_f32 v57, v57
    v_smfmac_f32_32x32x32_bf16 v[176:191], a[36:39], v[48:55], v3
    v_exp_f32 v58, v58
    v_exp_f32 v59, v59
    v_exp_f32 v60, v60
    v_exp_f32 v61, v61
    v_exp_f32 v62, v62
    v_exp_f32 v63, v63
    v_exp_f32 v32, v32
    v_exp_f32 v33, v33
    v_smfmac_f32_32x32x32_bf16 v[176:191], a[40:43], v[56:63], v3
    v_exp_f32 v34, v34
    v_exp_f32 v35, v35
    v_exp_f32 v36, v36
    v_mfma_f32_32x32x16_bf16 v[48:63], a[44:47], a[4:7], 0
    v_exp_f32 v37, v37
    v_exp_f32 v38, v38
    v_exp_f32 v39, v39
    v_exp_f32 v40, v40
    v_exp_f32 v41, v41
    v_smfmac_f32_32x32x32_bf16 v[64:79], a[48:51], v[32:39], v3
    v_exp_f32 v42, v42
    v_exp_f32 v43, v43
    v_exp_f32 v44, v44
    v_exp_f32 v45, v45
    v_exp_f32 v46, v46
    v_exp_f32 v47, v47
    v_exp_f32 v48, v48
    v_exp_f32 v49, v49
    v_smfmac_f32_32x32x32_bf16 v[64:79], a[52:55], v[40:47], v3
    s_mov_b64 exec, s[40:41]
    global_load_dwordx4 a[36:39], v7, s[86:87] offset:-3072 sc1
    global_load_dwordx4 a[40:43], v7, s[86:87] offset:-2560 sc1
    s_mov_b64 exec, -1
    global_load_dwordx4 a[32:35], v1, s[86:87] offset:-4096 sc1
    v_exp_f32 v50, v50
    v_exp_f32 v51, v51
    v_exp_f32 v52, v52
    v_mfma_f32_32x32x16_bf16 v[32:47], a[44:47], a[8:11], 0
    v_exp_f32 v53, v53
    v_exp_f32 v54, v54
    v_exp_f32 v55, v55
    v_exp_f32 v56, v56
    v_exp_f32 v57, v57
    v_smfmac_f32_32x32x32_bf16 v[80:95], a[48:51], v[48:55], v3
    v_exp_f32 v58, v58
    v_exp_f32 v59, v59
    v_exp_f32 v60, v60
    v_exp_f32 v61, v61
    v_exp_f32 v62, v62
    v_exp_f32 v63, v63
    v_exp_f32 v32, v32
    v_exp_f32 v33, v33
    v_smfmac_f32_32x32x32_bf16 v[80:95], a[52:55], v[56:63], v3
    s_add_u32 s84, s84, 16384
    s_addc_u32 s85, s85, 0
    v_exp_f32 v34, v34
    v_exp_f32 v35, v35
    v_exp_f32 v36, v36
    v_mfma_f32_32x32x16_bf16 v[48:63], a[44:47], a[12:15], 0
    v_exp_f32 v37, v37
    v_exp_f32 v38, v38
    v_exp_f32 v39, v39
    v_exp_f32 v40, v40
    v_exp_f32 v41, v41
    v_smfmac_f32_32x32x32_bf16 v[96:111], a[48:51], v[32:39], v3
    global_load_dwordx4 a[128:131], v1, s[84:85] offset:0 sc1
    global_load_dwordx4 a[132:135], v1, s[84:85] offset:1024 sc1
    global_load_dwordx4 a[136:139], v1, s[84:85] offset:2048 sc1
    global_load_dwordx4 a[140:143], v1, s[84:85] offset:3072 sc1
    v_exp_f32 v42, v42
    v_exp_f32 v43, v43
    v_exp_f32 v44, v44
    v_exp_f32 v45, v45
    v_exp_f32 v46, v46
    v_exp_f32 v47, v47
    v_exp_f32 v48, v48
    v_exp_f32 v49, v49
    v_smfmac_f32_32x32x32_bf16 v[96:111], a[52:55], v[40:47], v3
    v_exp_f32 v50, v50
    v_exp_f32 v51, v51
    v_exp_f32 v52, v52
    v_mfma_f32_32x32x16_bf16 v[32:47], a[44:47], a[16:19], 0
    v_exp_f32 v53, v53
    v_exp_f32 v54, v54
    v_exp_f32 v55, v55
    v_exp_f32 v56, v56
    v_exp_f32 v57, v57
    v_smfmac_f32_32x32x32_bf16 v[112:127], a[48:51], v[48:55], v3
    v_exp_f32 v58, v58
    v_exp_f32 v59, v59
    v_exp_f32 v60, v60
    v_exp_f32 v61, v61
    v_exp_f32 v62, v62
    v_exp_f32 v63, v63
    v_exp_f32 v32, v32
    v_exp_f32 v33, v33
    v_smfmac_f32_32x32x32_bf16 v[112:127], a[52:55], v[56:63], v3
    v_exp_f32 v34, v34
    v_exp_f32 v35, v35
    v_exp_f32 v36, v36
    v_mfma_f32_32x32x16_bf16 v[48:63], a[44:47], a[20:23], 0
    v_exp_f32 v37, v37
    v_exp_f32 v38, v38
    v_exp_f32 v39, v39
    v_exp_f32 v40, v40
    v_exp_f32 v41, v41
    v_smfmac_f32_32x32x32_bf16 v[128:143], a[48:51], v[32:39], v3
    v_exp_f32 v42, v42
    v_exp_f32 v43, v43
    v_exp_f32 v44, v44
    v_exp_f32 v45, v45
    v_exp_f32 v46, v46
    v_exp_f32 v47, v47
    v_exp_f32 v48, v48
    v_exp_f32 v49, v49
    v_smfmac_f32_32x32x32_bf16 v[128:143], a[52:55], v[40:47], v3
    v_exp_f32 v50, v50
    v_exp_f32 v51, v51
    v_exp_f32 v52, v52
    v_mfma_f32_32x32x16_bf16 v[32:47], a[44:47], a[24:27], 0
    v_exp_f32 v53, v53
    v_exp_f32 v54, v54
    v_exp_f32 v55, v55
    v_exp_f32 v56, v56
    v_exp_f32 v57, v57
    v_smfmac_f32_32x32x32_bf16 v[144:159], a[48:51], v[48:55], v3
    v_exp_f32 v58, v58
    v_exp_f32 v59, v59
    v_exp_f32 v60, v60
    v_exp_f32 v61, v61
    v_exp_f32 v62, v62
    v_exp_f32 v63, v63
    v_exp_f32 v32, v32
    v_exp_f32 v33, v33
    v_smfmac_f32_32x32x32_bf16 v[144:159], a[52:55], v[56:63], v3
    s_add_u32 s84, s84, 16384
    s_addc_u32 s85, s85, 0
    v_exp_f32 v34, v34
    v_exp_f32 v35, v35
    v_exp_f32 v36, v36
    v_mfma_f32_32x32x16_bf16 v[48:63], a[44:47], a[28:31], 0
    v_exp_f32 v37, v37
    v_exp_f32 v38, v38
    v_exp_f32 v39, v39
    v_exp_f32 v40, v40
    v_exp_f32 v41, v41
    v_smfmac_f32_32x32x32_bf16 v[160:175], a[48:51], v[32:39], v3
    global_load_dwordx4 a[144:147], v1, s[84:85] offset:0 sc1
    global_load_dwordx4 a[148:151], v1, s[84:85] offset:1024 sc1
    global_load_dwordx4 a[152:155], v1, s[84:85] offset:2048 sc1
    global_load_dwordx4 a[156:159], v1, s[84:85] offset:3072 sc1
    v_exp_f32 v42, v42
    v_exp_f32 v43, v43
    v_exp_f32 v44, v44
    v_exp_f32 v45, v45
    v_exp_f32 v46, v46
    v_exp_f32 v47, v47
    v_exp_f32 v48, v48
    v_exp_f32 v49, v49
    v_smfmac_f32_32x32x32_bf16 v[160:175], a[52:55], v[40:47], v3
    s_waitcnt vmcnt(26)
    v_exp_f32 v50, v50
    v_exp_f32 v51, v51
    v_exp_f32 v52, v52
    v_mfma_f32_32x32x16_bf16 v[32:47], a[56:59], a[0:3], 0
    v_exp_f32 v53, v53
    v_exp_f32 v54, v54
    v_exp_f32 v55, v55
    v_exp_f32 v56, v56
    v_exp_f32 v57, v57
    v_smfmac_f32_32x32x32_bf16 v[176:191], a[48:51], v[48:55], v3
    v_exp_f32 v58, v58
    v_exp_f32 v59, v59
    v_exp_f32 v60, v60
    v_exp_f32 v61, v61
    v_exp_f32 v62, v62
    v_exp_f32 v63, v63
    v_exp_f32 v32, v32
    v_exp_f32 v33, v33
    v_smfmac_f32_32x32x32_bf16 v[176:191], a[52:55], v[56:63], v3
    v_exp_f32 v34, v34
    v_exp_f32 v35, v35
    v_exp_f32 v36, v36
    v_mfma_f32_32x32x16_bf16 v[48:63], a[56:59], a[4:7], 0
    v_exp_f32 v37, v37
    v_exp_f32 v38, v38
    v_exp_f32 v39, v39
    v_exp_f32 v40, v40
    v_exp_f32 v41, v41
    v_smfmac_f32_32x32x32_bf16 v[64:79], a[60:63], v[32:39], v3
    v_exp_f32 v42, v42
    v_exp_f32 v43, v43
    v_exp_f32 v44, v44
    v_exp_f32 v45, v45
    v_exp_f32 v46, v46
    v_exp_f32 v47, v47
    v_exp_f32 v48, v48
    v_exp_f32 v49, v49
    v_smfmac_f32_32x32x32_bf16 v[64:79], a[64:67], v[40:47], v3
    s_mov_b64 exec, s[40:41]
    global_load_dwordx4 a[48:51], v7, s[86:87] offset:-1024 sc1
    global_load_dwordx4 a[52:55], v7, s[86:87] offset:-512 sc1
    s_mov_b64 exec, -1
    global_load_dwordx4 a[44:47], v1, s[86:87] offset:-2048 sc1
    v_exp_f32 v50, v50
    v_exp_f32 v51, v51
    v_exp_f32 v52, v52
    v_mfma_f32_32x32x16_bf16 v[32:47], a[56:59], a[8:11], 0
    v_exp_f32 v53, v53
    v_exp_f32 v54, v54
    v_exp_f32 v55, v55
    v_exp_f32 v56, v56
    v_exp_f32 v57, v57
    v_smfmac_f32_32x32x32_bf16 v[80:95], a[60:63], v[48:55], v3
    v_exp_f32 v58, v58
    v_exp_f32 v59, v59
    v_exp_f32 v60, v60
    v_exp_f32 v61, v61
    v_exp_f32 v62, v62
    v_exp_f32 v63, v63
    v_exp_f32 v32, v32
    v_exp_f32 v33, v33
    v_smfmac_f32_32x32x32_bf16 v[80:95], a[64:67], v[56:63], v3
    v_exp_f32 v34, v34
    v_exp_f32 v35, v35
    v_exp_f32 v36, v36
    v_mfma_f32_32x32x16_bf16 v[48:63], a[56:59], a[12:15], 0
    v_exp_f32 v37, v37
    v_exp_f32 v38, v38
    v_exp_f32 v39, v39
    v_exp_f32 v40, v40
    v_exp_f32 v41, v41
    v_smfmac_f32_32x32x32_bf16 v[96:111], a[60:63], v[32:39], v3
    v_exp_f32 v42, v42
    v_exp_f32 v43, v43
    v_exp_f32 v44, v44
    v_exp_f32 v45, v45
    v_exp_f32 v46, v46
    v_exp_f32 v47, v47
    v_exp_f32 v48, v48
    v_exp_f32 v49, v49
    v_smfmac_f32_32x32x32_bf16 v[96:111], a[64:67], v[40:47], v3
    v_exp_f32 v50, v50
    v_exp_f32 v51, v51
    v_exp_f32 v52, v52
    v_mfma_f32_32x32x16_bf16 v[32:47], a[56:59], a[16:19], 0
    v_exp_f32 v53, v53
    v_exp_f32 v54, v54
    v_exp_f32 v55, v55
    v_exp_f32 v56, v56
    v_exp_f32 v57, v57
    v_smfmac_f32_32x32x32_bf16 v[112:127], a[60:63], v[48:55], v3
    v_exp_f32 v58, v58
    v_exp_f32 v59, v59
    v_exp_f32 v60, v60
    v_exp_f32 v61, v61
    v_exp_f32 v62, v62
    v_exp_f32 v63, v63
    v_exp_f32 v32, v32
    v_exp_f32 v33, v33
    v_smfmac_f32_32x32x32_bf16 v[112:127], a[64:67], v[56:63], v3
    s_add_u32 s84, s84, 16384
    s_addc_u32 s85, s85, 0
    v_exp_f32 v34, v34
    v_exp_f32 v35, v35
    v_exp_f32 v36, v36
    v_mfma_f32_32x32x16_bf16 v[48:63], a[56:59], a[20:23], 0
    v_exp_f32 v37, v37
    v_exp_f32 v38, v38
    v_exp_f32 v39, v39
    v_exp_f32 v40, v40
    v_exp_f32 v41, v41
    v_smfmac_f32_32x32x32_bf16 v[128:143], a[60:63], v[32:39], v3
    global_load_dwordx4 a[160:163], v1, s[84:85] offset:0 sc1
    global_load_dwordx4 a[164:167], v1, s[84:85] offset:1024 sc1
    global_load_dwordx4 a[168:171], v1, s[84:85] offset:2048 sc1
    global_load_dwordx4 a[172:175], v1, s[84:85] offset:3072 sc1
    v_exp_f32 v42, v42
    v_exp_f32 v43, v43
    v_exp_f32 v44, v44
    v_exp_f32 v45, v45
    v_exp_f32 v46, v46
    v_exp_f32 v47, v47
    v_exp_f32 v48, v48
    v_exp_f32 v49, v49
    v_smfmac_f32_32x32x32_bf16 v[128:143], a[64:67], v[40:47], v3
    v_exp_f32 v50, v50
    v_exp_f32 v51, v51
    v_exp_f32 v52, v52
    v_mfma_f32_32x32x16_bf16 v[32:47], a[56:59], a[24:27], 0
    v_exp_f32 v53, v53
    v_exp_f32 v54, v54
    v_exp_f32 v55, v55
    v_exp_f32 v56, v56
    v_exp_f32 v57, v57
    v_smfmac_f32_32x32x32_bf16 v[144:159], a[60:63], v[48:55], v3
    v_exp_f32 v58, v58
    v_exp_f32 v59, v59
    v_exp_f32 v60, v60
    v_exp_f32 v61, v61
    v_exp_f32 v62, v62
    v_exp_f32 v63, v63
    v_exp_f32 v32, v32
    v_exp_f32 v33, v33
    v_smfmac_f32_32x32x32_bf16 v[144:159], a[64:67], v[56:63], v3
    v_exp_f32 v34, v34
    v_exp_f32 v35, v35
    v_exp_f32 v36, v36
    v_mfma_f32_32x32x16_bf16 v[48:63], a[56:59], a[28:31], 0
    v_exp_f32 v37, v37
    v_exp_f32 v38, v38
    v_exp_f32 v39, v39
    v_exp_f32 v40, v40
    v_exp_f32 v41, v41
    v_smfmac_f32_32x32x32_bf16 v[160:175], a[60:63], v[32:39], v3
    v_exp_f32 v42, v42
    v_exp_f32 v43, v43
    v_exp_f32 v44, v44
    v_exp_f32 v45, v45
    v_exp_f32 v46, v46
    v_exp_f32 v47, v47
    v_exp_f32 v48, v48
    v_exp_f32 v49, v49
    v_smfmac_f32_32x32x32_bf16 v[160:175], a[64:67], v[40:47], v3
    s_waitcnt vmcnt(22)
    v_exp_f32 v50, v50
    v_exp_f32 v51, v51
    v_exp_f32 v52, v52
    v_mfma_f32_32x32x16_bf16 v[32:47], a[68:71], a[0:3], 0
    v_exp_f32 v53, v53
    v_exp_f32 v54, v54
    v_exp_f32 v55, v55
    v_exp_f32 v56, v56
    v_exp_f32 v57, v57
    v_smfmac_f32_32x32x32_bf16 v[176:191], a[60:63], v[48:55], v3
    v_exp_f32 v58, v58
    v_exp_f32 v59, v59
    v_exp_f32 v60, v60
    v_exp_f32 v61, v61
    v_exp_f32 v62, v62
    v_exp_f32 v63, v63
    v_exp_f32 v32, v32
    v_exp_f32 v33, v33
    v_smfmac_f32_32x32x32_bf16 v[176:191], a[64:67], v[56:63], v3
    v_exp_f32 v34, v34
    v_exp_f32 v35, v35
    v_exp_f32 v36, v36
    v_mfma_f32_32x32x16_bf16 v[48:63], a[68:71], a[4:7], 0
    v_exp_f32 v37, v37
    v_exp_f32 v38, v38
    v_exp_f32 v39, v39
    v_exp_f32 v40, v40
    v_exp_f32 v41, v41
    v_smfmac_f32_32x32x32_bf16 v[64:79], a[72:75], v[32:39], v3
    v_exp_f32 v42, v42
    v_exp_f32 v43, v43
    v_exp_f32 v44, v44
    v_exp_f32 v45, v45
    v_exp_f32 v46, v46
    v_exp_f32 v47, v47
    v_exp_f32 v48, v48
    v_exp_f32 v49, v49
    v_smfmac_f32_32x32x32_bf16 v[64:79], a[76:79], v[40:47], v3
    s_mov_b64 exec, s[40:41]
    global_load_dwordx4 a[60:63], v7, s[86:87] offset:1024 sc1
    global_load_dwordx4 a[64:67], v7, s[86:87] offset:1536 sc1
    s_mov_b64 exec, -1
    global_load_dwordx4 a[56:59], v1, s[86:87] offset:0 sc1
    v_exp_f32 v50, v50
    v_exp_f32 v51, v51
    v_exp_f32 v52, v52
    v_mfma_f32_32x32x16_bf16 v[32:47], a[68:71], a[8:11], 0
    v_exp_f32 v53, v53
    v_exp_f32 v54, v54
    v_exp_f32 v55, v55
    v_exp_f32 v56, v56
    v_exp_f32 v57, v57
    v_smfmac_f32_32x32x32_bf16 v[80:95], a[72:75], v[48:55], v3
    v_exp_f32 v58, v58
    v_exp_f32 v59, v59
    v_exp_f32 v60, v60
    v_exp_f32 v61, v61
    v_exp_f32 v62, v62
    v_exp_f32 v63, v63
    v_exp_f32 v32, v32
    v_exp_f32 v33, v33
    v_smfmac_f32_32x32x32_bf16 v[80:95], a[76:79], v[56:63], v3
    v_exp_f32 v34, v34
    v_exp_f32 v35, v35
    v_exp_f32 v36, v36
    v_mfma_f32_32x32x16_bf16 v[48:63], a[68:71], a[12:15], 0
    v_exp_f32 v37, v37
    v_exp_f32 v38, v38
    v_exp_f32 v39, v39
    v_exp_f32 v40, v40
    v_exp_f32 v41, v41
    v_smfmac_f32_32x32x32_bf16 v[96:111], a[72:75], v[32:39], v3
    v_exp_f32 v42, v42
    v_exp_f32 v43, v43
    v_exp_f32 v44, v44
    v_exp_f32 v45, v45
    v_exp_f32 v46, v46
    v_exp_f32 v47, v47
    v_exp_f32 v48, v48
    v_exp_f32 v49, v49
    v_smfmac_f32_32x32x32_bf16 v[96:111], a[76:79], v[40:47], v3
    s_add_u32 s84, s84, 16384
    s_addc_u32 s85, s85, 0
    v_exp_f32 v50, v50
    v_exp_f32 v51, v51
    v_exp_f32 v52, v52
    v_mfma_f32_32x32x16_bf16 v[32:47], a[68:71], a[16:19], 0
    v_exp_f32 v53, v53
    v_exp_f32 v54, v54
    v_exp_f32 v55, v55
    v_exp_f32 v56, v56
    v_exp_f32 v57, v57
    v_smfmac_f32_32x32x32_bf16 v[112:127], a[72:75], v[48:55], v3
    global_load_dwordx4 a[176:179], v1, s[84:85] offset:0 sc1
    global_load_dwordx4 a[180:183], v1, s[84:85] offset:1024 sc1
    global_load_dwordx4 a[184:187], v1, s[84:85] offset:2048 sc1
    global_load_dwordx4 a[188:191], v1, s[84:85] offset:3072 sc1
    v_exp_f32 v58, v58
    v_exp_f32 v59, v59
    v_exp_f32 v60, v60
    v_exp_f32 v61, v61
    v_exp_f32 v62, v62
    v_exp_f32 v63, v63
    v_exp_f32 v32, v32
    v_exp_f32 v33, v33
    v_smfmac_f32_32x32x32_bf16 v[112:127], a[76:79], v[56:63], v3
    v_exp_f32 v34, v34
    v_exp_f32 v35, v35
    v_exp_f32 v36, v36
    v_mfma_f32_32x32x16_bf16 v[48:63], a[68:71], a[20:23], 0
    v_exp_f32 v37, v37
    v_exp_f32 v38, v38
    v_exp_f32 v39, v39
    v_exp_f32 v40, v40
    v_exp_f32 v41, v41
    v_smfmac_f32_32x32x32_bf16 v[128:143], a[72:75], v[32:39], v3
    v_exp_f32 v42, v42
    v_exp_f32 v43, v43
    v_exp_f32 v44, v44
    v_exp_f32 v45, v45
    v_exp_f32 v46, v46
    v_exp_f32 v47, v47
    v_exp_f32 v48, v48
    v_exp_f32 v49, v49
    v_smfmac_f32_32x32x32_bf16 v[128:143], a[76:79], v[40:47], v3
    v_exp_f32 v50, v50
    v_exp_f32 v51, v51
    v_exp_f32 v52, v52
    v_mfma_f32_32x32x16_bf16 v[32:47], a[68:71], a[24:27], 0
    v_exp_f32 v53, v53
    v_exp_f32 v54, v54
    v_exp_f32 v55, v55
    v_exp_f32 v56, v56
    v_exp_f32 v57, v57
    v_smfmac_f32_32x32x32_bf16 v[144:159], a[72:75], v[48:55], v3
    v_exp_f32 v58, v58
    v_exp_f32 v59, v59
    v_exp_f32 v60, v60
    v_exp_f32 v61, v61
    v_exp_f32 v62, v62
    v_exp_f32 v63, v63
    v_exp_f32 v32, v32
    v_exp_f32 v33, v33
    v_smfmac_f32_32x32x32_bf16 v[144:159], a[76:79], v[56:63], v3
    s_add_u32 s84, s84, 16384
    s_addc_u32 s85, s85, 0
    v_exp_f32 v34, v34
    v_exp_f32 v35, v35
    v_exp_f32 v36, v36
    v_mfma_f32_32x32x16_bf16 v[48:63], a[68:71], a[28:31], 0
    v_exp_f32 v37, v37
    v_exp_f32 v38, v38
    v_exp_f32 v39, v39
    v_exp_f32 v40, v40
    v_exp_f32 v41, v41
    v_smfmac_f32_32x32x32_bf16 v[160:175], a[72:75], v[32:39], v3
    global_load_dwordx4 a[192:195], v1, s[84:85] offset:0 sc1
    global_load_dwordx4 a[196:199], v1, s[84:85] offset:1024 sc1
    global_load_dwordx4 a[200:203], v1, s[84:85] offset:2048 sc1
    global_load_dwordx4 a[204:207], v1, s[84:85] offset:3072 sc1
    v_exp_f32 v42, v42
    v_exp_f32 v43, v43
    v_exp_f32 v44, v44
    v_exp_f32 v45, v45
    v_exp_f32 v46, v46
    v_exp_f32 v47, v47
    v_exp_f32 v48, v48
    v_exp_f32 v49, v49
    v_smfmac_f32_32x32x32_bf16 v[160:175], a[76:79], v[40:47], v3
    s_waitcnt vmcnt(26)
    v_exp_f32 v50, v50
    v_exp_f32 v51, v51
    v_exp_f32 v52, v52
    v_mfma_f32_32x32x16_bf16 v[32:47], a[32:35], a[0:3], 0
    v_exp_f32 v53, v53
    v_exp_f32 v54, v54
    v_exp_f32 v55, v55
    v_exp_f32 v56, v56
    v_exp_f32 v57, v57
    v_smfmac_f32_32x32x32_bf16 v[176:191], a[72:75], v[48:55], v3
    v_exp_f32 v58, v58
    v_exp_f32 v59, v59
    v_exp_f32 v60, v60
    v_exp_f32 v61, v61
    v_exp_f32 v62, v62
    v_exp_f32 v63, v63
    v_exp_f32 v32, v32
    v_exp_f32 v33, v33
    v_smfmac_f32_32x32x32_bf16 v[176:191], a[76:79], v[56:63], v3
    v_exp_f32 v34, v34
    v_exp_f32 v35, v35
    v_exp_f32 v36, v36
    v_mfma_f32_32x32x16_bf16 v[48:63], a[32:35], a[4:7], 0
    v_exp_f32 v37, v37
    v_exp_f32 v38, v38
    v_exp_f32 v39, v39
    v_exp_f32 v40, v40
    v_exp_f32 v41, v41
    v_smfmac_f32_32x32x32_bf16 v[64:79], a[36:39], v[32:39], v3
    v_exp_f32 v42, v42
    v_exp_f32 v43, v43
    v_exp_f32 v44, v44
    v_exp_f32 v45, v45
    v_exp_f32 v46, v46
    v_exp_f32 v47, v47
    v_exp_f32 v48, v48
    v_exp_f32 v49, v49
    v_smfmac_f32_32x32x32_bf16 v[64:79], a[40:43], v[40:47], v3
    s_mov_b64 exec, s[40:41]
    global_load_dwordx4 a[72:75], v7, s[86:87] offset:3072 sc1
    global_load_dwordx4 a[76:79], v7, s[86:87] offset:3584 sc1
    s_mov_b64 exec, -1
    global_load_dwordx4 a[68:71], v1, s[86:87] offset:2048 sc1
    v_exp_f32 v50, v50
    v_exp_f32 v51, v51
    v_exp_f32 v52, v52
    v_mfma_f32_32x32x16_bf16 v[32:47], a[32:35], a[8:11], 0
    v_exp_f32 v53, v53
    v_exp_f32 v54, v54
    v_exp_f32 v55, v55
    v_exp_f32 v56, v56
    v_exp_f32 v57, v57
    v_smfmac_f32_32x32x32_bf16 v[80:95], a[36:39], v[48:55], v3
    s_add_u32 s86, s86, 8192
    s_addc_u32 s87, s87, 0
    v_exp_f32 v58, v58
    v_exp_f32 v59, v59
    v_exp_f32 v60, v60
    v_exp_f32 v61, v61
    v_exp_f32 v62, v62
    v_exp_f32 v63, v63
    v_exp_f32 v32, v32
    v_exp_f32 v33, v33
    v_smfmac_f32_32x32x32_bf16 v[80:95], a[40:43], v[56:63], v3
    v_exp_f32 v34, v34
    v_exp_f32 v35, v35
    v_exp_f32 v36, v36
    v_mfma_f32_32x32x16_bf16 v[48:63], a[32:35], a[12:15], 0
    v_exp_f32 v37, v37
    v_exp_f32 v38, v38
    v_exp_f32 v39, v39
    v_exp_f32 v40, v40
    v_exp_f32 v41, v41
    v_smfmac_f32_32x32x32_bf16 v[96:111], a[36:39], v[32:39], v3
    v_exp_f32 v42, v42
    v_exp_f32 v43, v43
    v_exp_f32 v44, v44
    v_exp_f32 v45, v45
    v_exp_f32 v46, v46
    v_exp_f32 v47, v47
    v_exp_f32 v48, v48
    v_exp_f32 v49, v49
    v_smfmac_f32_32x32x32_bf16 v[96:111], a[40:43], v[40:47], v3
    v_exp_f32 v50, v50
    v_exp_f32 v51, v51
    v_exp_f32 v52, v52
    v_mfma_f32_32x32x16_bf16 v[32:47], a[32:35], a[16:19], 0
    v_exp_f32 v53, v53
    v_exp_f32 v54, v54
    v_exp_f32 v55, v55
    v_exp_f32 v56, v56
    v_exp_f32 v57, v57
    v_smfmac_f32_32x32x32_bf16 v[112:127], a[36:39], v[48:55], v3
    v_exp_f32 v58, v58
    v_exp_f32 v59, v59
    v_exp_f32 v60, v60
    v_exp_f32 v61, v61
    v_exp_f32 v62, v62
    v_exp_f32 v63, v63
    v_exp_f32 v32, v32
    v_exp_f32 v33, v33
    v_smfmac_f32_32x32x32_bf16 v[112:127], a[40:43], v[56:63], v3
    v_exp_f32 v34, v34
    v_exp_f32 v35, v35
    v_exp_f32 v36, v36
    v_mfma_f32_32x32x16_bf16 v[48:63], a[32:35], a[20:23], 0
    v_exp_f32 v37, v37
    v_exp_f32 v38, v38
    v_exp_f32 v39, v39
    v_exp_f32 v40, v40
    v_exp_f32 v41, v41
    v_smfmac_f32_32x32x32_bf16 v[128:143], a[36:39], v[32:39], v3
    v_exp_f32 v42, v42
    v_exp_f32 v43, v43
    v_exp_f32 v44, v44
    v_exp_f32 v45, v45
    v_exp_f32 v46, v46
    v_exp_f32 v47, v47
    v_exp_f32 v48, v48
    v_exp_f32 v49, v49
    v_smfmac_f32_32x32x32_bf16 v[128:143], a[40:43], v[40:47], v3
    s_add_u32 s84, s4, s52
    s_addc_u32 s85, s5, 0
    v_exp_f32 v50, v50
    v_exp_f32 v51, v51
    v_exp_f32 v52, v52
    v_mfma_f32_32x32x16_bf16 v[32:47], a[32:35], a[24:27], 0
    v_exp_f32 v53, v53
    v_exp_f32 v54, v54
    v_exp_f32 v55, v55
    v_exp_f32 v56, v56
    v_exp_f32 v57, v57
    v_smfmac_f32_32x32x32_bf16 v[144:159], a[36:39], v[48:55], v3
    global_load_dwordx4 a[208:211], v1, s[84:85] offset:0 sc1
    global_load_dwordx4 a[212:215], v1, s[84:85] offset:1024 sc1
    global_load_dwordx4 a[216:219], v1, s[84:85] offset:2048 sc1
    global_load_dwordx4 a[220:223], v1, s[84:85] offset:3072 sc1
    v_exp_f32 v58, v58
    v_exp_f32 v59, v59
    v_exp_f32 v60, v60
    v_exp_f32 v61, v61
    v_exp_f32 v62, v62
    v_exp_f32 v63, v63
    v_exp_f32 v32, v32
    v_exp_f32 v33, v33
    v_smfmac_f32_32x32x32_bf16 v[144:159], a[40:43], v[56:63], v3
    s_add_u32 s84, s84, 16384
    s_addc_u32 s85, s85, 0
    v_exp_f32 v34, v34
    v_exp_f32 v35, v35
    v_exp_f32 v36, v36
    v_mfma_f32_32x32x16_bf16 v[48:63], a[32:35], a[28:31], 0
    v_exp_f32 v37, v37
    v_exp_f32 v38, v38
    v_exp_f32 v39, v39
    v_exp_f32 v40, v40
    v_exp_f32 v41, v41
    v_smfmac_f32_32x32x32_bf16 v[160:175], a[36:39], v[32:39], v3
    global_load_dwordx4 a[224:227], v1, s[84:85] offset:0 sc1
    global_load_dwordx4 a[228:231], v1, s[84:85] offset:1024 sc1
    global_load_dwordx4 a[232:235], v1, s[84:85] offset:2048 sc1
    global_load_dwordx4 a[236:239], v1, s[84:85] offset:3072 sc1
    v_exp_f32 v42, v42
    v_exp_f32 v43, v43
    v_exp_f32 v44, v44
    v_exp_f32 v45, v45
    v_exp_f32 v46, v46
    v_exp_f32 v47, v47
    v_exp_f32 v48, v48
    v_exp_f32 v49, v49
    v_smfmac_f32_32x32x32_bf16 v[160:175], a[40:43], v[40:47], v3
    s_waitcnt vmcnt(26)
    v_exp_f32 v50, v50
    v_exp_f32 v51, v51
    v_exp_f32 v52, v52
    v_mfma_f32_32x32x16_bf16 v[32:47], a[44:47], a[0:3], 0
    v_exp_f32 v53, v53
    v_exp_f32 v54, v54
    v_exp_f32 v55, v55
    v_exp_f32 v56, v56
    v_exp_f32 v57, v57
    v_smfmac_f32_32x32x32_bf16 v[176:191], a[36:39], v[48:55], v3
    v_exp_f32 v58, v58
    v_exp_f32 v59, v59
    v_exp_f32 v60, v60
    v_exp_f32 v61, v61
    v_exp_f32 v62, v62
    v_exp_f32 v63, v63
    v_exp_f32 v32, v32
    v_exp_f32 v33, v33
    v_smfmac_f32_32x32x32_bf16 v[176:191], a[40:43], v[56:63], v3
    s_waitcnt vmcnt(19)
    v_exp_f32 v34, v34
    v_exp_f32 v35, v35
    v_exp_f32 v36, v36
    v_mfma_f32_32x32x16_bf16 v[48:63], a[56:59], a[0:3], 0
    v_exp_f32 v37, v37
    v_exp_f32 v38, v38
    v_exp_f32 v39, v39
    v_exp_f32 v40, v40
    v_exp_f32 v41, v41
    v_smfmac_f32_32x32x32_bf16 v[64:79], a[48:51], v[32:39], v3
    v_exp_f32 v42, v42
    v_exp_f32 v43, v43
    v_exp_f32 v44, v44
    v_exp_f32 v45, v45
    v_exp_f32 v46, v46
    v_exp_f32 v47, v47
    v_exp_f32 v48, v48
    v_exp_f32 v49, v49
    v_smfmac_f32_32x32x32_bf16 v[64:79], a[52:55], v[40:47], v3
    s_waitcnt vmcnt(8)
    v_exp_f32 v50, v50
    v_exp_f32 v51, v51
    v_exp_f32 v52, v52
    v_mfma_f32_32x32x16_bf16 v[32:47], a[68:71], a[0:3], 0
    v_exp_f32 v53, v53
    v_exp_f32 v54, v54
    v_exp_f32 v55, v55
    v_exp_f32 v56, v56
    v_exp_f32 v57, v57
    v_smfmac_f32_32x32x32_bf16 v[64:79], a[60:63], v[48:55], v3
    v_exp_f32 v58, v58
    v_exp_f32 v59, v59
    v_exp_f32 v60, v60
    v_exp_f32 v61, v61
    v_exp_f32 v62, v62
    v_exp_f32 v63, v63
    v_exp_f32 v32, v32
    v_exp_f32 v33, v33
    v_smfmac_f32_32x32x32_bf16 v[64:79], a[64:67], v[56:63], v3
    v_exp_f32 v34, v34
    v_exp_f32 v35, v35
    v_exp_f32 v36, v36
    v_mfma_f32_32x32x16_bf16 v[48:63], a[44:47], a[4:7], 0
    v_exp_f32 v37, v37
    v_exp_f32 v38, v38
    v_exp_f32 v39, v39
    v_exp_f32 v40, v40
    v_exp_f32 v41, v41
    v_smfmac_f32_32x32x32_bf16 v[64:79], a[72:75], v[32:39], v3
    v_exp_f32 v42, v42
    v_exp_f32 v43, v43
    v_exp_f32 v44, v44
    v_exp_f32 v45, v45
    v_exp_f32 v46, v46
    v_exp_f32 v47, v47
    v_exp_f32 v48, v48
    v_exp_f32 v49, v49
    v_smfmac_f32_32x32x32_bf16 v[64:79], a[76:79], v[40:47], v3
    s_add_u32 s84, s84, 16384
    s_addc_u32 s85, s85, 0
    v_exp_f32 v50, v50
    v_exp_f32 v51, v51
    v_exp_f32 v52, v52
    v_mfma_f32_32x32x16_bf16 v[32:47], a[56:59], a[4:7], 0
    s_mul_i32 s23, s58, 2048
    v_exp_f32 v53, v53
    v_exp_f32 v54, v54
    v_exp_f32 v55, v55
    v_exp_f32 v56, v56
    v_exp_f32 v57, v57
    v_smfmac_f32_32x32x32_bf16 v[80:95], a[48:51], v[48:55], v3
    global_load_dwordx4 a[240:243], v1, s[84:85] offset:0 sc1
    global_load_dwordx4 a[244:247], v1, s[84:85] offset:1024 sc1
    global_load_dwordx4 a[248:251], v1, s[84:85] offset:2048 sc1
    global_load_dwordx4 a[252:255], v1, s[84:85] offset:3072 sc1
    s_add_u32 s23, s23, 60850176
    v_lshlrev_b32 v22, 5, v0
    buffer_load_dword v242, v22, s[4:7], s23 offen sc1
    v_exp_f32 v58, v58
    v_exp_f32 v59, v59
    v_exp_f32 v60, v60
    v_exp_f32 v61, v61
    v_exp_f32 v62, v62
    v_exp_f32 v63, v63
    v_exp_f32 v32, v32
    v_exp_f32 v33, v33
    v_smfmac_f32_32x32x32_bf16 v[80:95], a[52:55], v[56:63], v3
    ds_write_b128 v8, v[64:67] offset:0
    v_exp_f32 v34, v34
    v_exp_f32 v35, v35
    v_exp_f32 v36, v36
    v_mfma_f32_32x32x16_bf16 v[48:63], a[68:71], a[4:7], 0
    ds_write_b32 v9, v72 offset:2048
    v_exp_f32 v37, v37
    v_exp_f32 v38, v38
    v_exp_f32 v39, v39
    v_exp_f32 v40, v40
    v_exp_f32 v41, v41
    v_smfmac_f32_32x32x32_bf16 v[80:95], a[60:63], v[32:39], v3
    v_exp_f32 v42, v42
    v_exp_f32 v43, v43
    v_exp_f32 v44, v44
    v_exp_f32 v45, v45
    v_exp_f32 v46, v46
    v_exp_f32 v47, v47
    v_exp_f32 v48, v48
    v_exp_f32 v49, v49
    v_smfmac_f32_32x32x32_bf16 v[80:95], a[64:67], v[40:47], v3
    s_add_u32 s84, s84, 16384
    s_addc_u32 s85, s85, 0
    ds_write_b128 v8, v[68:71] offset:1024
    v_exp_f32 v50, v50
    v_exp_f32 v51, v51
    v_exp_f32 v52, v52
    v_mfma_f32_32x32x16_bf16 v[32:47], a[44:47], a[8:11], 0
    v_exp_f32 v53, v53
    v_exp_f32 v54, v54
    v_exp_f32 v55, v55
    v_exp_f32 v56, v56
    v_exp_f32 v57, v57
    v_smfmac_f32_32x32x32_bf16 v[80:95], a[72:75], v[48:55], v3
    global_load_dwordx4 v[192:195], v1, s[84:85] offset:0 sc1
    global_load_dwordx4 v[196:199], v1, s[84:85] offset:1024 sc1
    global_load_dwordx4 v[200:203], v1, s[84:85] offset:2048 sc1
    global_load_dwordx4 v[204:207], v1, s[84:85] offset:3072 sc1
    v_exp_f32 v58, v58
    v_exp_f32 v59, v59
    v_exp_f32 v60, v60
    v_exp_f32 v61, v61
    v_exp_f32 v62, v62
    v_exp_f32 v63, v63
    v_exp_f32 v32, v32
    v_exp_f32 v33, v33
    v_smfmac_f32_32x32x32_bf16 v[80:95], a[76:79], v[56:63], v3
    v_exp_f32 v34, v34
    v_exp_f32 v35, v35
    v_exp_f32 v36, v36
    v_mfma_f32_32x32x16_bf16 v[48:63], a[56:59], a[8:11], 0
    v_exp_f32 v37, v37
    v_exp_f32 v38, v38
    v_exp_f32 v39, v39
    v_exp_f32 v40, v40
    v_exp_f32 v41, v41
    v_smfmac_f32_32x32x32_bf16 v[96:111], a[48:51], v[32:39], v3
    v_lshlrev_b32 v22, 2, v0
    buffer_load_dword v242, v22, s[16:19], s99 offen
    v_exp_f32 v42, v42
    v_exp_f32 v43, v43
    v_exp_f32 v44, v44
    v_exp_f32 v45, v45
    v_exp_f32 v46, v46
    v_exp_f32 v47, v47
    v_exp_f32 v48, v48
    v_exp_f32 v49, v49
    v_smfmac_f32_32x32x32_bf16 v[96:111], a[52:55], v[40:47], v3
    ds_write_b128 v8, v[80:83] offset:2304
    v_exp_f32 v50, v50
    v_exp_f32 v51, v51
    v_exp_f32 v52, v52
    v_mfma_f32_32x32x16_bf16 v[32:47], a[68:71], a[8:11], 0
    ds_write_b32 v9, v88 offset:4352
    v_exp_f32 v53, v53
    v_exp_f32 v54, v54
    v_exp_f32 v55, v55
    v_exp_f32 v56, v56
    v_exp_f32 v57, v57
    v_smfmac_f32_32x32x32_bf16 v[96:111], a[60:63], v[48:55], v3
    v_exp_f32 v58, v58
    v_exp_f32 v59, v59
    v_exp_f32 v60, v60
    v_exp_f32 v61, v61
    v_exp_f32 v62, v62
    v_exp_f32 v63, v63
    v_exp_f32 v32, v32
    v_exp_f32 v33, v33
    v_smfmac_f32_32x32x32_bf16 v[96:111], a[64:67], v[56:63], v3
    ds_write_b128 v8, v[84:87] offset:3328
    v_exp_f32 v34, v34
    v_exp_f32 v35, v35
    v_exp_f32 v36, v36
    v_mfma_f32_32x32x16_bf16 v[48:63], a[44:47], a[12:15], 0
    v_exp_f32 v37, v37
    v_exp_f32 v38, v38
    v_exp_f32 v39, v39
    v_exp_f32 v40, v40
    v_exp_f32 v41, v41
    v_smfmac_f32_32x32x32_bf16 v[96:111], a[72:75], v[32:39], v3
    v_exp_f32 v42, v42
    v_exp_f32 v43, v43
    v_exp_f32 v44, v44
    v_exp_f32 v45, v45
    v_exp_f32 v46, v46
    v_exp_f32 v47, v47
    v_exp_f32 v48, v48
    v_exp_f32 v49, v49
    v_smfmac_f32_32x32x32_bf16 v[96:111], a[76:79], v[40:47], v3
    v_exp_f32 v50, v50
    v_exp_f32 v51, v51
    v_exp_f32 v52, v52
    v_mfma_f32_32x32x16_bf16 v[32:47], a[56:59], a[12:15], 0
    v_exp_f32 v53, v53
    v_exp_f32 v54, v54
    v_exp_f32 v55, v55
    v_exp_f32 v56, v56
    v_exp_f32 v57, v57
    v_smfmac_f32_32x32x32_bf16 v[112:127], a[48:51], v[48:55], v3
    v_exp_f32 v58, v58
    v_exp_f32 v59, v59
    v_exp_f32 v60, v60
    v_exp_f32 v61, v61
    v_exp_f32 v62, v62
    v_exp_f32 v63, v63
    v_exp_f32 v32, v32
    v_exp_f32 v33, v33
    v_smfmac_f32_32x32x32_bf16 v[112:127], a[52:55], v[56:63], v3
    s_lshr_b32 s24, s22, 4
    s_lshl_b32 s24, s24, 15
    ds_write_b128 v10, v[96:99] offset:0
    v_exp_f32 v34, v34
    v_exp_f32 v35, v35
    v_exp_f32 v36, v36
    v_mfma_f32_32x32x16_bf16 v[48:63], a[68:71], a[12:15], 0
    ds_write_b32 v11, v104 offset:2048
    v_exp_f32 v37, v37
    v_exp_f32 v38, v38
    v_exp_f32 v39, v39
    v_exp_f32 v40, v40
    v_exp_f32 v41, v41
    v_smfmac_f32_32x32x32_bf16 v[112:127], a[60:63], v[32:39], v3
    s_add_u32 s24, s24, s49
    s_add_u32 s24, s24, s51
    v_exp_f32 v42, v42
    v_exp_f32 v43, v43
    v_exp_f32 v44, v44
    v_exp_f32 v45, v45
    v_exp_f32 v46, v46
    v_exp_f32 v47, v47
    v_exp_f32 v48, v48
    v_exp_f32 v49, v49
    v_smfmac_f32_32x32x32_bf16 v[112:127], a[64:67], v[40:47], v3
    ds_write_b128 v10, v[100:103] offset:1024
    v_exp_f32 v50, v50
    v_exp_f32 v51, v51
    v_exp_f32 v52, v52
    v_mfma_f32_32x32x16_bf16 v[32:47], a[44:47], a[16:19], 0
    s_add_u32 s24, s24, 163840
    v_exp_f32 v53, v53
    v_exp_f32 v54, v54
    v_exp_f32 v55, v55
    v_exp_f32 v56, v56
    v_exp_f32 v57, v57
    v_smfmac_f32_32x32x32_bf16 v[112:127], a[72:75], v[48:55], v3
    v_lshlrev_b32 v24, 7, v0
    buffer_load_dword v242, v24, s[4:7], s24 offen sc1
    v_exp_f32 v58, v58
    v_exp_f32 v59, v59
    v_exp_f32 v60, v60
    v_exp_f32 v61, v61
    v_exp_f32 v62, v62
    v_exp_f32 v63, v63
    v_exp_f32 v32, v32
    v_exp_f32 v33, v33
    v_smfmac_f32_32x32x32_bf16 v[112:127], a[76:79], v[56:63], v3
    v_exp_f32 v34, v34
    v_exp_f32 v35, v35
    v_exp_f32 v36, v36
    v_mfma_f32_32x32x16_bf16 v[48:63], a[56:59], a[16:19], 0
    v_exp_f32 v37, v37
    v_exp_f32 v38, v38
    v_exp_f32 v39, v39
    v_exp_f32 v40, v40
    v_exp_f32 v41, v41
    v_smfmac_f32_32x32x32_bf16 v[128:143], a[48:51], v[32:39], v3
    v_exp_f32 v42, v42
    v_exp_f32 v43, v43
    v_exp_f32 v44, v44
    v_exp_f32 v45, v45
    v_exp_f32 v46, v46
    v_exp_f32 v47, v47
    v_exp_f32 v48, v48
    v_exp_f32 v49, v49
    v_smfmac_f32_32x32x32_bf16 v[128:143], a[52:55], v[40:47], v3
    ds_write_b128 v10, v[112:115] offset:2304
    v_exp_f32 v50, v50
    v_exp_f32 v51, v51
    v_exp_f32 v52, v52
    v_mfma_f32_32x32x16_bf16 v[32:47], a[68:71], a[16:19], 0
    ds_write_b32 v11, v120 offset:4352
    v_exp_f32 v53, v53
    v_exp_f32 v54, v54
    v_exp_f32 v55, v55
    v_exp_f32 v56, v56
    v_exp_f32 v57, v57
    v_smfmac_f32_32x32x32_bf16 v[128:143], a[60:63], v[48:55], v3
    v_exp_f32 v58, v58
    v_exp_f32 v59, v59
    v_exp_f32 v60, v60
    v_exp_f32 v61, v61
    v_exp_f32 v62, v62
    v_exp_f32 v63, v63
    v_exp_f32 v32, v32
    v_exp_f32 v33, v33
    v_smfmac_f32_32x32x32_bf16 v[128:143], a[64:67], v[56:63], v3
    ds_write_b128 v10, v[116:119] offset:3328
    v_exp_f32 v34, v34
    v_exp_f32 v35, v35
    v_exp_f32 v36, v36
    v_mfma_f32_32x32x16_bf16 v[48:63], a[44:47], a[20:23], 0
    v_exp_f32 v37, v37
    v_exp_f32 v38, v38
    v_exp_f32 v39, v39
    v_exp_f32 v40, v40
    v_exp_f32 v41, v41
    v_smfmac_f32_32x32x32_bf16 v[128:143], a[72:75], v[32:39], v3
    v_exp_f32 v42, v42
    v_exp_f32 v43, v43
    v_exp_f32 v44, v44
    v_exp_f32 v45, v45
    v_exp_f32 v46, v46
    v_exp_f32 v47, v47
    v_exp_f32 v48, v48
    v_exp_f32 v49, v49
    v_smfmac_f32_32x32x32_bf16 v[128:143], a[76:79], v[40:47], v3
    v_exp_f32 v50, v50
    v_exp_f32 v51, v51
    v_exp_f32 v52, v52
    v_mfma_f32_32x32x16_bf16 v[32:47], a[56:59], a[20:23], 0
    v_exp_f32 v53, v53
    v_exp_f32 v54, v54
    v_exp_f32 v55, v55
    v_exp_f32 v56, v56
    v_exp_f32 v57, v57
    v_smfmac_f32_32x32x32_bf16 v[144:159], a[48:51], v[48:55], v3
    v_exp_f32 v58, v58
    v_exp_f32 v59, v59
    v_exp_f32 v60, v60
    v_exp_f32 v61, v61
    v_exp_f32 v62, v62
    v_exp_f32 v63, v63
    v_exp_f32 v32, v32
    v_exp_f32 v33, v33
    v_smfmac_f32_32x32x32_bf16 v[144:159], a[52:55], v[56:63], v3
    ds_write_b128 v12, v[128:131] offset:0
    v_exp_f32 v34, v34
    v_exp_f32 v35, v35
    v_exp_f32 v36, v36
    v_mfma_f32_32x32x16_bf16 v[48:63], a[68:71], a[20:23], 0
    ds_write_b32 v13, v136 offset:2048
    v_exp_f32 v37, v37
    v_exp_f32 v38, v38
    v_exp_f32 v39, v39
    v_exp_f32 v40, v40
    v_exp_f32 v41, v41
    v_smfmac_f32_32x32x32_bf16 v[144:159], a[60:63], v[32:39], v3
    v_exp_f32 v42, v42
    v_exp_f32 v43, v43
    v_exp_f32 v44, v44
    v_exp_f32 v45, v45
    v_exp_f32 v46, v46
    v_exp_f32 v47, v47
    v_exp_f32 v48, v48
    v_exp_f32 v49, v49
    v_smfmac_f32_32x32x32_bf16 v[144:159], a[64:67], v[40:47], v3
    ds_write_b128 v12, v[132:135] offset:1024
    v_exp_f32 v50, v50
    v_exp_f32 v51, v51
    v_exp_f32 v52, v52
    v_mfma_f32_32x32x16_bf16 v[32:47], a[44:47], a[24:27], 0
    v_exp_f32 v53, v53
    v_exp_f32 v54, v54
    v_exp_f32 v55, v55
    v_exp_f32 v56, v56
    v_exp_f32 v57, v57
    v_smfmac_f32_32x32x32_bf16 v[144:159], a[72:75], v[48:55], v3
    v_exp_f32 v58, v58
    v_exp_f32 v59, v59
    v_exp_f32 v60, v60
    v_exp_f32 v61, v61
    v_exp_f32 v62, v62
    v_exp_f32 v63, v63
    v_exp_f32 v32, v32
    v_exp_f32 v33, v33
    v_smfmac_f32_32x32x32_bf16 v[144:159], a[76:79], v[56:63], v3
    v_exp_f32 v34, v34
    v_exp_f32 v35, v35
    v_exp_f32 v36, v36
    v_mfma_f32_32x32x16_bf16 v[48:63], a[56:59], a[24:27], 0
    v_exp_f32 v37, v37
    v_exp_f32 v38, v38
    v_exp_f32 v39, v39
    v_exp_f32 v40, v40
    v_exp_f32 v41, v41
    v_smfmac_f32_32x32x32_bf16 v[160:175], a[48:51], v[32:39], v3
    v_exp_f32 v42, v42
    v_exp_f32 v43, v43
    v_exp_f32 v44, v44
    v_exp_f32 v45, v45
    v_exp_f32 v46, v46
    v_exp_f32 v47, v47
    v_exp_f32 v48, v48
    v_exp_f32 v49, v49
    v_smfmac_f32_32x32x32_bf16 v[160:175], a[52:55], v[40:47], v3
    ds_write_b128 v12, v[144:147] offset:2304
    v_exp_f32 v50, v50
    v_exp_f32 v51, v51
    v_exp_f32 v52, v52
    v_mfma_f32_32x32x16_bf16 v[32:47], a[68:71], a[24:27], 0
    ds_write_b32 v13, v152 offset:4352
    v_exp_f32 v53, v53
    v_exp_f32 v54, v54
    v_exp_f32 v55, v55
    v_exp_f32 v56, v56
    v_exp_f32 v57, v57
    v_smfmac_f32_32x32x32_bf16 v[160:175], a[60:63], v[48:55], v3
    ds_write_b128 v12, v[148:151] offset:3328
    v_exp_f32 v58, v58
    v_exp_f32 v59, v59
    v_exp_f32 v60, v60
    v_exp_f32 v61, v61
    v_exp_f32 v62, v62
    v_exp_f32 v63, v63
    v_exp_f32 v32, v32
    v_exp_f32 v33, v33
    v_smfmac_f32_32x32x32_bf16 v[160:175], a[64:67], v[56:63], v3
    s_waitcnt lgkmcnt(0)
    s_barrier
    v_exp_f32 v34, v34
    v_exp_f32 v35, v35
    v_exp_f32 v36, v36
    v_mfma_f32_32x32x16_bf16 v[48:63], a[44:47], a[28:31], 0
    ds_read_b128 v[64:67], v14 offset:0
    ds_read_b128 v[68:71], v14 offset:1024
    v_exp_f32 v37, v37
    v_exp_f32 v38, v38
    v_exp_f32 v39, v39
    v_exp_f32 v40, v40
    v_exp_f32 v41, v41
    v_smfmac_f32_32x32x32_bf16 v[160:175], a[72:75], v[32:39], v3
    ds_read_b32 v16, v15 offset:2048
    ds_read_b128 v[72:75], v14 offset:4608
    v_exp_f32 v42, v42
    v_exp_f32 v43, v43
    v_exp_f32 v44, v44
    v_exp_f32 v45, v45
    v_exp_f32 v46, v46
    v_exp_f32 v47, v47
    v_exp_f32 v48, v48
    v_exp_f32 v49, v49
    v_smfmac_f32_32x32x32_bf16 v[160:175], a[76:79], v[40:47], v3
    ds_read_b128 v[76:79], v14 offset:5632
    ds_read_b32 v17, v15 offset:6656
    v_exp_f32 v50, v50
    v_exp_f32 v51, v51
    v_exp_f32 v52, v52
    v_mfma_f32_32x32x16_bf16 v[32:47], a[56:59], a[28:31], 0
    ds_read_b128 v[80:83], v14 offset:9216
    v_exp_f32 v53, v53
    v_exp_f32 v54, v54
    v_exp_f32 v55, v55
    v_exp_f32 v56, v56
    v_exp_f32 v57, v57
    v_smfmac_f32_32x32x32_bf16 v[176:191], a[48:51], v[48:55], v3
    ds_read_b128 v[84:87], v14 offset:10240
    ds_read_b32 v18, v15 offset:11264
    v_exp_f32 v58, v58
    v_exp_f32 v59, v59
    v_exp_f32 v60, v60
    v_exp_f32 v61, v61
    v_exp_f32 v62, v62
    v_exp_f32 v63, v63
    v_exp_f32 v32, v32
    v_exp_f32 v33, v33
    v_smfmac_f32_32x32x32_bf16 v[176:191], a[52:55], v[56:63], v3
    ds_read_b128 v[88:91], v14 offset:2304
    ds_read_b128 v[92:95], v14 offset:3328
    v_exp_f32 v34, v34
    v_exp_f32 v35, v35
    v_exp_f32 v36, v36
    v_mfma_f32_32x32x16_bf16 v[48:63], a[68:71], a[28:31], 0
    ds_read_b32 v19, v15 offset:4352
    v_exp_f32 v37, v37
    v_exp_f32 v38, v38
    v_exp_f32 v39, v39
    v_exp_f32 v40, v40
    v_exp_f32 v41, v41
    v_smfmac_f32_32x32x32_bf16 v[176:191], a[60:63], v[32:39], v3
    ds_read_b128 v[96:99], v14 offset:6912
    ds_read_b128 v[100:103], v14 offset:7936
    v_exp_f32 v42, v42
    v_exp_f32 v43, v43
    v_exp_f32 v44, v44
    v_exp_f32 v45, v45
    v_exp_f32 v46, v46
    v_exp_f32 v47, v47
    v_exp_f32 v48, v48
    v_exp_f32 v49, v49
    v_smfmac_f32_32x32x32_bf16 v[176:191], a[64:67], v[40:47], v3
    ds_read_b32 v20, v15 offset:8960
    ds_read_b128 v[104:107], v14 offset:11520
    v_exp_f32 v50, v50
    v_exp_f32 v51, v51
    v_exp_f32 v52, v52
    v_exp_f32 v53, v53
    v_exp_f32 v54, v54
    v_exp_f32 v55, v55
    v_exp_f32 v56, v56
    v_exp_f32 v57, v57
    v_smfmac_f32_32x32x32_bf16 v[176:191], a[72:75], v[48:55], v3
    ds_read_b128 v[108:111], v14 offset:12544
    ds_read_b32 v21, v15 offset:13568
    v_exp_f32 v58, v58
    v_exp_f32 v59, v59
    v_exp_f32 v60, v60
    v_exp_f32 v61, v61
    v_exp_f32 v62, v62
    v_exp_f32 v63, v63
    s_nop 1
    v_smfmac_f32_32x32x32_bf16 v[176:191], a[76:79], v[56:63], v3
L_p3:
    s_waitcnt lgkmcnt(9)
    v_add_f32 v16, v16, v17
    v_add_f32 v168, v168, v18
    v_add_f32 v168, v168, v16
    v_pk_add_f32 v[160:161], v[160:161], v[64:65]
    v_pk_add_f32 v[162:163], v[162:163], v[66:67]
    v_pk_add_f32 v[164:165], v[164:165], v[68:69]
    v_pk_add_f32 v[166:167], v[166:167], v[70:71]
    v_pk_add_f32 v[160:161], v[160:161], v[72:73]
    v_pk_add_f32 v[162:163], v[162:163], v[74:75]
    v_pk_add_f32 v[164:165], v[164:165], v[76:77]
    v_pk_add_f32 v[166:167], v[166:167], v[78:79]
    v_pk_add_f32 v[160:161], v[160:161], v[80:81]
    v_pk_add_f32 v[162:163], v[162:163], v[82:83]
    v_pk_add_f32 v[164:165], v[164:165], v[84:85]
    v_pk_add_f32 v[166:167], v[166:167], v[86:87]
    v_rcp_f32 v169, v168
    s_nop 0
    v_pk_mul_f32 v[160:161], v[160:161], v[168:169] op_sel:[0,1] op_sel_hi:[1,1]
    v_pk_mul_f32 v[162:163], v[162:163], v[168:169] op_sel:[0,1] op_sel_hi:[1,1]
    v_pk_mul_f32 v[164:165], v[164:165], v[168:169] op_sel:[0,1] op_sel_hi:[1,1]
    v_pk_mul_f32 v[166:167], v[166:167], v[168:169] op_sel:[0,1] op_sel_hi:[1,1]
    v_cvt_pk_bf16_f32 v172, v160, v161
    v_cvt_pk_bf16_f32 v173, v162, v163
    v_cvt_pk_bf16_f32 v174, v164, v165
    v_cvt_pk_bf16_f32 v175, v166, v167
    buffer_store_dwordx4 v[172:175], v1, s[4:7], s28 offen sc1
    s_waitcnt lgkmcnt(0)
    v_add_f32 v19, v19, v20
    v_add_f32 v184, v184, v21
    v_add_f32 v184, v184, v19
    v_pk_add_f32 v[176:177], v[176:177], v[88:89]
    v_pk_add_f32 v[178:179], v[178:179], v[90:91]
    v_pk_add_f32 v[180:181], v[180:181], v[92:93]
    v_pk_add_f32 v[182:183], v[182:183], v[94:95]
    v_pk_add_f32 v[176:177], v[176:177], v[96:97]
    v_pk_add_f32 v[178:179], v[178:179], v[98:99]
    v_pk_add_f32 v[180:181], v[180:181], v[100:101]
    v_pk_add_f32 v[182:183], v[182:183], v[102:103]
    v_pk_add_f32 v[176:177], v[176:177], v[104:105]
    v_pk_add_f32 v[178:179], v[178:179], v[106:107]
    v_pk_add_f32 v[180:181], v[180:181], v[108:109]
    v_pk_add_f32 v[182:183], v[182:183], v[110:111]
    v_rcp_f32 v185, v184
    s_nop 0
    v_pk_mul_f32 v[176:177], v[176:177], v[184:185] op_sel:[0,1] op_sel_hi:[1,1]
    v_pk_mul_f32 v[178:179], v[178:179], v[184:185] op_sel:[0,1] op_sel_hi:[1,1]
    v_pk_mul_f32 v[180:181], v[180:181], v[184:185] op_sel:[0,1] op_sel_hi:[1,1]
    v_pk_mul_f32 v[182:183], v[182:183], v[184:185] op_sel:[0,1] op_sel_hi:[1,1]
    v_cvt_pk_bf16_f32 v188, v176, v177
    v_cvt_pk_bf16_f32 v189, v178, v179
    v_cvt_pk_bf16_f32 v190, v180, v181
    v_cvt_pk_bf16_f32 v191, v182, v183
    buffer_store_dwordx4 v[188:191], v1, s[4:7], s29 offen sc1
    s_barrier
    s_mov_b32 s42, 0x30800000
    s_mov_b32 s43, 0x5d800000
    s_mov_b64 s[44:45], 0
    v_add_f32 v2, abs(v160), abs(v161)
    v_add_f32 v2, v2, abs(v162)
    v_add_f32 v2, v2, abs(v163)
    v_add_f32 v2, v2, abs(v164)
    v_add_f32 v2, v2, abs(v165)
    v_add_f32 v2, v2, abs(v166)
    v_add_f32 v2, v2, abs(v167)
    v_cmp_nle_f32 vcc, s42, v168
    s_or_b64 s[44:45], s[44:45], vcc
    v_cmp_nge_f32 vcc, s43, v168
    s_or_b64 s[44:45], s[44:45], vcc
    v_cmp_nge_f32 vcc, 0x7e800000, v2
    s_or_b64 s[44:45], s[44:45], vcc
    v_add_f32 v2, abs(v176), abs(v177)
    v_add_f32 v2, v2, abs(v178)
    v_add_f32 v2, v2, abs(v179)
    v_add_f32 v2, v2, abs(v180)
    v_add_f32 v2, v2, abs(v181)
    v_add_f32 v2, v2, abs(v182)
    v_add_f32 v2, v2, abs(v183)
    v_cmp_nle_f32 vcc, s42, v184
    s_or_b64 s[44:45], s[44:45], vcc
    v_cmp_nge_f32 vcc, s43, v184
    s_or_b64 s[44:45], s[44:45], vcc
    v_cmp_nge_f32 vcc, 0x7e800000, v2
    s_or_b64 s[44:45], s[44:45], vcc
    s_cbranch_scc1 L_slow
L_fin:
    s_and_b32 s35, s21, 0
    s_lshl_b32 s35, s35, 5
    s_and_b32 s23, s21, 7
    s_mul_i32 s23, s23, 4
    s_add_u32 s35, s35, s23
    s_mul_i32 s35, s35, 128
    v_lshrrev_b32 v240, 2, v0
    v_and_b32 v2, 3, v0
    v_lshl_add_u32 v240, v240, 5, v2
    v_mul_u32_u24 v240, 128, v240
    s_add_u32 s35, s35, 60817408
    s_lshr_b32 s26, s57, 1
    s_mul_i32 s26, s26, 32768
    s_and_b32 s27, s57, 1
    s_lshl_b32 s27, s27, 8
    s_add_u32 s26, s26, s27
    s_add_u32 s26, s26, s48
    s_add_u32 s26, s26, 11534336
    v_and_b32 v6, 15, v0
    v_lshrrev_b32 v3, 4, v0
    v_lshlrev_b32 v6, 4, v6
    v_lshl_add_u32 v6, v3, 9, v6
    v_lshlrev_b32 v16, 16, v248
    v_and_b32 v17, 0xffff0000, v248
    v_lshlrev_b32 v18, 16, v249
    v_and_b32 v19, 0xffff0000, v249
    v_lshlrev_b32 v20, 16, v250
    v_and_b32 v21, 0xffff0000, v250
    v_lshlrev_b32 v22, 16, v251
    v_and_b32 v23, 0xffff0000, v251
    v_lshlrev_b32 v24, 16, v252
    v_and_b32 v25, 0xffff0000, v252
    v_lshlrev_b32 v26, 16, v253
    v_and_b32 v27, 0xffff0000, v253
    v_lshlrev_b32 v28, 16, v254
    v_and_b32 v29, 0xffff0000, v254
    v_lshlrev_b32 v30, 16, v255
    v_and_b32 v31, 0xffff0000, v255
    s_add_u32 s61, s61, 1
    s_add_u32 s34, s55, 32768
    v_mov_b32 v2, s61
    s_waitcnt vmcnt(0)
    s_barrier
    s_mov_b64 exec, 1
    buffer_store_dword v2, off, s[4:7], s55 sc1
    s_mov_b64 exec, -1
    s_add_u32 s38, s52, 65536
    buffer_load_dwordx4 v[144:147], v1, s[4:7], s38 offen offset:0 sc1
    ds_write_b128 v245, a[128:131] offset:16384
    buffer_load_dwordx4 v[148:151], v1, s[4:7], s38 offen offset:1024 sc1
    ds_write_b128 v245, a[132:135] offset:17408
    buffer_load_dwordx4 v[152:155], v1, s[4:7], s38 offen offset:2048 sc1
    ds_write_b128 v245, a[136:139] offset:18432
    buffer_load_dwordx4 v[156:159], v1, s[4:7], s38 offen offset:3072 sc1
    ds_write_b128 v245, a[140:143] offset:19456
    s_add_u32 s38, s52, 81920
    buffer_load_dwordx4 v[160:163], v1, s[4:7], s38 offen offset:0 sc1
    ds_write_b128 v245, a[112:115] offset:0
    buffer_load_dwordx4 v[164:167], v1, s[4:7], s38 offen offset:1024 sc1
    ds_write_b128 v245, a[116:119] offset:1024
    buffer_load_dwordx4 v[168:171], v1, s[4:7], s38 offen offset:2048 sc1
    ds_write_b128 v245, a[120:123] offset:2048
    buffer_load_dwordx4 v[172:175], v1, s[4:7], s38 offen offset:3072 sc1
    ds_write_b128 v245, a[124:127] offset:3072
    s_add_u32 s38, s52, 98304
    buffer_load_dwordx4 v[176:179], v1, s[4:7], s38 offen offset:0 sc1
    ds_write_b128 v244, a[96:99] offset:49152
    buffer_load_dwordx4 v[180:183], v1, s[4:7], s38 offen offset:1024 sc1
    ds_write_b128 v244, a[100:103] offset:50176
    buffer_load_dwordx4 v[184:187], v1, s[4:7], s38 offen offset:2048 sc1
    ds_write_b128 v244, a[104:107] offset:51200
    buffer_load_dwordx4 v[188:191], v1, s[4:7], s38 offen offset:3072 sc1
    ds_write_b128 v244, a[108:111] offset:52224
    ds_write_b128 v244, a[80:83] offset:32768
    ds_write_b128 v244, a[84:87] offset:33792
    ds_write_b128 v244, a[88:91] offset:34816
    ds_write_b128 v244, a[92:95] offset:35840
    s_cmp_lg_u32 s20, 1
    s_cbranch_scc1 L_go3
    s_mov_b32 exec_lo, 0xffffffff
    s_mov_b32 exec_hi, 0
    buffer_load_dword v241, v240, s[4:7], s35 offen sc1
    s_mov_b64 exec, -1
L_go3:
    ds_read_b128 v[32:35], v1 offset:0
    ds_read_b128 v[36:39], v1 offset:1024
    ds_read_b128 v[40:43], v1 offset:2048
    ds_read_b128 v[44:47], v1 offset:3072
    ds_read_b128 v[48:51], v1 offset:4096
    ds_read_b128 v[52:55], v1 offset:5120
    ds_read_b128 v[56:59], v1 offset:6144
    ds_read_b128 v[60:63], v1 offset:7168
    ds_read_b128 v[64:67], v1 offset:8192
    ds_read_b128 v[68:71], v1 offset:9216
    ds_read_b128 v[72:75], v1 offset:10240
    ds_read_b128 v[76:79], v1 offset:11264
    ds_read_b128 v[80:83], v1 offset:12288
    ds_read_b128 v[84:87], v1 offset:13312
    ds_read_b128 v[88:91], v1 offset:14336
    ds_read_b128 v[92:95], v1 offset:15360
    s_cmp_lg_u32 s20, 1
    s_cbranch_scc1 L_go4
    s_mov_b32 exec_lo, 0xffffffff
    s_mov_b32 exec_hi, 0
    s_mov_b32 s60, 0
    s_add_u32 s34, s35, 32768
    s_waitcnt vmcnt(0)
    v_cmp_gt_u32 vcc, s61, v241
    s_cbranch_vccz L_done4
    s_mov_b64 exec, vcc
L_poll4:
    buffer_load_dword v2, v240, s[4:7], s35 offen sc1
    s_add_u32 s60, s60, 1
    s_waitcnt vmcnt(0)
    v_cmp_gt_u32 vcc, s61, v2
    s_cbranch_vccz L_done4
    s_mov_b64 exec, vcc
    s_cmp_lt_u32 s60, 0x20000
    s_cbranch_scc1 L_poll4
L_done4:
    s_mov_b64 exec, -1
L_go4:
    s_waitcnt lgkmcnt(15)
    s_barrier
    buffer_load_dwordx4 a[0:3], v6, s[4:7], s26 offen offset:0 sc1
    buffer_load_dwordx4 a[4:7], v6, s[4:7], s26 offen offset:2048 sc1
    s_add_u32 s26, s26, 4096
    buffer_load_dwordx4 a[8:11], v6, s[4:7], s26 offen offset:0 sc1
    buffer_load_dwordx4 a[12:15], v6, s[4:7], s26 offen offset:2048 sc1
    s_add_u32 s26, s26, 4096
    buffer_load_dwordx4 a[16:19], v6, s[4:7], s26 offen offset:0 sc1
    buffer_load_dwordx4 a[20:23], v6, s[4:7], s26 offen offset:2048 sc1
    s_add_u32 s26, s26, 4096
    buffer_load_dwordx4 a[24:27], v6, s[4:7], s26 offen offset:0 sc1
    buffer_load_dwordx4 a[28:31], v6, s[4:7], s26 offen offset:2048 sc1
    s_add_u32 s26, s26, 4096
    buffer_load_dwordx4 a[32:35], v6, s[4:7], s26 offen offset:0 sc1
    buffer_load_dwordx4 a[36:39], v6, s[4:7], s26 offen offset:2048 sc1
    s_lshr_b32 s33, s57, 1
    s_lshl_b32 s33, s33, 15
    s_and_b32 s23, s57, 1
    s_lshl_b32 s23, s23, 8
    s_add_u32 s33, s33, s23
    s_and_b32 s23, s22, 7
    s_lshl_b32 s23, s23, 12
    s_add_u32 s33, s33, s23
    s_add_u32 s33, s33, s48
    s_add_u32 s33, s33, 2097152
    s_and_b32 s32, s22, 7
    s_lshl_b32 s32, s32, 14
    s_lshl_b32 s23, s57, 7
    s_add_u32 s32, s32, s23
    s_add_u32 s32, s32, s48
    s_add_u32 s32, s32, 4325376
    v_and_b32 v7, 15, v0
    v_lshlrev_b32 v7, 3, v7
    v_lshrrev_b32 v3, 5, v0
    v_lshl_add_u32 v7, v3, 2, v7
    s_waitcnt vmcnt(9) lgkmcnt(12)
    v_mfma_f32_16x16x32_bf16 v[16:19], v[32:35], a[0:3], v[16:19]
    ds_read_b128 v[96:99], v1 offset:16384
    s_add_u32 s26, s26, 4096
    buffer_load_dwordx4 a[40:43], v6, s[4:7], s26 offen offset:0 sc1
    v_mfma_f32_16x16x32_bf16 v[20:23], v[36:39], a[0:3], v[20:23]
    ds_read_b128 v[100:103], v1 offset:17408
    v_mfma_f32_16x16x32_bf16 v[24:27], v[40:43], a[0:3], v[24:27]
    ds_read_b128 v[104:107], v1 offset:18432
    v_mfma_f32_16x16x32_bf16 v[28:31], v[44:47], a[0:3], v[28:31]
    ds_read_b128 v[108:111], v1 offset:19456
    s_waitcnt vmcnt(9) lgkmcnt(12)
    v_mfma_f32_16x16x32_bf16 v[16:19], v[48:51], a[4:7], v[16:19]
    ds_read_b128 v[112:115], v1 offset:20480
    buffer_load_dwordx4 a[44:47], v6, s[4:7], s26 offen offset:2048 sc1
    v_mfma_f32_16x16x32_bf16 v[20:23], v[52:55], a[4:7], v[20:23]
    ds_read_b128 v[116:119], v1 offset:21504
    v_mfma_f32_16x16x32_bf16 v[24:27], v[56:59], a[4:7], v[24:27]
    ds_read_b128 v[120:123], v1 offset:22528
    v_mfma_f32_16x16x32_bf16 v[28:31], v[60:63], a[4:7], v[28:31]
    ds_read_b128 v[124:127], v1 offset:23552
    s_waitcnt vmcnt(9) lgkmcnt(12)
    v_mfma_f32_16x16x32_bf16 v[16:19], v[64:67], a[8:11], v[16:19]
    ds_read_b128 v[128:131], v1 offset:24576
    s_add_u32 s26, s26, 4096
    buffer_load_dwordx4 a[48:51], v6, s[4:7], s26 offen offset:0 sc1
    v_mfma_f32_16x16x32_bf16 v[20:23], v[68:71], a[8:11], v[20:23]
    ds_read_b128 v[132:135], v1 offset:25600
    v_mfma_f32_16x16x32_bf16 v[24:27], v[72:75], a[8:11], v[24:27]
    ds_read_b128 v[136:139], v1 offset:26624
    v_mfma_f32_16x16x32_bf16 v[28:31], v[76:79], a[8:11], v[28:31]
    ds_read_b128 v[140:143], v1 offset:27648
    s_waitcnt vmcnt(9) lgkmcnt(12)
    v_mfma_f32_16x16x32_bf16 v[16:19], v[80:83], a[12:15], v[16:19]
    ds_read_b128 v[32:35], v1 offset:28672
    buffer_load_dwordx4 a[52:55], v6, s[4:7], s26 offen offset:2048 sc1
    v_mfma_f32_16x16x32_bf16 v[20:23], v[84:87], a[12:15], v[20:23]
    ds_read_b128 v[36:39], v1 offset:29696
    v_mfma_f32_16x16x32_bf16 v[24:27], v[88:91], a[12:15], v[24:27]
    ds_read_b128 v[40:43], v1 offset:30720
    v_mfma_f32_16x16x32_bf16 v[28:31], v[92:95], a[12:15], v[28:31]
    ds_read_b128 v[44:47], v1 offset:31744
    s_waitcnt vmcnt(9) lgkmcnt(12)
    v_mfma_f32_16x16x32_bf16 v[16:19], v[96:99], a[16:19], v[16:19]
    ds_read_b128 v[48:51], v1 offset:32768
    s_add_u32 s26, s26, 4096
    buffer_load_dwordx4 a[56:59], v6, s[4:7], s26 offen offset:0 sc1
    v_mfma_f32_16x16x32_bf16 v[20:23], v[100:103], a[16:19], v[20:23]
    ds_read_b128 v[52:55], v1 offset:33792
    v_mfma_f32_16x16x32_bf16 v[24:27], v[104:107], a[16:19], v[24:27]
    ds_read_b128 v[56:59], v1 offset:34816
    v_mfma_f32_16x16x32_bf16 v[28:31], v[108:111], a[16:19], v[28:31]
    ds_read_b128 v[60:63], v1 offset:35840
    s_waitcnt vmcnt(9) lgkmcnt(12)
    v_mfma_f32_16x16x32_bf16 v[16:19], v[112:115], a[20:23], v[16:19]
    ds_read_b128 v[64:67], v1 offset:36864
    buffer_load_dwordx4 a[60:63], v6, s[4:7], s26 offen offset:2048 sc1
    v_mfma_f32_16x16x32_bf16 v[20:23], v[116:119], a[20:23], v[20:23]
    ds_read_b128 v[68:71], v1 offset:37888
    v_mfma_f32_16x16x32_bf16 v[24:27], v[120:123], a[20:23], v[24:27]
    ds_read_b128 v[72:75], v1 offset:38912
    v_mfma_f32_16x16x32_bf16 v[28:31], v[124:127], a[20:23], v[28:31]
    ds_read_b128 v[76:79], v1 offset:39936
    s_waitcnt vmcnt(9) lgkmcnt(12)
    v_mfma_f32_16x16x32_bf16 v[16:19], v[128:131], a[24:27], v[16:19]
    ds_read_b128 v[80:83], v1 offset:40960
    v_mfma_f32_16x16x32_bf16 v[20:23], v[132:135], a[24:27], v[20:23]
    ds_read_b128 v[84:87], v1 offset:41984
    v_mfma_f32_16x16x32_bf16 v[24:27], v[136:139], a[24:27], v[24:27]
    ds_read_b128 v[88:91], v1 offset:43008
    v_mfma_f32_16x16x32_bf16 v[28:31], v[140:143], a[24:27], v[28:31]
    ds_read_b128 v[92:95], v1 offset:44032
    s_waitcnt vmcnt(8) lgkmcnt(12)
    v_mfma_f32_16x16x32_bf16 v[16:19], v[32:35], a[28:31], v[16:19]
    ds_read_b128 v[96:99], v1 offset:45056
    v_mfma_f32_16x16x32_bf16 v[20:23], v[36:39], a[28:31], v[20:23]
    ds_read_b128 v[100:103], v1 offset:46080
    v_mfma_f32_16x16x32_bf16 v[24:27], v[40:43], a[28:31], v[24:27]
    ds_read_b128 v[104:107], v1 offset:47104
    v_mfma_f32_16x16x32_bf16 v[28:31], v[44:47], a[28:31], v[28:31]
    ds_read_b128 v[108:111], v1 offset:48128
    s_waitcnt vmcnt(7) lgkmcnt(12)
    v_mfma_f32_16x16x32_bf16 v[16:19], v[48:51], a[32:35], v[16:19]
    ds_read_b128 v[112:115], v1 offset:49152
    v_mfma_f32_16x16x32_bf16 v[20:23], v[52:55], a[32:35], v[20:23]
    ds_read_b128 v[116:119], v1 offset:50176
    v_mfma_f32_16x16x32_bf16 v[24:27], v[56:59], a[32:35], v[24:27]
    ds_read_b128 v[120:123], v1 offset:51200
    v_mfma_f32_16x16x32_bf16 v[28:31], v[60:63], a[32:35], v[28:31]
    ds_read_b128 v[124:127], v1 offset:52224
    s_waitcnt vmcnt(6) lgkmcnt(12)
    v_mfma_f32_16x16x32_bf16 v[16:19], v[64:67], a[36:39], v[16:19]
    ds_read_b128 v[128:131], v1 offset:53248
    v_mfma_f32_16x16x32_bf16 v[20:23], v[68:71], a[36:39], v[20:23]
    ds_read_b128 v[132:135], v1 offset:54272
    v_mfma_f32_16x16x32_bf16 v[24:27], v[72:75], a[36:39], v[24:27]
    ds_read_b128 v[136:139], v1 offset:55296
    v_mfma_f32_16x16x32_bf16 v[28:31], v[76:79], a[36:39], v[28:31]
    ds_read_b128 v[140:143], v1 offset:56320
    s_waitcnt vmcnt(5) lgkmcnt(12)
    v_mfma_f32_16x16x32_bf16 v[16:19], v[80:83], a[40:43], v[16:19]
    ds_read_b128 v[32:35], v1 offset:57344
    v_mfma_f32_16x16x32_bf16 v[20:23], v[84:87], a[40:43], v[20:23]
    ds_read_b128 v[36:39], v1 offset:58368
    v_mfma_f32_16x16x32_bf16 v[24:27], v[88:91], a[40:43], v[24:27]
    ds_read_b128 v[40:43], v1 offset:59392
    v_mfma_f32_16x16x32_bf16 v[28:31], v[92:95], a[40:43], v[28:31]
    ds_read_b128 v[44:47], v1 offset:60416
    s_waitcnt vmcnt(4) lgkmcnt(12)
    v_mfma_f32_16x16x32_bf16 v[16:19], v[96:99], a[44:47], v[16:19]
    ds_read_b128 v[48:51], v1 offset:61440
    v_mfma_f32_16x16x32_bf16 v[20:23], v[100:103], a[44:47], v[20:23]
    ds_read_b128 v[52:55], v1 offset:62464
    v_mfma_f32_16x16x32_bf16 v[24:27], v[104:107], a[44:47], v[24:27]
    ds_read_b128 v[56:59], v1 offset:63488
    v_mfma_f32_16x16x32_bf16 v[28:31], v[108:111], a[44:47], v[28:31]
    ds_read_b128 v[60:63], v1 offset:64512
    s_waitcnt vmcnt(3) lgkmcnt(12)
    v_mfma_f32_16x16x32_bf16 v[16:19], v[112:115], a[48:51], v[16:19]
    v_mfma_f32_16x16x32_bf16 v[20:23], v[116:119], a[48:51], v[20:23]
    v_mfma_f32_16x16x32_bf16 v[24:27], v[120:123], a[48:51], v[24:27]
    v_mfma_f32_16x16x32_bf16 v[28:31], v[124:127], a[48:51], v[28:31]
    s_waitcnt vmcnt(2) lgkmcnt(8)
    v_mfma_f32_16x16x32_bf16 v[16:19], v[128:131], a[52:55], v[16:19]
    v_mfma_f32_16x16x32_bf16 v[20:23], v[132:135], a[52:55], v[20:23]
    v_mfma_f32_16x16x32_bf16 v[24:27], v[136:139], a[52:55], v[24:27]
    v_mfma_f32_16x16x32_bf16 v[28:31], v[140:143], a[52:55], v[28:31]
    s_waitcnt vmcnt(1) lgkmcnt(4)
    v_mfma_f32_16x16x32_bf16 v[16:19], v[32:35], a[56:59], v[16:19]
    v_mfma_f32_16x16x32_bf16 v[20:23], v[36:39], a[56:59], v[20:23]
    v_mfma_f32_16x16x32_bf16 v[24:27], v[40:43], a[56:59], v[24:27]
    v_mfma_f32_16x16x32_bf16 v[28:31], v[44:47], a[56:59], v[28:31]
    s_waitcnt vmcnt(0) lgkmcnt(0)
    v_mfma_f32_16x16x32_bf16 v[16:19], v[48:51], a[60:63], v[16:19]
    v_mfma_f32_16x16x32_bf16 v[20:23], v[52:55], a[60:63], v[20:23]
    v_mfma_f32_16x16x32_bf16 v[24:27], v[56:59], a[60:63], v[24:27]
    v_mfma_f32_16x16x32_bf16 v[28:31], v[60:63], a[60:63], v[28:31]
    s_barrier
    s_nop 6
    v_cvt_pk_bf16_f32 v248, v16, v17
    v_cvt_pk_bf16_f32 v249, v18, v19
    v_cvt_pk_bf16_f32 v250, v20, v21
    v_cvt_pk_bf16_f32 v251, v22, v23
    v_cvt_pk_bf16_f32 v252, v24, v25
    v_cvt_pk_bf16_f32 v253, v26, v27
    v_cvt_pk_bf16_f32 v254, v28, v29
    v_cvt_pk_bf16_f32 v255, v30, v31
    buffer_store_dwordx4 v[248:251], v6, s[4:7], s33 offen offset:0 sc1
    buffer_store_dwordx4 v[252:255], v6, s[4:7], s33 offen offset:2048 sc1
    v_pk_add_f32 v[8:9], v[16:17], v[18:19]
    v_pk_mul_f32 v[10:11], v[16:17], v[16:17]
    v_pk_fma_f32 v[10:11], v[18:19], v[18:19], v[10:11]
    v_pk_add_f32 v[8:9], v[8:9], v[20:21]
    v_pk_fma_f32 v[10:11], v[20:21], v[20:21], v[10:11]
    v_pk_add_f32 v[8:9], v[8:9], v[22:23]
    v_pk_fma_f32 v[10:11], v[22:23], v[22:23], v[10:11]
    v_pk_add_f32 v[8:9], v[8:9], v[24:25]
    v_pk_fma_f32 v[10:11], v[24:25], v[24:25], v[10:11]
    v_pk_add_f32 v[8:9], v[8:9], v[26:27]
    v_pk_fma_f32 v[10:11], v[26:27], v[26:27], v[10:11]
    v_pk_add_f32 v[8:9], v[8:9], v[28:29]
    v_pk_fma_f32 v[10:11], v[28:29], v[28:29], v[10:11]
    v_pk_add_f32 v[8:9], v[8:9], v[30:31]
    v_pk_fma_f32 v[10:11], v[30:31], v[30:31], v[10:11]
    v_add_f32 v8, v8, v9
    v_add_f32 v9, v10, v11
    s_nop 1
    v_permlane32_swap_b32 v8, v9
    s_nop 1
    v_add_f32 v8, v8, v9
    v_mov_b32 v9, v8
    s_nop 1
    v_permlane16_swap_b32 v8, v9
    s_nop 1
    v_add_f32 v8, v8, v9
    buffer_store_dword v8, v7, s[4:7], s32 offen sc1
    s_lshl_b32 s26, s56, 15
    s_add_u32 s26, s26, s48
    s_add_u32 s26, s26, 2097152
    s_lshl_b32 s27, s56, 8
    s_add_u32 s27, s27, s48
    s_add_u32 s27, s27, 4325376
    v_and_b32 v6, 31, v0
    v_lshlrev_b32 v6, 3, v6
    v_lshrrev_b32 v3, 5, v0
    v_lshl_add_u32 v6, v3, 16, v6
    s_mul_i32 s35, s58, 2048
    v_mul_u32_u24 v240, 128, v0
    s_add_u32 s35, s35, 60817408
    s_mul_i32 s39, s88, 768
    s_add_u32 s39, s39, s35
    s_add_u32 s39, s39, 33600
    s_and_b32 s23, s22, 15
    s_add_u32 s25, s39, s23
    s_cmp_eq_u32 s20, 0
    s_cselect_b32 s25, s25, 1073741824
    v_mov_b32 v241, 1
    ds_write_b128 v243, a[144:147] offset:0
    ds_write_b128 v243, a[148:151] offset:1024
    ds_write_b128 v243, a[152:155] offset:2048
    ds_write_b128 v243, a[156:159] offset:3072
    ds_write_b128 v243, a[160:163] offset:16384
    ds_write_b128 v243, a[164:167] offset:17408
    ds_write_b128 v243, a[168:171] offset:18432
    ds_write_b128 v243, a[172:175] offset:19456
    ds_write_b128 v243, a[176:179] offset:32768
    ds_write_b128 v243, a[180:183] offset:33792
    ds_write_b128 v243, a[184:187] offset:34816
    ds_write_b128 v243, a[188:191] offset:35840
    s_add_u32 s61, s61, 1
    s_waitcnt vmcnt(0)
    s_barrier
    s_mov_b64 exec, 7
    buffer_store_byte v241, v240, s[4:7], s25 offen
    s_mov_b64 exec, -1
    ds_write_b128 v243, a[192:195] offset:49152
    ds_write_b128 v243, a[196:199] offset:50176
    ds_write_b128 v243, a[200:203] offset:51200
    ds_write_b128 v243, a[204:207] offset:52224
    s_add_u32 s24, s39, 0
    s_load_dwordx4 s[80:83], s[4:5], s24
    s_waitcnt lgkmcnt(0)
    s_and_b64 s[80:81], s[80:81], s[82:83]
    s_and_b32 s80, s80, s81
    s_cmp_eq_u32 s80, 0x01010101
    s_cbranch_scc1 L_go5
    s_add_u32 s24, s39, 128
    s_load_dwordx4 s[80:83], s[4:5], s24
    s_waitcnt lgkmcnt(0)
    s_and_b64 s[80:81], s[80:81], s[82:83]
    s_and_b32 s80, s80, s81
    s_cmp_eq_u32 s80, 0x01010101
    s_cbranch_scc1 L_go5
    s_add_u32 s24, s39, 256
    s_load_dwordx4 s[80:83], s[4:5], s24
    s_waitcnt lgkmcnt(0)
    s_and_b64 s[80:81], s[80:81], s[82:83]
    s_and_b32 s80, s80, s81
    s_cmp_lg_u32 s80, 0x01010101
    s_cbranch_scc1 L_late6
L_back6:
L_go5:
    buffer_load_dwordx4 a[0:3], v1, s[4:7], s26 offen offset:0 sc1
    buffer_load_dwordx4 a[4:7], v1, s[4:7], s26 offen offset:1024 sc1
    buffer_load_dwordx4 a[8:11], v1, s[4:7], s26 offen offset:2048 sc1
    buffer_load_dwordx4 a[12:15], v1, s[4:7], s26 offen offset:3072 sc1
    s_add_u32 s26, s26, 4096
    buffer_load_dwordx4 a[16:19], v1, s[4:7], s26 offen offset:0 sc1
    buffer_load_dwordx4 a[20:23], v1, s[4:7], s26 offen offset:1024 sc1
    buffer_load_dwordx4 a[24:27], v1, s[4:7], s26 offen offset:2048 sc1
    buffer_load_dwordx4 a[28:31], v1, s[4:7], s26 offen offset:3072 sc1
    s_mul_i32 s30, s56, 114688
    s_add_u32 s30, s30, s48
    s_add_u32 s30, s30, 13631488
    s_and_b32 s23, s22, 15
    s_lshl_b32 s31, s23, 11
    s_add_u32 s31, s31, s30
    s_add_u32 s37, s31, 81920
    s_add_u32 s31, s31, 49152
    s_mul_i32 s23, s23, 3072
    s_add_u32 s30, s30, s23
    ds_read_b128 v[96:99], v4 offset:0
    ds_read_b128 v[100:103], v4 offset:1024
    ds_read_b128 v[104:107], v4 offset:2048
    ds_read_b128 v[108:111], v4 offset:3072
    ds_read_b128 v[112:115], v4 offset:4096
    ds_read_b128 v[116:119], v4 offset:5120
    s_waitcnt vmcnt(7) lgkmcnt(4)
    v_mfma_f32_32x32x16_bf16 v[32:47], v[96:99], a[0:3], 0
    ds_read_b128 v[120:123], v4 offset:6144
    s_add_u32 s26, s26, 4096
    buffer_load_dwordx4 a[32:35], v1, s[4:7], s26 offen offset:0 sc1
    v_mfma_f32_32x32x16_bf16 v[48:63], v[100:103], a[0:3], 0
    ds_read_b128 v[124:127], v4 offset:7168
    s_waitcnt vmcnt(7) lgkmcnt(4)
    v_mfma_f32_32x32x16_bf16 v[64:79], v[104:107], a[0:3], 0
    ds_read_b128 v[96:99], v4 offset:8192
    buffer_load_dwordx4 a[36:39], v1, s[4:7], s26 offen offset:1024 sc1
    v_mfma_f32_32x32x16_bf16 v[32:47], v[108:111], a[4:7], v[32:47]
    ds_read_b128 v[100:103], v4 offset:9216
    s_waitcnt lgkmcnt(4)
    buffer_load_dwordx2 v[8:9], v6, s[4:7], s27 offen sc1
    s_add_u32 s27, s27, 16384
    buffer_load_dwordx2 v[10:11], v6, s[4:7], s27 offen sc1
    v_mfma_f32_32x32x16_bf16 v[48:63], v[112:115], a[4:7], v[48:63]
    ds_read_b128 v[104:107], v4 offset:10240
    buffer_load_dwordx4 a[40:43], v1, s[4:7], s26 offen offset:2048 sc1
    s_add_u32 s27, s27, 16384
    buffer_load_dwordx2 v[12:13], v6, s[4:7], s27 offen sc1
    v_mfma_f32_32x32x16_bf16 v[64:79], v[116:119], a[4:7], v[64:79]
    ds_read_b128 v[108:111], v4 offset:11264
    s_waitcnt vmcnt(11) lgkmcnt(4)
    s_add_u32 s27, s27, 16384
    buffer_load_dwordx2 v[14:15], v6, s[4:7], s27 offen sc1
    v_mfma_f32_32x32x16_bf16 v[32:47], v[120:123], a[8:11], v[32:47]
    ds_read_b128 v[112:115], v4 offset:12288
    buffer_load_dwordx4 a[44:47], v1, s[4:7], s26 offen offset:3072 sc1
    v_mfma_f32_32x32x16_bf16 v[48:63], v[124:127], a[8:11], v[48:63]
    ds_read_b128 v[116:119], v4 offset:13312
    s_waitcnt vmcnt(12) lgkmcnt(4)
    v_mfma_f32_32x32x16_bf16 v[64:79], v[96:99], a[8:11], v[64:79]
    ds_read_b128 v[120:123], v4 offset:14336
    s_add_u32 s26, s26, 4096
    buffer_load_dwordx4 a[48:51], v1, s[4:7], s26 offen offset:0 sc1
    v_mfma_f32_32x32x16_bf16 v[32:47], v[100:103], a[12:15], v[32:47]
    ds_read_b128 v[124:127], v4 offset:15360
    s_waitcnt lgkmcnt(4)
    v_mfma_f32_32x32x16_bf16 v[48:63], v[104:107], a[12:15], v[48:63]
    ds_read_b128 v[96:99], v4 offset:16384
    buffer_load_dwordx4 a[52:55], v1, s[4:7], s26 offen offset:1024 sc1
    v_mfma_f32_32x32x16_bf16 v[64:79], v[108:111], a[12:15], v[64:79]
    ds_read_b128 v[100:103], v4 offset:17408
    s_waitcnt vmcnt(13) lgkmcnt(4)
    v_mfma_f32_32x32x16_bf16 v[32:47], v[112:115], a[16:19], v[32:47]
    ds_read_b128 v[104:107], v4 offset:18432
    buffer_load_dwordx4 a[56:59], v1, s[4:7], s26 offen offset:2048 sc1
    v_mfma_f32_32x32x16_bf16 v[48:63], v[116:119], a[16:19], v[48:63]
    ds_read_b128 v[108:111], v4 offset:19456
    s_waitcnt vmcnt(13) lgkmcnt(4)
    v_mfma_f32_32x32x16_bf16 v[64:79], v[120:123], a[16:19], v[64:79]
    ds_read_b128 v[112:115], v4 offset:20480
    v_mfma_f32_32x32x16_bf16 v[32:47], v[124:127], a[20:23], v[32:47]
    ds_read_b128 v[116:119], v4 offset:21504
    s_waitcnt lgkmcnt(4)
    buffer_load_dwordx4 a[60:63], v1, s[4:7], s26 offen offset:3072 sc1
    v_mfma_f32_32x32x16_bf16 v[48:63], v[96:99], a[20:23], v[48:63]
    ds_read_b128 v[120:123], v4 offset:22528
    v_mfma_f32_32x32x16_bf16 v[64:79], v[100:103], a[20:23], v[64:79]
    ds_read_b128 v[124:127], v4 offset:23552
    s_waitcnt vmcnt(13) lgkmcnt(4)
    v_mfma_f32_32x32x16_bf16 v[32:47], v[104:107], a[24:27], v[32:47]
    ds_read_b128 v[96:99], v4 offset:24576
    s_add_u32 s26, s26, 4096
    buffer_load_dwordx4 a[64:67], v1, s[4:7], s26 offen offset:0 sc1
    v_mfma_f32_32x32x16_bf16 v[48:63], v[108:111], a[24:27], v[48:63]
    ds_read_b128 v[100:103], v4 offset:25600
    s_waitcnt vmcnt(13) lgkmcnt(4)
    v_mfma_f32_32x32x16_bf16 v[64:79], v[112:115], a[24:27], v[64:79]
    ds_read_b128 v[104:107], v4 offset:26624
    v_mfma_f32_32x32x16_bf16 v[32:47], v[116:119], a[28:31], v[32:47]
    ds_read_b128 v[108:111], v4 offset:27648
    s_waitcnt lgkmcnt(4)
    buffer_load_dwordx4 a[68:71], v1, s[4:7], s26 offen offset:1024 sc1
    v_mfma_f32_32x32x16_bf16 v[48:63], v[120:123], a[28:31], v[48:63]
    ds_read_b128 v[112:115], v4 offset:28672
    v_mfma_f32_32x32x16_bf16 v[64:79], v[124:127], a[28:31], v[64:79]
    ds_read_b128 v[116:119], v4 offset:29696
    s_waitcnt vmcnt(13) lgkmcnt(4)
    v_mfma_f32_32x32x16_bf16 v[32:47], v[96:99], a[32:35], v[32:47]
    ds_read_b128 v[120:123], v4 offset:30720
    buffer_load_dwordx4 a[72:75], v1, s[4:7], s26 offen offset:2048 sc1
    v_mfma_f32_32x32x16_bf16 v[48:63], v[100:103], a[32:35], v[48:63]
    ds_read_b128 v[124:127], v4 offset:31744
    s_waitcnt vmcnt(13) lgkmcnt(4)
    v_mfma_f32_32x32x16_bf16 v[64:79], v[104:107], a[32:35], v[64:79]
    ds_read_b128 v[96:99], v4 offset:32768
    v_mfma_f32_32x32x16_bf16 v[32:47], v[108:111], a[36:39], v[32:47]
    ds_read_b128 v[100:103], v4 offset:33792
    s_waitcnt lgkmcnt(4)
    buffer_load_dwordx4 a[76:79], v1, s[4:7], s26 offen offset:3072 sc1
    v_mfma_f32_32x32x16_bf16 v[48:63], v[112:115], a[36:39], v[48:63]
    ds_read_b128 v[104:107], v4 offset:34816
    v_mfma_f32_32x32x16_bf16 v[64:79], v[116:119], a[36:39], v[64:79]
    ds_read_b128 v[108:111], v4 offset:35840
    s_waitcnt vmcnt(11) lgkmcnt(4)
    v_mfma_f32_32x32x16_bf16 v[32:47], v[120:123], a[40:43], v[32:47]
    ds_read_b128 v[112:115], v4 offset:36864
    s_add_u32 s26, s26, 4096
    buffer_load_dwordx4 a[80:83], v1, s[4:7], s26 offen offset:0 sc1
    s_waitcnt vmcnt(10)
    v_add_f32 v8, v8, v10
    v_mfma_f32_32x32x16_bf16 v[48:63], v[124:127], a[40:43], v[48:63]
    ds_read_b128 v[116:119], v4 offset:37888
    s_waitcnt vmcnt(9) lgkmcnt(4)
    v_add_f32 v9, v9, v11
    v_add_f32 v12, v12, v14
    v_add_f32 v13, v13, v15
    v_add_f32 v8, v8, v12
    v_mfma_f32_32x32x16_bf16 v[64:79], v[96:99], a[40:43], v[64:79]
    ds_read_b128 v[120:123], v4 offset:38912
    v_add_f32 v9, v9, v13
    v_mov_b32 v10, v8
    v_mov_b32 v11, v9
    s_nop 1
    v_mfma_f32_32x32x16_bf16 v[32:47], v[100:103], a[44:47], v[32:47]
    ds_read_b128 v[124:127], v4 offset:39936
    s_waitcnt lgkmcnt(4)
    buffer_load_dwordx4 a[84:87], v1, s[4:7], s26 offen offset:1024 sc1
    v_permlane32_swap_b32 v8, v10
    v_permlane32_swap_b32 v9, v11
    v_mfma_f32_32x32x16_bf16 v[48:63], v[104:107], a[44:47], v[48:63]
    ds_read_b128 v[96:99], v4 offset:40960
    s_nop 1
    v_add_f32 v8, v8, v10
    v_add_f32 v9, v9, v11
    v_mul_f32 v8, 0xbb000000, v8
    v_mfma_f32_32x32x16_bf16 v[64:79], v[108:111], a[44:47], v[64:79]
    ds_read_b128 v[100:103], v4 offset:41984
    s_waitcnt vmcnt(9) lgkmcnt(4)
    v_mul_f32 v9, 0x3b000000, v9
    v_fma_f32 v9, -v8, v8, v9
    v_max_f32 v9, 0, v9
    v_add_f32 v21, 0x3727c5ac, v9
    v_mfma_f32_32x32x16_bf16 v[32:47], v[112:115], a[48:51], v[32:47]
    ds_read_b128 v[104:107], v4 offset:43008
    buffer_load_dwordx4 a[88:91], v1, s[4:7], s26 offen offset:2048 sc1
    v_rsq_f32 v20, v21
    v_mov_b32 v10, 0
    v_mfma_f32_32x32x16_bf16 v[48:63], v[116:119], a[48:51], v[48:63]
    ds_read_b128 v[108:111], v4 offset:44032
    s_waitcnt vmcnt(9) lgkmcnt(4)
    v_cvt_pk_bf16_f32 v17, v8, v10
    v_lshlrev_b32 v11, 16, v17
    v_sub_f32 v11, v8, v11
    v_cvt_pk_bf16_f32 v16, v8, v11
    v_mfma_f32_32x32x16_bf16 v[64:79], v[120:123], a[48:51], v[64:79]
    ds_read_b128 v[112:115], v4 offset:45056
    v_mov_b32 v19, v17
    v_mov_b32 v18, v16
    v_mul_f32 v22, 0xbfb8aa3b, v20
    s_mul_i32 s35, s58, 2048
    s_add_u32 s35, s35, 60817408
    v_mfma_f32_32x32x16_bf16 v[32:47], v[124:127], a[52:55], v[32:47]
    ds_read_b128 v[116:119], v4 offset:46080
    s_waitcnt lgkmcnt(4)
    buffer_load_dwordx4 a[92:95], v1, s[4:7], s26 offen offset:3072 sc1
    s_add_u32 s36, s35, 32768
    s_cmp_eq_u32 s20, 1
    s_cselect_b32 s36, s36, 1073741824
    v_mfma_f32_32x32x16_bf16 v[48:63], v[96:99], a[52:55], v[48:63]
    ds_read_b128 v[120:123], v4 offset:47104
    v_and_b32 v240, 15, v0
    v_mul_u32_u24 v240, 128, v240
    v_and_b32 v6, 15, v0
    v_lshrrev_b32 v3, 4, v0
    v_lshlrev_b32 v6, 4, v6
    v_mfma_f32_32x32x16_bf16 v[64:79], v[100:103], a[52:55], v[64:79]
    ds_read_b128 v[124:127], v4 offset:48128
    s_waitcnt vmcnt(9) lgkmcnt(4)
    v_lshl_add_u32 v6, v3, 9, v6
    s_lshr_b32 s28, s57, 2
    s_mul_i32 s28, s28, 229376
    s_lshl_b32 s29, s20, 11
    v_mfma_f32_32x32x16_bf16 v[32:47], v[104:107], a[56:59], v[32:47]
    ds_read_b128 v[96:99], v4 offset:49152
    s_add_u32 s26, s26, 4096
    buffer_load_dwordx4 a[96:99], v1, s[4:7], s26 offen offset:0 sc1
    s_add_u32 s28, s28, s29
    s_add_u32 s28, s28, s48
    v_mfma_f32_32x32x16_bf16 v[48:63], v[108:111], a[56:59], v[48:63]
    ds_read_b128 v[100:103], v4 offset:50176
    s_waitcnt vmcnt(9) lgkmcnt(4)
    s_add_u32 s28, s28, 13631488
    s_add_u32 s29, s20, 1
    s_and_b32 s29, s29, 3
    s_mul_i32 s23, s29, 12288
    v_mfma_f32_32x32x16_bf16 v[64:79], v[112:115], a[56:59], v[64:79]
    ds_read_b128 v[104:107], v4 offset:51200
    s_add_u32 s23, s23, 0
    v_add_u32 v12, s23, v1
    s_lshr_b32 s23, s29, 1
    s_mul_i32 s23, s23, 114688
    s_and_b32 s29, s29, 1
    v_mfma_f32_32x32x16_bf16 v[32:47], v[116:119], a[60:63], v[32:47]
    ds_read_b128 v[108:111], v4 offset:52224
    s_waitcnt lgkmcnt(4)
    buffer_load_dwordx4 a[100:103], v1, s[4:7], s26 offen offset:1024 sc1
    s_lshl_b32 s29, s29, 8
    s_add_u32 s23, s23, s29
    v_mfma_f32_32x32x16_bf16 v[48:63], v[120:123], a[60:63], v[48:63]
    ds_read_b128 v[112:115], v4 offset:53248
    s_add_u32 s23, s23, s28
    v_add_u32 v8, s23, v6
    s_add_u32 s29, s20, 2
    s_and_b32 s29, s29, 3
    s_mul_i32 s23, s29, 12288
    v_mfma_f32_32x32x16_bf16 v[64:79], v[124:127], a[60:63], v[64:79]
    ds_read_b128 v[116:119], v4 offset:54272
    s_waitcnt vmcnt(9) lgkmcnt(4)
    s_add_u32 s23, s23, 4096
    v_add_u32 v13, s23, v1
    s_lshr_b32 s23, s29, 1
    s_mul_i32 s23, s23, 114688
    v_mfma_f32_32x32x16_bf16 v[32:47], v[96:99], a[64:67], v[32:47]
    ds_read_b128 v[120:123], v4 offset:55296
    buffer_load_dwordx4 a[104:107], v1, s[4:7], s26 offen offset:2048 sc1
    s_and_b32 s29, s29, 1
    s_lshl_b32 s29, s29, 8
    s_add_u32 s23, s23, s29
    v_mfma_f32_32x32x16_bf16 v[48:63], v[100:103], a[64:67], v[48:63]
    ds_read_b128 v[124:127], v4 offset:56320
    s_waitcnt vmcnt(9) lgkmcnt(4)
    s_add_u32 s23, s23, s28
    v_add_u32 v9, s23, v6
    s_add_u32 s29, s20, 3
    s_and_b32 s29, s29, 3
    v_mfma_f32_32x32x16_bf16 v[64:79], v[104:107], a[64:67], v[64:79]
    ds_read_b128 v[96:99], v4 offset:57344
    s_mul_i32 s23, s29, 12288
    s_add_u32 s23, s23, 8192
    v_add_u32 v14, s23, v1
    s_lshr_b32 s23, s29, 1
    s_mul_i32 s23, s23, 114688
    v_mfma_f32_32x32x16_bf16 v[32:47], v[108:111], a[68:71], v[32:47]
    ds_read_b128 v[100:103], v4 offset:58368
    s_waitcnt lgkmcnt(4)
    buffer_load_dwordx4 a[108:111], v1, s[4:7], s26 offen offset:3072 sc1
    s_and_b32 s29, s29, 1
    s_lshl_b32 s29, s29, 8
    v_mfma_f32_32x32x16_bf16 v[48:63], v[112:115], a[68:71], v[48:63]
    ds_read_b128 v[104:107], v4 offset:59392
    s_add_u32 s23, s23, s29
    s_add_u32 s23, s23, s28
    v_add_u32 v10, s23, v6
    s_add_u32 s29, s20, 4
    s_and_b32 s29, s29, 3
    v_mfma_f32_32x32x16_bf16 v[64:79], v[116:119], a[68:71], v[64:79]
    ds_read_b128 v[108:111], v4 offset:60416
    s_waitcnt vmcnt(9) lgkmcnt(4)
    s_mul_i32 s23, s29, 12288
    s_add_u32 s23, s23, 0
    v_add_u32 v15, s23, v1
    s_lshr_b32 s23, s29, 1
    v_mfma_f32_32x32x16_bf16 v[32:47], v[120:123], a[72:75], v[32:47]
    ds_read_b128 v[112:115], v4 offset:61440
    s_add_u32 s26, s26, 4096
    buffer_load_dwordx4 a[112:115], v1, s[4:7], s26 offen offset:0 sc1
    s_mul_i32 s23, s23, 114688
    s_and_b32 s29, s29, 1
    v_mfma_f32_32x32x16_bf16 v[48:63], v[124:127], a[72:75], v[48:63]
    ds_read_b128 v[116:119], v4 offset:62464
    s_waitcnt vmcnt(9) lgkmcnt(4)
    s_lshl_b32 s29, s29, 8
    s_add_u32 s23, s23, s29
    s_add_u32 s23, s23, s28
    v_add_u32 v11, s23, v6
    v_mfma_f32_32x32x16_bf16 v[64:79], v[96:99], a[72:75], v[64:79]
    ds_read_b128 v[120:123], v4 offset:63488
    s_mul_i32 s39, s88, 384
    s_add_u32 s39, s39, s35
    s_add_u32 s39, s39, 32832
    s_and_b32 s23, s22, 15
    s_add_u32 s25, s39, s23
    v_mfma_f32_32x32x16_bf16 v[32:47], v[100:103], a[76:79], v[32:47]
    ds_read_b128 v[124:127], v4 offset:64512
    s_waitcnt lgkmcnt(4)
    buffer_load_dwordx4 a[116:119], v1, s[4:7], s26 offen offset:1024 sc1
    s_cmp_eq_u32 s20, 0
    s_cselect_b32 s25, s25, 1073741824
    v_mov_b32 v241, 1
    v_mfma_f32_32x32x16_bf16 v[48:63], v[104:107], a[76:79], v[48:63]
    ds_read_b128 v[96:99], v5 offset:0
    s_add_u32 s38, s52, 114688
    s_lshr_b32 s33, s57, 1
    s_lshl_b32 s33, s33, 15
    s_and_b32 s23, s57, 1
    s_lshl_b32 s23, s23, 8
    v_mfma_f32_32x32x16_bf16 v[64:79], v[108:111], a[76:79], v[64:79]
    ds_read_b128 v[100:103], v5 offset:1024
    s_waitcnt vmcnt(9) lgkmcnt(4)
    s_add_u32 s33, s33, s23
    s_and_b32 s23, s22, 7
    s_lshl_b32 s23, s23, 12
    s_add_u32 s33, s33, s23
    v_mfma_f32_32x32x16_bf16 v[32:47], v[112:115], a[80:83], v[32:47]
    ds_read_b128 v[104:107], v5 offset:2048
    buffer_load_dwordx4 a[120:123], v1, s[4:7], s26 offen offset:2048 sc1
    s_add_u32 s33, s33, s48
    s_add_u32 s33, s33, 25165824
    s_and_b32 s32, s22, 7
    v_mfma_f32_32x32x16_bf16 v[48:63], v[116:119], a[80:83], v[48:63]
    ds_read_b128 v[108:111], v5 offset:3072
    s_waitcnt vmcnt(9) lgkmcnt(4)
    buffer_load_dwordx4 a[128:131], v1, s[4:7], s38 offen offset:0 sc1
    s_lshl_b32 s32, s32, 14
    s_lshl_b32 s23, s57, 7
    v_mfma_f32_32x32x16_bf16 v[64:79], v[120:123], a[80:83], v[64:79]
    ds_read_b128 v[112:115], v5 offset:4096
    s_add_u32 s32, s32, s23
    s_add_u32 s32, s32, s48
    s_add_u32 s32, s32, 29360128
    v_and_b32 v7, 15, v0
    v_lshlrev_b32 v7, 3, v7
    v_mfma_f32_32x32x16_bf16 v[32:47], v[124:127], a[84:87], v[32:47]
    ds_read_b128 v[116:119], v5 offset:5120
    s_waitcnt lgkmcnt(4)
    buffer_load_dwordx4 a[124:127], v1, s[4:7], s26 offen offset:3072 sc1
    v_lshrrev_b32 v3, 5, v0
    v_lshl_add_u32 v7, v3, 2, v7
    v_mfma_f32_32x32x16_bf16 v[48:63], v[96:99], a[84:87], v[48:63]
    ds_read_b128 v[120:123], v5 offset:6144
    buffer_load_dwordx4 a[132:135], v1, s[4:7], s38 offen offset:1024 sc1
    v_mfma_f32_32x32x16_bf16 v[64:79], v[100:103], a[84:87], v[64:79]
    ds_read_b128 v[124:127], v5 offset:7168
    s_waitcnt vmcnt(11) lgkmcnt(4)
    buffer_load_dwordx4 a[136:139], v1, s[4:7], s38 offen offset:2048 sc1
    v_mfma_f32_32x32x16_bf16 v[32:47], v[104:107], a[88:91], v[32:47]
    ds_read_b128 v[96:99], v5 offset:8192
    v_mfma_f32_32x32x16_bf16 v[48:63], v[108:111], a[88:91], v[48:63]
    ds_read_b128 v[100:103], v5 offset:9216
    s_waitcnt vmcnt(11) lgkmcnt(4)
    v_mfma_f32_32x32x16_bf16 v[64:79], v[112:115], a[88:91], v[64:79]
    ds_read_b128 v[104:107], v5 offset:10240
    buffer_load_dwordx4 a[140:143], v1, s[4:7], s38 offen offset:3072 sc1
    v_mfma_f32_32x32x16_bf16 v[32:47], v[116:119], a[92:95], v[32:47]
    ds_read_b128 v[108:111], v5 offset:11264
    s_waitcnt lgkmcnt(4)
    v_mfma_f32_32x32x16_bf16 v[48:63], v[120:123], a[92:95], v[48:63]
    ds_read_b128 v[112:115], v5 offset:12288
    s_add_u32 s38, s52, 131072
    v_mfma_f32_32x32x16_bf16 v[64:79], v[124:127], a[92:95], v[64:79]
    ds_read_b128 v[116:119], v5 offset:13312
    s_waitcnt vmcnt(11) lgkmcnt(4)
    v_mfma_f32_32x32x16_bf16 v[32:47], v[96:99], a[96:99], v[32:47]
    ds_read_b128 v[120:123], v5 offset:14336
    v_mfma_f32_32x32x16_bf16 v[48:63], v[100:103], a[96:99], v[48:63]
    ds_read_b128 v[124:127], v5 offset:15360
    s_waitcnt vmcnt(10) lgkmcnt(4)
    buffer_load_dwordx4 a[144:147], v1, s[4:7], s38 offen offset:0 sc1
    v_mfma_f32_32x32x16_bf16 v[64:79], v[104:107], a[96:99], v[64:79]
    ds_read_b128 v[96:99], v5 offset:16384
    v_mfma_f32_32x32x16_bf16 v[32:47], v[108:111], a[100:103], v[32:47]
    ds_read_b128 v[100:103], v5 offset:17408
    s_waitcnt lgkmcnt(4)
    buffer_load_dwordx4 a[148:151], v1, s[4:7], s38 offen offset:1024 sc1
    v_mfma_f32_32x32x16_bf16 v[48:63], v[112:115], a[100:103], v[48:63]
    ds_read_b128 v[104:107], v5 offset:18432
    v_mfma_f32_32x32x16_bf16 v[64:79], v[116:119], a[100:103], v[64:79]
    ds_read_b128 v[108:111], v5 offset:19456
    s_waitcnt vmcnt(11) lgkmcnt(4)
    v_mfma_f32_32x32x16_bf16 v[32:47], v[120:123], a[104:107], v[32:47]
    ds_read_b128 v[112:115], v5 offset:20480
    buffer_load_dwordx4 a[152:155], v1, s[4:7], s38 offen offset:2048 sc1
    v_mfma_f32_32x32x16_bf16 v[48:63], v[124:127], a[104:107], v[48:63]
    ds_read_b128 v[116:119], v5 offset:21504
    s_waitcnt vmcnt(11) lgkmcnt(4)
    v_mfma_f32_32x32x16_bf16 v[64:79], v[96:99], a[104:107], v[64:79]
    s_barrier
    ds_read_b128 v[120:123], v5 offset:22528
    v_mfma_f32_32x32x16_bf16 v[32:47], v[100:103], a[108:111], v[32:47]
    ds_read_b128 v[124:127], v5 offset:23552
    s_waitcnt lgkmcnt(4)
    s_add_u32 m0, s49, 65536
    s_add_u32 s54, s51, 163840
    v_mfma_f32_32x32x16_bf16 v[48:63], v[104:107], a[108:111], v[48:63]
    ds_read_b128 v[96:99], v5 offset:24576
    v_mfma_f32_32x32x16_bf16 v[64:79], v[108:111], a[108:111], v[64:79]
    ds_read_b128 v[100:103], v5 offset:25600
    s_waitcnt vmcnt(10) lgkmcnt(4)
    buffer_load_dwordx4 v1, s[4:7], s54 offen offset:0 sc1 lds
    v_mfma_f32_32x32x16_bf16 v[32:47], v[112:115], a[112:115], v[32:47]
    ds_read_b128 v[104:107], v5 offset:26624
    v_mfma_f32_32x32x16_bf16 v[48:63], v[116:119], a[112:115], v[48:63]
    ds_read_b128 v[108:111], v5 offset:27648
    s_waitcnt vmcnt(10) lgkmcnt(4)
    buffer_load_dwordx4 v1, s[4:7], s54 offen offset:1024 sc1 lds
    v_mfma_f32_32x32x16_bf16 v[64:79], v[120:123], a[112:115], v[64:79]
    ds_read_b128 v[112:115], v5 offset:28672
    v_mfma_f32_32x32x16_bf16 v[32:47], v[124:127], a[116:119], v[32:47]
    ds_read_b128 v[116:119], v5 offset:29696
    s_waitcnt lgkmcnt(4)
    buffer_load_dwordx4 v1, s[4:7], s54 offen offset:2048 sc1 lds
    v_mfma_f32_32x32x16_bf16 v[48:63], v[96:99], a[116:119], v[48:63]
    ds_read_b128 v[120:123], v5 offset:30720
    v_mfma_f32_32x32x16_bf16 v[64:79], v[100:103], a[116:119], v[64:79]
    ds_read_b128 v[124:127], v5 offset:31744
    s_waitcnt vmcnt(11) lgkmcnt(4)
    buffer_load_dwordx4 v1, s[4:7], s54 offen offset:3072 sc1 lds
    v_mfma_f32_32x32x16_bf16 v[32:47], v[104:107], a[120:123], v[32:47]
    ds_read_b128 v[96:99], v1 offset:0
    v_mfma_f32_32x32x16_bf16 v[48:63], v[108:111], a[120:123], v[48:63]
    ds_read_b128 v[100:103], v1 offset:1024
    s_waitcnt vmcnt(10) lgkmcnt(4)
    s_add_u32 m0, s49, 81920
    s_add_u32 s54, s51, 180224
    v_mfma_f32_32x32x16_bf16 v[64:79], v[112:115], a[120:123], v[64:79]
    ds_read_b128 v[104:107], v1 offset:2048
    v_mfma_f32_32x32x16_bf16 v[32:47], v[116:119], a[124:127], v[32:47]
    ds_read_b128 v[108:111], v1 offset:3072
    s_waitcnt lgkmcnt(4)
    buffer_load_dwordx4 v1, s[4:7], s54 offen offset:0 sc1 lds
    v_mfma_f32_32x32x16_bf16 v[48:63], v[120:123], a[124:127], v[48:63]
    ds_read_b128 v[112:115], v1 offset:4096
    v_mfma_f32_32x32x16_bf16 v[64:79], v[124:127], a[124:127], v[64:79]
    ds_read_b128 v[116:119], v1 offset:5120
    s_waitcnt lgkmcnt(4)
    buffer_load_dwordx4 v1, s[4:7], s54 offen offset:1024 sc1 lds
    v_mfma_f32_32x32x16_bf16 v[32:47], v[96:99], v[16:19], v[32:47]
    ds_read_b128 v[120:123], v1 offset:6144
    v_mfma_f32_32x32x16_bf16 v[48:63], v[100:103], v[16:19], v[48:63]
    ds_read_b128 v[124:127], v1 offset:7168
    s_waitcnt lgkmcnt(4)
    buffer_load_dwordx4 v1, s[4:7], s54 offen offset:2048 sc1 lds
    v_mfma_f32_32x32x16_bf16 v[64:79], v[104:107], v[16:19], v[64:79]
    ds_read_b128 v[96:99], v1 offset:8192
    v_mfma_f32_32x32x16_bf16 v[80:95], v[108:111], a[0:3], 0
    ds_read_b128 v[100:103], v1 offset:9216
    s_waitcnt lgkmcnt(4)
    buffer_load_dwordx4 v1, s[4:7], s54 offen offset:3072 sc1 lds
    v_mfma_f32_32x32x16_bf16 v[80:95], v[112:115], a[4:7], v[80:95]
    ds_read_b128 v[104:107], v1 offset:10240
    v_mfma_f32_32x32x16_bf16 v[80:95], v[116:119], a[8:11], v[80:95]
    ds_read_b128 v[108:111], v1 offset:11264
    s_waitcnt lgkmcnt(4)
    s_add_u32 m0, s49, 98304
    s_add_u32 s54, s51, 196608
    v_mfma_f32_32x32x16_bf16 v[80:95], v[120:123], a[12:15], v[80:95]
    ds_read_b128 v[112:115], v1 offset:12288
    v_mfma_f32_32x32x16_bf16 v[80:95], v[124:127], a[16:19], v[80:95]
    ds_read_b128 v[116:119], v1 offset:13312
    s_waitcnt lgkmcnt(4)
    buffer_load_dwordx4 v1, s[4:7], s54 offen offset:0 sc1 lds
    v_mul_f32 v128, v22, v32
    v_mul_f32 v129, v22, v33
    v_mfma_f32_32x32x16_bf16 v[80:95], v[96:99], a[20:23], v[80:95]
    ds_read_b128 v[120:123], v1 offset:14336
    v_mul_f32 v130, v22, v34
    v_mul_f32 v131, v22, v35
    v_exp_f32 v128, v128
    v_mul_f32 v32, v32, v40
    v_mfma_f32_32x32x16_bf16 v[80:95], v[100:103], a[24:27], v[80:95]
    ds_read_b128 v[124:127], v1 offset:15360
    s_waitcnt lgkmcnt(4)
    buffer_load_dwordx4 v1, s[4:7], s54 offen offset:1024 sc1 lds
    v_exp_f32 v129, v129
    v_mfma_f32_32x32x16_bf16 v[80:95], v[104:107], a[28:31], v[80:95]
    ds_read_b128 v[96:99], v1 offset:16384
    v_mul_f32 v33, v33, v41
    v_exp_f32 v130, v130
    v_mul_f32 v34, v34, v42
    v_mfma_f32_32x32x16_bf16 v[80:95], v[108:111], a[32:35], v[80:95]
    ds_read_b128 v[100:103], v1 offset:17408
    s_waitcnt lgkmcnt(4)
    buffer_load_dwordx4 v1, s[4:7], s54 offen offset:2048 sc1 lds
    v_exp_f32 v131, v131
    v_mfma_f32_32x32x16_bf16 v[80:95], v[112:115], a[36:39], v[80:95]
    ds_read_b128 v[104:107], v1 offset:18432
    v_mul_f32 v35, v35, v43
    v_fma_f32 v128, v128, v21, v21
    v_fma_f32 v129, v129, v21, v21
    v_fma_f32 v130, v130, v21, v21
    v_fma_f32 v131, v131, v21, v21
    v_mfma_f32_32x32x16_bf16 v[80:95], v[116:119], a[40:43], v[80:95]
    ds_read_b128 v[108:111], v1 offset:19456
    s_waitcnt lgkmcnt(4)
    buffer_load_dwordx4 v1, s[4:7], s54 offen offset:3072 sc1 lds
    v_rcp_f32 v128, v128
    v_mfma_f32_32x32x16_bf16 v[80:95], v[120:123], a[44:47], v[80:95]
    ds_read_b128 v[112:115], v1 offset:20480
    v_rcp_f32 v129, v129
    v_rcp_f32 v130, v130
    v_mfma_f32_32x32x16_bf16 v[80:95], v[124:127], a[48:51], v[80:95]
    ds_read_b128 v[116:119], v1 offset:21504
    s_waitcnt lgkmcnt(4)
    s_add_u32 m0, s49, 114688
    s_add_u32 s54, s51, 212992
    v_rcp_f32 v131, v131
    v_mfma_f32_32x32x16_bf16 v[80:95], v[96:99], a[52:55], v[80:95]
    ds_read_b128 v[120:123], v1 offset:22528
    v_mul_f32 v32, v32, v128
    v_mul_f32 v33, v33, v129
    v_mul_f32 v34, v34, v130
    v_mul_f32 v35, v35, v131
    v_mul_f32 v132, v22, v36
    v_mfma_f32_32x32x16_bf16 v[80:95], v[100:103], a[56:59], v[80:95]
    ds_read_b128 v[124:127], v1 offset:23552
    s_waitcnt lgkmcnt(4)
    buffer_load_dwordx4 v1, s[4:7], s54 offen offset:0 sc1 lds
    v_mul_f32 v133, v22, v37
    v_mul_f32 v134, v22, v38
    v_mfma_f32_32x32x16_bf16 v[80:95], v[104:107], a[60:63], v[80:95]
    ds_read_b128 v[96:99], v1 offset:24576
    v_mul_f32 v135, v22, v39
    v_exp_f32 v132, v132
    v_mul_f32 v36, v36, v44
    v_mfma_f32_32x32x16_bf16 v[80:95], v[108:111], a[64:67], v[80:95]
    ds_read_b128 v[100:103], v1 offset:25600
    s_waitcnt lgkmcnt(4)
    buffer_load_dwordx4 v1, s[4:7], s54 offen offset:1024 sc1 lds
    v_exp_f32 v133, v133
    v_mfma_f32_32x32x16_bf16 v[80:95], v[112:115], a[68:71], v[80:95]
    ds_read_b128 v[104:107], v1 offset:26624
    v_mul_f32 v37, v37, v45
    v_exp_f32 v134, v134
    v_mul_f32 v38, v38, v46
    v_mfma_f32_32x32x16_bf16 v[80:95], v[116:119], a[72:75], v[80:95]
    ds_read_b128 v[108:111], v1 offset:27648
    s_waitcnt lgkmcnt(4)
    buffer_load_dwordx4 v1, s[4:7], s54 offen offset:2048 sc1 lds
    v_exp_f32 v135, v135
    v_mfma_f32_32x32x16_bf16 v[80:95], v[120:123], a[76:79], v[80:95]
    ds_read_b128 v[112:115], v1 offset:28672
    v_mul_f32 v39, v39, v47
    v_fma_f32 v132, v132, v21, v21
    v_fma_f32 v133, v133, v21, v21
    v_fma_f32 v134, v134, v21, v21
    v_fma_f32 v135, v135, v21, v21
    v_mfma_f32_32x32x16_bf16 v[80:95], v[124:127], a[80:83], v[80:95]
    ds_read_b128 v[116:119], v1 offset:29696
    s_waitcnt lgkmcnt(4)
    buffer_load_dwordx4 v1, s[4:7], s54 offen offset:3072 sc1 lds
    v_rcp_f32 v132, v132
    v_mfma_f32_32x32x16_bf16 v[80:95], v[96:99], a[84:87], v[80:95]
    ds_read_b128 v[120:123], v1 offset:30720
    v_rcp_f32 v133, v133
    v_rcp_f32 v134, v134
    v_mfma_f32_32x32x16_bf16 v[80:95], v[100:103], a[88:91], v[80:95]
    ds_read_b128 v[124:127], v1 offset:31744
    s_waitcnt lgkmcnt(4)
    s_mul_i32 s54, s20, 2048
    s_add_u32 m0, s54, 131072
    s_sub_u32 s54, s54, s49
    s_add_u32 s54, s54, s51
    s_add_u32 s54, s54, 229376
    v_mfma_f32_32x32x16_bf16 v[80:95], v[104:107], a[92:95], v[80:95]
    ds_read_b128 v[96:99], v1 offset:32768
    v_rcp_f32 v135, v135
    v_mul_f32 v36, v36, v132
    v_mul_f32 v37, v37, v133
    v_mul_f32 v38, v38, v134
    v_mfma_f32_32x32x16_bf16 v[80:95], v[108:111], a[96:99], v[80:95]
    ds_read_b128 v[100:103], v1 offset:33792
    s_waitcnt lgkmcnt(4)
    buffer_load_dwordx4 v1, s[4:7], s54 offen offset:0 sc1 lds
    v_mul_f32 v39, v39, v135
    v_cvt_pk_bf16_f32 v24, v32, v33
    v_mfma_f32_32x32x16_bf16 v[80:95], v[112:115], a[100:103], v[80:95]
    ds_read_b128 v[104:107], v1 offset:34816
    v_cvt_pk_bf16_f32 v25, v34, v35
    v_cvt_pk_bf16_f32 v26, v36, v37
    v_cvt_pk_bf16_f32 v27, v38, v39
    buffer_store_dwordx4 v[24:27], v1, s[4:7], s30 offen offset:0 sc1
    v_mul_f32 v128, v22, v48
    v_mfma_f32_32x32x16_bf16 v[80:95], v[116:119], a[104:107], v[80:95]
    ds_read_b128 v[108:111], v1 offset:35840
    s_waitcnt lgkmcnt(4)
    buffer_load_dwordx4 v1, s[4:7], s54 offen offset:1024 sc1 lds
    v_mul_f32 v129, v22, v49
    v_mul_f32 v130, v22, v50
    v_mfma_f32_32x32x16_bf16 v[80:95], v[120:123], a[108:111], v[80:95]
    ds_read_b128 v[112:115], v1 offset:36864
    v_mul_f32 v131, v22, v51
    v_exp_f32 v128, v128
    v_mul_f32 v48, v48, v56
    v_mfma_f32_32x32x16_bf16 v[80:95], v[124:127], a[112:115], v[80:95]
    ds_read_b128 v[116:119], v1 offset:37888
    s_waitcnt lgkmcnt(4)
    buffer_load_dwordx4 a[156:159], v1, s[4:7], s38 offen offset:3072 sc1
    v_exp_f32 v129, v129
    v_mfma_f32_32x32x16_bf16 v[80:95], v[96:99], a[116:119], v[80:95]
    ds_read_b128 v[120:123], v1 offset:38912
    v_mul_f32 v49, v49, v57
    v_exp_f32 v130, v130
    v_mul_f32 v50, v50, v58
    v_mfma_f32_32x32x16_bf16 v[80:95], v[100:103], a[120:123], v[80:95]
    ds_read_b128 v[124:127], v1 offset:39936
    s_waitcnt lgkmcnt(4)
    v_exp_f32 v131, v131
    v_mul_f32 v51, v51, v59
    v_fma_f32 v128, v128, v21, v21
    v_mfma_f32_32x32x16_bf16 v[80:95], v[104:107], a[124:127], v[80:95]
    ds_read_b128 v[96:99], v1 offset:40960
    s_add_u32 s38, s52, 147456
    v_fma_f32 v129, v129, v21, v21
    v_fma_f32 v130, v130, v21, v21
    v_fma_f32 v131, v131, v21, v21
    v_mfma_f32_32x32x16_bf16 v[80:95], v[108:111], v[16:19], v[80:95]
    ds_read_b128 v[100:103], v1 offset:41984
    s_waitcnt lgkmcnt(4)
    v_rcp_f32 v128, v128
    v_rcp_f32 v129, v129
    v_mfma_f32_32x32x16_bf16 v[32:47], v[112:115], a[0:3], 0
    ds_read_b128 v[104:107], v1 offset:43008
    buffer_load_dwordx4 a[160:163], v1, s[4:7], s38 offen offset:0 sc1
    v_rcp_f32 v130, v130
    v_mfma_f32_32x32x16_bf16 v[32:47], v[116:119], a[4:7], v[32:47]
    ds_read_b128 v[108:111], v1 offset:44032
    s_waitcnt lgkmcnt(4)
    v_rcp_f32 v131, v131
    v_mul_f32 v48, v48, v128
    v_mul_f32 v49, v49, v129
    v_mfma_f32_32x32x16_bf16 v[32:47], v[120:123], a[8:11], v[32:47]
    ds_read_b128 v[112:115], v1 offset:45056
    v_mul_f32 v50, v50, v130
    v_mul_f32 v51, v51, v131
    v_mul_f32 v132, v22, v52
    v_mul_f32 v133, v22, v53
    v_mul_f32 v134, v22, v54
    v_mfma_f32_32x32x16_bf16 v[32:47], v[124:127], a[12:15], v[32:47]
    ds_read_b128 v[116:119], v1 offset:46080
    s_waitcnt lgkmcnt(4)
    buffer_load_dwordx4 a[164:167], v1, s[4:7], s38 offen offset:1024 sc1
    v_mul_f32 v135, v22, v55
    v_mfma_f32_32x32x16_bf16 v[32:47], v[96:99], a[16:19], v[32:47]
    ds_read_b128 v[120:123], v1 offset:47104
    v_exp_f32 v132, v132
    v_mul_f32 v52, v52, v60
    v_exp_f32 v133, v133
    v_mfma_f32_32x32x16_bf16 v[32:47], v[100:103], a[20:23], v[32:47]
    ds_read_b128 v[124:127], v1 offset:48128
    s_waitcnt lgkmcnt(4)
    v_mul_f32 v53, v53, v61
    v_exp_f32 v134, v134
    v_mul_f32 v54, v54, v62
    v_mfma_f32_32x32x16_bf16 v[32:47], v[104:107], a[24:27], v[32:47]
    ds_read_b128 v[96:99], v1 offset:49152
    buffer_load_dwordx4 a[168:171], v1, s[4:7], s38 offen offset:2048 sc1
    v_exp_f32 v135, v135
    v_mul_f32 v55, v55, v63
    v_mfma_f32_32x32x16_bf16 v[32:47], v[108:111], a[28:31], v[32:47]
    ds_read_b128 v[100:103], v1 offset:50176
    s_waitcnt lgkmcnt(4)
    v_fma_f32 v132, v132, v21, v21
    v_fma_f32 v133, v133, v21, v21
    v_fma_f32 v134, v134, v21, v21
    v_fma_f32 v135, v135, v21, v21
    v_mfma_f32_32x32x16_bf16 v[32:47], v[112:115], a[32:35], v[32:47]
    ds_read_b128 v[104:107], v1 offset:51200
    buffer_load_dwordx4 a[172:175], v1, s[4:7], s38 offen offset:3072 sc1
    v_rcp_f32 v132, v132
    v_mfma_f32_32x32x16_bf16 v[32:47], v[116:119], a[36:39], v[32:47]
    ds_read_b128 v[108:111], v1 offset:52224
    s_waitcnt lgkmcnt(4)
    v_rcp_f32 v133, v133
    v_rcp_f32 v134, v134
    v_mfma_f32_32x32x16_bf16 v[32:47], v[120:123], a[40:43], v[32:47]
    ds_read_b128 v[112:115], v1 offset:53248
    v_rcp_f32 v135, v135
    v_mul_f32 v52, v52, v132
    v_mul_f32 v53, v53, v133
    v_mul_f32 v54, v54, v134
    v_mfma_f32_32x32x16_bf16 v[32:47], v[124:127], a[44:47], v[32:47]
    ds_read_b128 v[116:119], v1 offset:54272
    s_waitcnt lgkmcnt(4)
    s_add_u32 s38, s52, 163840
    v_mul_f32 v55, v55, v135
    v_cvt_pk_bf16_f32 v28, v48, v49
    v_cvt_pk_bf16_f32 v29, v50, v51
    v_mfma_f32_32x32x16_bf16 v[32:47], v[96:99], a[48:51], v[32:47]
    ds_read_b128 v[120:123], v1 offset:55296
    v_cvt_pk_bf16_f32 v30, v52, v53
    v_cvt_pk_bf16_f32 v31, v54, v55
    buffer_store_dwordx4 v[28:31], v1, s[4:7], s30 offen offset:1024 sc1
    v_mul_f32 v128, v22, v64
    v_mul_f32 v129, v22, v65
    v_mfma_f32_32x32x16_bf16 v[32:47], v[100:103], a[52:55], v[32:47]
    ds_read_b128 v[124:127], v1 offset:56320
    s_waitcnt lgkmcnt(4)
    buffer_load_dwordx4 a[176:179], v1, s[4:7], s38 offen offset:0 sc1
    v_mul_f32 v130, v22, v66
    v_mul_f32 v131, v22, v67
    v_mfma_f32_32x32x16_bf16 v[32:47], v[104:107], a[56:59], v[32:47]
    ds_read_b128 v[96:99], v1 offset:57344
    v_exp_f32 v128, v128
    v_mul_f32 v64, v64, v72
    v_exp_f32 v129, v129
    v_mfma_f32_32x32x16_bf16 v[32:47], v[108:111], a[60:63], v[32:47]
    ds_read_b128 v[100:103], v1 offset:58368
    s_waitcnt lgkmcnt(4)
    v_mul_f32 v65, v65, v73
    v_exp_f32 v130, v130
    v_mul_f32 v66, v66, v74
    v_mfma_f32_32x32x16_bf16 v[32:47], v[112:115], a[64:67], v[32:47]
    ds_read_b128 v[104:107], v1 offset:59392
    buffer_load_dwordx4 a[180:183], v1, s[4:7], s38 offen offset:1024 sc1
    v_exp_f32 v131, v131
    v_mul_f32 v67, v67, v75
    v_mfma_f32_32x32x16_bf16 v[32:47], v[116:119], a[68:71], v[32:47]
    ds_read_b128 v[108:111], v1 offset:60416
    s_waitcnt lgkmcnt(4)
    v_fma_f32 v128, v128, v21, v21
    v_fma_f32 v129, v129, v21, v21
    v_fma_f32 v130, v130, v21, v21
    v_fma_f32 v131, v131, v21, v21
    v_mfma_f32_32x32x16_bf16 v[32:47], v[120:123], a[72:75], v[32:47]
    ds_read_b128 v[112:115], v1 offset:61440
    buffer_load_dwordx4 a[184:187], v1, s[4:7], s38 offen offset:2048 sc1
    v_rcp_f32 v128, v128
    v_mfma_f32_32x32x16_bf16 v[32:47], v[124:127], a[76:79], v[32:47]
    ds_read_b128 v[116:119], v1 offset:62464
    s_waitcnt lgkmcnt(4)
    v_rcp_f32 v129, v129
    v_rcp_f32 v130, v130
    v_mfma_f32_32x32x16_bf16 v[32:47], v[96:99], a[80:83], v[32:47]
    ds_read_b128 v[120:123], v1 offset:63488
    v_rcp_f32 v131, v131
    v_mul_f32 v64, v64, v128
    v_mul_f32 v65, v65, v129
    v_mul_f32 v66, v66, v130
    v_mfma_f32_32x32x16_bf16 v[32:47], v[100:103], a[84:87], v[32:47]
    ds_read_b128 v[124:127], v1 offset:64512
    s_waitcnt lgkmcnt(4)
    buffer_load_dwordx4 a[188:191], v1, s[4:7], s38 offen offset:3072 sc1
    v_mul_f32 v67, v67, v131
    v_mul_f32 v132, v22, v68
    v_mfma_f32_32x32x16_bf16 v[32:47], v[104:107], a[88:91], v[32:47]
    s_waitcnt vmcnt(17)
    s_barrier
    ds_read_b128 v[96:99], v4 offset:0
    v_mul_f32 v133, v22, v69
    v_mul_f32 v134, v22, v70
    v_mul_f32 v135, v22, v71
    v_mfma_f32_32x32x16_bf16 v[32:47], v[108:111], a[92:95], v[32:47]
    ds_read_b128 v[100:103], v4 offset:1024
    s_waitcnt lgkmcnt(4)
    s_add_u32 s38, s52, 180224
    v_exp_f32 v132, v132
    v_mul_f32 v68, v68, v76
    v_mfma_f32_32x32x16_bf16 v[32:47], v[112:115], a[96:99], v[32:47]
    ds_read_b128 v[104:107], v4 offset:2048
    v_exp_f32 v133, v133
    v_mul_f32 v69, v69, v77
    v_exp_f32 v134, v134
    v_mfma_f32_32x32x16_bf16 v[32:47], v[116:119], a[100:103], v[32:47]
    ds_read_b128 v[108:111], v4 offset:3072
    s_waitcnt lgkmcnt(4)
    v_mul_f32 v70, v70, v78
    v_exp_f32 v135, v135
    v_mul_f32 v71, v71, v79
    v_mfma_f32_32x32x16_bf16 v[32:47], v[120:123], a[104:107], v[32:47]
    ds_read_b128 v[112:115], v4 offset:4096
    buffer_load_dwordx4 a[192:195], v1, s[4:7], s38 offen offset:0 sc1
    v_fma_f32 v132, v132, v21, v21
    v_fma_f32 v133, v133, v21, v21
    v_fma_f32 v134, v134, v21, v21
    v_mfma_f32_32x32x16_bf16 v[32:47], v[124:127], a[108:111], v[32:47]
    ds_read_b128 v[116:119], v4 offset:5120
    s_waitcnt lgkmcnt(4)
    v_fma_f32 v135, v135, v21, v21
    v_rcp_f32 v132, v132
    v_mfma_f32_32x32x16_bf16 v[32:47], v[96:99], a[112:115], v[32:47]
    ds_read_b128 v[120:123], v4 offset:6144
    buffer_load_dwordx4 a[196:199], v1, s[4:7], s38 offen offset:1024 sc1
    v_rcp_f32 v133, v133
    v_mfma_f32_32x32x16_bf16 v[32:47], v[100:103], a[116:119], v[32:47]
    ds_read_b128 v[124:127], v4 offset:7168
    s_waitcnt lgkmcnt(4)
    v_rcp_f32 v134, v134
    v_rcp_f32 v135, v135
    v_mfma_f32_32x32x16_bf16 v[32:47], v[104:107], a[120:123], v[32:47]
    ds_read_b128 v[96:99], v4 offset:8192
    v_mul_f32 v68, v68, v132
    v_mul_f32 v69, v69, v133
    v_mul_f32 v70, v70, v134
    v_mul_f32 v71, v71, v135
    v_cvt_pk_bf16_f32 v136, v64, v65
    v_mfma_f32_32x32x16_bf16 v[32:47], v[108:111], a[124:127], v[32:47]
    ds_read_b128 v[100:103], v4 offset:9216
    s_waitcnt lgkmcnt(4)
    buffer_load_dwordx4 a[200:203], v1, s[4:7], s38 offen offset:2048 sc1
    v_cvt_pk_bf16_f32 v137, v66, v67
    v_cvt_pk_bf16_f32 v138, v68, v69
    v_mfma_f32_32x32x16_bf16 v[32:47], v[112:115], v[16:19], v[32:47]
    ds_read_b128 v[104:107], v4 offset:10240
    v_cvt_pk_bf16_f32 v139, v70, v71
    buffer_store_dwordx4 v[136:139], v1, s[4:7], s30 offen offset:2048 sc1
    v_mul_f32 v128, v22, v80
    v_mul_f32 v129, v22, v81
    v_mul_f32 v130, v22, v82
    v_mfma_f32_32x32x16_bf16 v[48:63], v[116:119], a[0:3], 0
    ds_read_b128 v[108:111], v4 offset:11264
    s_waitcnt lgkmcnt(4)
    v_mul_f32 v131, v22, v83
    v_exp_f32 v128, v128
    v_mul_f32 v80, v80, v88
    v_mfma_f32_32x32x16_bf16 v[48:63], v[120:123], a[4:7], v[48:63]
    ds_read_b128 v[112:115], v4 offset:12288
    buffer_load_dwordx4 a[204:207], v1, s[4:7], s38 offen offset:3072 sc1
    v_exp_f32 v129, v129
    v_mul_f32 v81, v81, v89
    v_mfma_f32_32x32x16_bf16 v[48:63], v[124:127], a[8:11], v[48:63]
    ds_read_b128 v[116:119], v4 offset:13312
    s_waitcnt lgkmcnt(4)
    v_exp_f32 v130, v130
    v_mul_f32 v82, v82, v90
    v_mfma_f32_32x32x16_bf16 v[48:63], v[96:99], a[12:15], v[48:63]
    ds_read_b128 v[120:123], v4 offset:14336
    s_add_u32 s38, s52, 196608
    v_exp_f32 v131, v131
    v_mul_f32 v83, v83, v91
    v_fma_f32 v128, v128, v21, v21
    v_mfma_f32_32x32x16_bf16 v[48:63], v[100:103], a[16:19], v[48:63]
    ds_read_b128 v[124:127], v4 offset:15360
    s_waitcnt lgkmcnt(4)
    v_fma_f32 v129, v129, v21, v21
    v_fma_f32 v130, v130, v21, v21
    v_fma_f32 v131, v131, v21, v21
    v_mfma_f32_32x32x16_bf16 v[48:63], v[104:107], a[20:23], v[48:63]
    ds_read_b128 v[96:99], v4 offset:16384
    v_rcp_f32 v128, v128
    v_rcp_f32 v129, v129
    v_mfma_f32_32x32x16_bf16 v[48:63], v[108:111], a[24:27], v[48:63]
    ds_read_b128 v[100:103], v4 offset:17408
    s_waitcnt lgkmcnt(4)
    buffer_load_dwordx4 v[208:211], v1, s[4:7], s38 offen offset:0 sc1
    v_rcp_f32 v130, v130
    v_mfma_f32_32x32x16_bf16 v[48:63], v[112:115], a[28:31], v[48:63]
    ds_read_b128 v[104:107], v4 offset:18432
    v_rcp_f32 v131, v131
    v_mul_f32 v80, v80, v128
    v_mul_f32 v81, v81, v129
    v_mul_f32 v82, v82, v130
    v_mfma_f32_32x32x16_bf16 v[48:63], v[116:119], a[32:35], v[48:63]
    ds_read_b128 v[108:111], v4 offset:19456
    s_waitcnt lgkmcnt(4)
    buffer_load_dwordx4 v[212:215], v1, s[4:7], s38 offen offset:1024 sc1
    v_mul_f32 v83, v83, v131
    v_mul_f32 v132, v22, v84
    v_mfma_f32_32x32x16_bf16 v[48:63], v[120:123], a[36:39], v[48:63]
    ds_read_b128 v[112:115], v4 offset:20480
    v_mul_f32 v133, v22, v85
    v_mul_f32 v134, v22, v86
    v_mul_f32 v135, v22, v87
    v_exp_f32 v132, v132
    v_mfma_f32_32x32x16_bf16 v[48:63], v[124:127], a[40:43], v[48:63]
    ds_read_b128 v[116:119], v4 offset:21504
    s_waitcnt lgkmcnt(4)
    v_mul_f32 v84, v84, v92
    v_exp_f32 v133, v133
    v_mul_f32 v85, v85, v93
    v_mfma_f32_32x32x16_bf16 v[48:63], v[96:99], a[44:47], v[48:63]
    ds_read_b128 v[120:123], v4 offset:22528
    buffer_load_dwordx4 v[216:219], v1, s[4:7], s38 offen offset:2048 sc1
    v_exp_f32 v134, v134
    v_mul_f32 v86, v86, v94
    v_mfma_f32_32x32x16_bf16 v[48:63], v[100:103], a[48:51], v[48:63]
    ds_read_b128 v[124:127], v4 offset:23552
    s_waitcnt lgkmcnt(4)
    v_exp_f32 v135, v135
    v_mul_f32 v87, v87, v95
    v_fma_f32 v132, v132, v21, v21
    v_mfma_f32_32x32x16_bf16 v[48:63], v[104:107], a[52:55], v[48:63]
    ds_read_b128 v[96:99], v4 offset:24576
    v_fma_f32 v133, v133, v21, v21
    v_fma_f32 v134, v134, v21, v21
    v_fma_f32 v135, v135, v21, v21
    v_rcp_f32 v132, v132
    v_mfma_f32_32x32x16_bf16 v[48:63], v[108:111], a[56:59], v[48:63]
    ds_read_b128 v[100:103], v4 offset:25600
    s_waitcnt lgkmcnt(4)
    v_rcp_f32 v133, v133
    v_rcp_f32 v134, v134
    v_mfma_f32_32x32x16_bf16 v[48:63], v[112:115], a[60:63], v[48:63]
    ds_read_b128 v[104:107], v4 offset:26624
    v_rcp_f32 v135, v135
    v_mul_f32 v84, v84, v132
    v_mul_f32 v85, v85, v133
    v_mul_f32 v86, v86, v134
    v_mfma_f32_32x32x16_bf16 v[48:63], v[116:119], a[64:67], v[48:63]
    ds_read_b128 v[108:111], v4 offset:27648
    s_waitcnt lgkmcnt(4)
    v_mul_f32 v87, v87, v135
    v_cvt_pk_bf16_f32 v140, v80, v81
    v_cvt_pk_bf16_f32 v141, v82, v83
    v_cvt_pk_bf16_f32 v142, v84, v85
    v_mfma_f32_32x32x16_bf16 v[48:63], v[120:123], a[68:71], v[48:63]
    ds_read_b128 v[112:115], v4 offset:28672
    v_cvt_pk_bf16_f32 v143, v86, v87
    v_mul_f32 v128, v22, v32
    v_mul_f32 v129, v22, v33
    v_mul_f32 v130, v22, v34
    v_mul_f32 v131, v22, v35
    v_mfma_f32_32x32x16_bf16 v[48:63], v[124:127], a[72:75], v[48:63]
    ds_read_b128 v[116:119], v4 offset:29696
    s_waitcnt lgkmcnt(4)
    v_exp_f32 v128, v128
    v_mul_f32 v32, v32, v40
    v_mfma_f32_32x32x16_bf16 v[48:63], v[96:99], a[76:79], v[48:63]
    ds_read_b128 v[120:123], v4 offset:30720
    v_exp_f32 v129, v129
    v_mul_f32 v33, v33, v41
    v_exp_f32 v130, v130
    v_mfma_f32_32x32x16_bf16 v[48:63], v[100:103], a[80:83], v[48:63]
    ds_read_b128 v[124:127], v4 offset:31744
    s_waitcnt lgkmcnt(4)
    v_mul_f32 v34, v34, v42
    v_exp_f32 v131, v131
    v_mul_f32 v35, v35, v43
    v_mfma_f32_32x32x16_bf16 v[48:63], v[104:107], a[84:87], v[48:63]
    ds_read_b128 v[96:99], v4 offset:32768
    v_fma_f32 v128, v128, v21, v21
    v_fma_f32 v129, v129, v21, v21
    v_fma_f32 v130, v130, v21, v21
    v_fma_f32 v131, v131, v21, v21
    v_mfma_f32_32x32x16_bf16 v[48:63], v[108:111], a[88:91], v[48:63]
    ds_read_b128 v[100:103], v4 offset:33792
    s_waitcnt lgkmcnt(4)
    v_rcp_f32 v128, v128
    v_rcp_f32 v129, v129
    v_mfma_f32_32x32x16_bf16 v[48:63], v[112:115], a[92:95], v[48:63]
    s_waitcnt vmcnt(18)
    s_add_u32 s61, s61, 1
    s_waitcnt vmcnt(4)
    s_barrier
    s_mov_b64 exec, 1
    buffer_store_byte v241, off, s[4:7], s25 offset:0
    s_mov_b64 exec, -1
    buffer_store_dwordx4 v[140:143], v1, s[4:7], s31 offen offset:0 sc1
    ds_read_b128 v[104:107], v4 offset:34816
    v_mfma_f32_32x32x16_bf16 v[48:63], v[116:119], a[96:99], v[48:63]
    ds_read_b128 v[108:111], v4 offset:35840
    s_waitcnt lgkmcnt(4)
    v_rcp_f32 v130, v130
    v_rcp_f32 v131, v131
    v_mfma_f32_32x32x16_bf16 v[48:63], v[120:123], a[100:103], v[48:63]
    ds_read_b128 v[112:115], v4 offset:36864
    buffer_load_dwordx4 v[220:223], v1, s[4:7], s38 offen offset:3072 sc1
    v_mul_f32 v32, v32, v128
    v_mul_f32 v33, v33, v129
    v_mul_f32 v34, v34, v130
    v_mfma_f32_32x32x16_bf16 v[48:63], v[124:127], a[104:107], v[48:63]
    ds_read_b128 v[116:119], v4 offset:37888
    s_waitcnt lgkmcnt(4)
    v_mul_f32 v35, v35, v131
    v_mul_f32 v132, v22, v36
    v_mul_f32 v133, v22, v37
    v_mul_f32 v134, v22, v38
    v_mfma_f32_32x32x16_bf16 v[48:63], v[96:99], a[108:111], v[48:63]
    ds_read_b128 v[120:123], v4 offset:38912
    v_mul_f32 v135, v22, v39
    v_exp_f32 v132, v132
    v_mul_f32 v36, v36, v44
    v_mfma_f32_32x32x16_bf16 v[48:63], v[100:103], a[112:115], v[48:63]
    ds_read_b128 v[124:127], v4 offset:39936
    s_waitcnt lgkmcnt(4)
    s_add_u32 s38, s52, 212992
    v_exp_f32 v133, v133
    v_mul_f32 v37, v37, v45
    v_mfma_f32_32x32x16_bf16 v[48:63], v[104:107], a[116:119], v[48:63]
    ds_read_b128 v[96:99], v4 offset:40960
    v_exp_f32 v134, v134
    v_mul_f32 v38, v38, v46
    v_exp_f32 v135, v135
    v_mfma_f32_32x32x16_bf16 v[48:63], v[108:111], a[120:123], v[48:63]
    ds_read_b128 v[100:103], v4 offset:41984
    s_waitcnt lgkmcnt(4)
    buffer_load_dwordx4 v[224:227], v1, s[4:7], s38 offen offset:0 sc1
    v_mul_f32 v39, v39, v47
    v_fma_f32 v132, v132, v21, v21
    v_mfma_f32_32x32x16_bf16 v[48:63], v[112:115], a[124:127], v[48:63]
    ds_read_b128 v[104:107], v4 offset:43008
    v_fma_f32 v133, v133, v21, v21
    v_fma_f32 v134, v134, v21, v21
    v_fma_f32 v135, v135, v21, v21
    v_rcp_f32 v132, v132
    v_mfma_f32_32x32x16_bf16 v[48:63], v[116:119], v[16:19], v[48:63]
    ds_read_b128 v[108:111], v4 offset:44032
    s_waitcnt lgkmcnt(4)
    v_rcp_f32 v133, v133
    v_rcp_f32 v134, v134
    v_mfma_f32_32x32x16_bf16 v[64:79], v[120:123], a[0:3], 0
    ds_read_b128 v[112:115], v4 offset:45056
    buffer_load_dwordx4 v[228:231], v1, s[4:7], s38 offen offset:1024 sc1
    v_rcp_f32 v135, v135
    v_mul_f32 v36, v36, v132
    v_mfma_f32_32x32x16_bf16 v[64:79], v[124:127], a[4:7], v[64:79]
    ds_read_b128 v[116:119], v4 offset:46080
    s_waitcnt lgkmcnt(4)
    v_mul_f32 v37, v37, v133
    v_mul_f32 v38, v38, v134
    v_mul_f32 v39, v39, v135
    v_cvt_pk_bf16_f32 v24, v32, v33
    v_mfma_f32_32x32x16_bf16 v[64:79], v[96:99], a[8:11], v[64:79]
    ds_read_b128 v[120:123], v4 offset:47104
    buffer_load_dwordx4 v[232:235], v1, s[4:7], s38 offen offset:2048 sc1
    v_cvt_pk_bf16_f32 v25, v34, v35
    v_cvt_pk_bf16_f32 v26, v36, v37
    v_cvt_pk_bf16_f32 v27, v38, v39
    v_mfma_f32_32x32x16_bf16 v[64:79], v[100:103], a[12:15], v[64:79]
    ds_read_b128 v[124:127], v4 offset:48128
    s_waitcnt lgkmcnt(4)
    buffer_store_dwordx4 v[24:27], v1, s[4:7], s31 offen offset:1024 sc1
    v_mfma_f32_32x32x16_bf16 v[64:79], v[104:107], a[16:19], v[64:79]
    ds_read_b128 v[96:99], v4 offset:49152
    v_mfma_f32_32x32x16_bf16 v[64:79], v[108:111], a[20:23], v[64:79]
    ds_read_b128 v[100:103], v4 offset:50176
    s_waitcnt lgkmcnt(4)
    buffer_load_dwordx4 v[236:239], v1, s[4:7], s38 offen offset:3072 sc1
    v_mfma_f32_32x32x16_bf16 v[64:79], v[112:115], a[24:27], v[64:79]
    ds_read_b128 v[104:107], v4 offset:51200
    v_mul_f32 v128, v22, v48
    v_mul_f32 v129, v22, v49
    v_mul_f32 v130, v22, v50
    v_mul_f32 v131, v22, v51
    v_mfma_f32_32x32x16_bf16 v[64:79], v[116:119], a[28:31], v[64:79]
    ds_read_b128 v[108:111], v4 offset:52224
    s_waitcnt lgkmcnt(4)
    v_exp_f32 v128, v128
    v_mul_f32 v48, v48, v56
    v_mfma_f32_32x32x16_bf16 v[64:79], v[120:123], a[32:35], v[64:79]
    ds_read_b128 v[112:115], v4 offset:53248
    v_exp_f32 v129, v129
    v_mul_f32 v49, v49, v57
    v_exp_f32 v130, v130
    v_mfma_f32_32x32x16_bf16 v[64:79], v[124:127], a[36:39], v[64:79]
    ds_read_b128 v[116:119], v4 offset:54272
    s_waitcnt lgkmcnt(4)
    s_add_u32 s24, s39, 0
    s_load_dwordx4 s[80:83], s[4:5], s24
    v_mul_f32 v50, v50, v58
    v_mfma_f32_32x32x16_bf16 v[64:79], v[96:99], a[40:43], v[64:79]
    ds_read_b128 v[120:123], v4 offset:55296
    v_exp_f32 v131, v131
    v_mul_f32 v51, v51, v59
    v_fma_f32 v128, v128, v21, v21
    v_fma_f32 v129, v129, v21, v21
    v_mfma_f32_32x32x16_bf16 v[64:79], v[100:103], a[44:47], v[64:79]
    ds_read_b128 v[124:127], v4 offset:56320
    s_waitcnt lgkmcnt(4)
    v_fma_f32 v130, v130, v21, v21
    v_fma_f32 v131, v131, v21, v21
    v_rcp_f32 v128, v128
    v_mfma_f32_32x32x16_bf16 v[64:79], v[104:107], a[48:51], v[64:79]
    ds_read_b128 v[96:99], v4 offset:57344
    v_rcp_f32 v129, v129
    v_rcp_f32 v130, v130
    v_mfma_f32_32x32x16_bf16 v[64:79], v[108:111], a[52:55], v[64:79]
    ds_read_b128 v[100:103], v4 offset:58368
    s_waitcnt lgkmcnt(4)
    v_rcp_f32 v131, v131
    v_mul_f32 v48, v48, v128
    v_mul_f32 v49, v49, v129
    v_mfma_f32_32x32x16_bf16 v[64:79], v[112:115], a[56:59], v[64:79]
    ds_read_b128 v[104:107], v4 offset:59392
    s_waitcnt lgkmcnt(0)
    s_and_b64 s[80:81], s[80:81], s[82:83]
    s_and_b32 s80, s80, s81
    s_cmp_lg_u32 s80, 0x01010101
    s_cbranch_scc1 L_late7
L_back7:
    v_mfma_f32_32x32x16_bf16 v[64:79], v[116:119], a[60:63], v[64:79]
    ds_read_b128 v[108:111], v4 offset:60416
    s_mov_b32 s26, 0
    buffer_load_dwordx4 a[0:3], v8, s[4:7], s26 offen sc1
    v_mul_f32 v50, v50, v130
    v_mul_f32 v51, v51, v131
    v_mfma_f32_32x32x16_bf16 v[64:79], v[120:123], a[64:67], v[64:79]
    ds_read_b128 v[112:115], v4 offset:61440
    v_mul_f32 v132, v22, v52
    v_mul_f32 v133, v22, v53
    v_mul_f32 v134, v22, v54
    v_mul_f32 v135, v22, v55
    v_mfma_f32_32x32x16_bf16 v[64:79], v[124:127], a[68:71], v[64:79]
    ds_read_b128 v[116:119], v4 offset:62464
    buffer_load_dwordx4 a[4:7], v9, s[4:7], s26 offen sc1
    v_exp_f32 v132, v132
    v_mul_f32 v52, v52, v60
    v_mfma_f32_32x32x16_bf16 v[64:79], v[96:99], a[72:75], v[64:79]
    ds_read_b128 v[120:123], v4 offset:63488
    v_exp_f32 v133, v133
    v_mul_f32 v53, v53, v61
    v_exp_f32 v134, v134
    v_mfma_f32_32x32x16_bf16 v[64:79], v[100:103], a[76:79], v[64:79]
    ds_read_b128 v[124:127], v4 offset:64512
    s_waitcnt lgkmcnt(4)
    buffer_load_dwordx4 a[8:11], v10, s[4:7], s26 offen sc1
    v_mul_f32 v54, v54, v62
    v_mfma_f32_32x32x16_bf16 v[64:79], v[104:107], a[80:83], v[64:79]
    ds_read_b128 v[96:99], v5 offset:0
    v_exp_f32 v135, v135
    v_mul_f32 v55, v55, v63
    v_fma_f32 v132, v132, v21, v21
    v_fma_f32 v133, v133, v21, v21
    v_mfma_f32_32x32x16_bf16 v[64:79], v[108:111], a[84:87], v[64:79]
    ds_read_b128 v[100:103], v5 offset:1024
    s_waitcnt lgkmcnt(4)
    buffer_load_dwordx4 a[12:15], v11, s[4:7], s26 offen sc1
    v_fma_f32 v134, v134, v21, v21
    v_fma_f32 v135, v135, v21, v21
    v_mfma_f32_32x32x16_bf16 v[64:79], v[112:115], a[88:91], v[64:79]
    ds_read_b128 v[104:107], v5 offset:2048
    v_rcp_f32 v132, v132
    v_rcp_f32 v133, v133
    v_mfma_f32_32x32x16_bf16 v[64:79], v[116:119], a[92:95], v[64:79]
    ds_read_b128 v[108:111], v5 offset:3072
    s_waitcnt lgkmcnt(4)
    s_mov_b32 s26, 8192
    buffer_load_dwordx4 a[16:19], v8, s[4:7], s26 offen sc1
    v_mfma_f32_32x32x16_bf16 v[64:79], v[120:123], a[96:99], v[64:79]
    ds_read_b128 v[112:115], v5 offset:4096
    v_rcp_f32 v134, v134
    v_rcp_f32 v135, v135
    v_mul_f32 v52, v52, v132
    v_mfma_f32_32x32x16_bf16 v[64:79], v[124:127], a[100:103], v[64:79]
    ds_read_b128 v[116:119], v5 offset:5120
    s_waitcnt lgkmcnt(4)
    buffer_load_dwordx4 a[20:23], v9, s[4:7], s26 offen sc1
    v_mul_f32 v53, v53, v133
    v_mul_f32 v54, v54, v134
    v_mfma_f32_32x32x16_bf16 v[64:79], v[96:99], a[104:107], v[64:79]
    ds_read_b128 v[120:123], v5 offset:6144
    v_mul_f32 v55, v55, v135
    v_cvt_pk_bf16_f32 v28, v48, v49
    v_cvt_pk_bf16_f32 v29, v50, v51
    v_cvt_pk_bf16_f32 v30, v52, v53
    v_cvt_pk_bf16_f32 v31, v54, v55
    v_mfma_f32_32x32x16_bf16 v[64:79], v[100:103], a[108:111], v[64:79]
    s_waitcnt lgkmcnt(3)
    buffer_load_dwordx4 a[24:27], v10, s[4:7], s26 offen sc1
    v_mfma_f32_32x32x16_bf16 v[64:79], v[104:107], a[112:115], v[64:79]
    v_mfma_f32_32x32x16_bf16 v[64:79], v[108:111], a[116:119], v[64:79]
    s_waitcnt lgkmcnt(1)
    buffer_load_dwordx4 a[28:31], v11, s[4:7], s26 offen sc1
    v_mfma_f32_32x32x16_bf16 v[64:79], v[112:115], a[120:123], v[64:79]
    v_mfma_f32_32x32x16_bf16 v[64:79], v[116:119], a[124:127], v[64:79]
    s_waitcnt lgkmcnt(0)
    s_mov_b32 s26, 16384
    buffer_load_dwordx4 a[32:35], v8, s[4:7], s26 offen sc1
    v_mfma_f32_32x32x16_bf16 v[64:79], v[120:123], v[16:19], v[64:79]
    s_add_u32 s61, s61, 1
    s_waitcnt vmcnt(10)
    s_barrier
    s_mov_b64 exec, 1
    buffer_store_byte v241, off, s[4:7], s25 offset:128
    s_mov_b64 exec, -1
    s_nop 6
    v_mul_f32 v128, v22, v64
    v_mul_f32 v129, v22, v65
    v_mul_f32 v130, v22, v66
    v_mul_f32 v131, v22, v67
    v_exp_f32 v128, v128
    v_mul_f32 v64, v64, v72
    v_exp_f32 v129, v129
    v_mul_f32 v65, v65, v73
    v_exp_f32 v130, v130
    v_mul_f32 v66, v66, v74
    v_exp_f32 v131, v131
    v_mul_f32 v67, v67, v75
    v_fma_f32 v128, v128, v21, v21
    v_fma_f32 v129, v129, v21, v21
    v_fma_f32 v130, v130, v21, v21
    v_fma_f32 v131, v131, v21, v21
    v_rcp_f32 v128, v128
    v_rcp_f32 v129, v129
    buffer_load_dwordx4 a[36:39], v9, s[4:7], s26 offen sc1
    v_rcp_f32 v130, v130
    v_rcp_f32 v131, v131
    v_mul_f32 v64, v64, v128
    v_mul_f32 v65, v65, v129
    v_mul_f32 v66, v66, v130
    v_mul_f32 v67, v67, v131
    v_mul_f32 v132, v22, v68
    v_mul_f32 v133, v22, v69
    v_mul_f32 v134, v22, v70
    v_mul_f32 v135, v22, v71
    v_exp_f32 v132, v132
    v_mul_f32 v68, v68, v76
    v_exp_f32 v133, v133
    v_mul_f32 v69, v69, v77
    v_exp_f32 v134, v134
    v_mul_f32 v70, v70, v78
    v_exp_f32 v135, v135
    v_mul_f32 v71, v71, v79
    buffer_load_dwordx4 a[40:43], v10, s[4:7], s26 offen sc1
    v_fma_f32 v132, v132, v21, v21
    v_fma_f32 v133, v133, v21, v21
    v_fma_f32 v134, v134, v21, v21
    v_fma_f32 v135, v135, v21, v21
    v_rcp_f32 v132, v132
    v_rcp_f32 v133, v133
    v_rcp_f32 v134, v134
    v_rcp_f32 v135, v135
    v_mul_f32 v68, v68, v132
    v_mul_f32 v69, v69, v133
    v_mul_f32 v70, v70, v134
    v_mul_f32 v71, v71, v135
    v_cvt_pk_bf16_f32 v136, v64, v65
    v_cvt_pk_bf16_f32 v137, v66, v67
    v_cvt_pk_bf16_f32 v138, v68, v69
    v_cvt_pk_bf16_f32 v139, v70, v71
    buffer_store_dwordx4 v[28:31], v1, s[4:7], s37 offen offset:0 sc1
    buffer_store_dwordx4 v[136:139], v1, s[4:7], s37 offen offset:1024 sc1
    s_waitcnt vmcnt(13)
    v_mfma_f32_16x16x32_bf16 v[32:35], a[208:211], a[0:3], 0
    buffer_load_dwordx4 a[44:47], v11, s[4:7], s26 offen sc1
    v_lshlrev_b32 v16, 16, v248
    v_and_b32 v17, 0xffff0000, v248
    v_mfma_f32_16x16x32_bf16 v[36:39], a[212:215], a[0:3], 0
    v_lshlrev_b32 v18, 16, v249
    v_and_b32 v19, 0xffff0000, v249
    v_mfma_f32_16x16x32_bf16 v[40:43], a[216:219], a[0:3], 0
    s_mov_b32 s26, 24576
    buffer_load_dwordx4 a[48:51], v8, s[4:7], s26 offen sc1
    v_lshlrev_b32 v20, 16, v250
    v_and_b32 v21, 0xffff0000, v250
    v_mfma_f32_16x16x32_bf16 v[44:47], a[220:223], a[0:3], 0
    v_lshlrev_b32 v22, 16, v251
    v_and_b32 v23, 0xffff0000, v251
    s_waitcnt vmcnt(14)
    v_mfma_f32_16x16x32_bf16 v[48:51], a[208:211], a[4:7], 0
    buffer_load_dwordx4 a[52:55], v9, s[4:7], s26 offen sc1
    v_lshlrev_b32 v24, 16, v252
    v_and_b32 v25, 0xffff0000, v252
    v_mfma_f32_16x16x32_bf16 v[52:55], a[212:215], a[4:7], 0
    v_lshlrev_b32 v26, 16, v253
    v_and_b32 v27, 0xffff0000, v253
    v_mfma_f32_16x16x32_bf16 v[56:59], a[216:219], a[4:7], 0
    v_lshlrev_b32 v28, 16, v254
    v_and_b32 v29, 0xffff0000, v254
    v_mfma_f32_16x16x32_bf16 v[60:63], a[220:223], a[4:7], 0
    v_lshlrev_b32 v30, 16, v255
    v_and_b32 v31, 0xffff0000, v255
    s_waitcnt vmcnt(14)
    v_mfma_f32_16x16x32_bf16 v[64:67], a[208:211], a[8:11], 0
    buffer_load_dwordx4 a[56:59], v10, s[4:7], s26 offen sc1
    v_mfma_f32_16x16x32_bf16 v[68:71], a[212:215], a[8:11], 0
    v_mfma_f32_16x16x32_bf16 v[72:75], a[216:219], a[8:11], 0
    v_mfma_f32_16x16x32_bf16 v[76:79], a[220:223], a[8:11], 0
    s_waitcnt vmcnt(14)
    v_mfma_f32_16x16x32_bf16 v[16:19], a[208:211], a[12:15], v[16:19]
    buffer_load_dwordx4 a[60:63], v11, s[4:7], s26 offen sc1
    v_mfma_f32_16x16x32_bf16 v[20:23], a[212:215], a[12:15], v[20:23]
    v_mfma_f32_16x16x32_bf16 v[24:27], a[216:219], a[12:15], v[24:27]
    v_mfma_f32_16x16x32_bf16 v[28:31], a[220:223], a[12:15], v[28:31]
    s_waitcnt vmcnt(14)
    v_mfma_f32_16x16x32_bf16 v[32:35], a[224:227], a[16:19], v[32:35]
    s_mov_b32 s26, 32768
    buffer_load_dwordx4 a[64:67], v8, s[4:7], s26 offen sc1
    v_mfma_f32_16x16x32_bf16 v[36:39], a[228:231], a[16:19], v[36:39]
    v_mfma_f32_16x16x32_bf16 v[40:43], a[232:235], a[16:19], v[40:43]
    v_mfma_f32_16x16x32_bf16 v[44:47], a[236:239], a[16:19], v[44:47]
    s_waitcnt vmcnt(14)
    v_mfma_f32_16x16x32_bf16 v[48:51], a[224:227], a[20:23], v[48:51]
    buffer_load_dwordx4 a[68:71], v9, s[4:7], s26 offen sc1
    v_mfma_f32_16x16x32_bf16 v[52:55], a[228:231], a[20:23], v[52:55]
    v_mfma_f32_16x16x32_bf16 v[56:59], a[232:235], a[20:23], v[56:59]
    v_mfma_f32_16x16x32_bf16 v[60:63], a[236:239], a[20:23], v[60:63]
    s_waitcnt vmcnt(14)
    v_mfma_f32_16x16x32_bf16 v[64:67], a[224:227], a[24:27], v[64:67]
    buffer_load_dwordx4 a[72:75], v10, s[4:7], s26 offen sc1
    v_mfma_f32_16x16x32_bf16 v[68:71], a[228:231], a[24:27], v[68:71]
    v_mfma_f32_16x16x32_bf16 v[72:75], a[232:235], a[24:27], v[72:75]
    v_mfma_f32_16x16x32_bf16 v[76:79], a[236:239], a[24:27], v[76:79]
    s_waitcnt vmcnt(14)
    v_mfma_f32_16x16x32_bf16 v[16:19], a[224:227], a[28:31], v[16:19]
    buffer_load_dwordx4 a[76:79], v11, s[4:7], s26 offen sc1
    v_mfma_f32_16x16x32_bf16 v[20:23], a[228:231], a[28:31], v[20:23]
    v_mfma_f32_16x16x32_bf16 v[24:27], a[232:235], a[28:31], v[24:27]
    v_mfma_f32_16x16x32_bf16 v[28:31], a[236:239], a[28:31], v[28:31]
    s_waitcnt vmcnt(14)
    v_mfma_f32_16x16x32_bf16 v[32:35], a[240:243], a[32:35], v[32:35]
    s_mov_b32 s26, 40960
    buffer_load_dwordx4 a[80:83], v8, s[4:7], s26 offen sc1
    s_add_u32 s24, s39, 128
    s_load_dwordx4 s[80:83], s[4:5], s24
    v_mfma_f32_16x16x32_bf16 v[36:39], a[244:247], a[32:35], v[36:39]
    v_mfma_f32_16x16x32_bf16 v[40:43], a[248:251], a[32:35], v[40:43]
    v_mfma_f32_16x16x32_bf16 v[44:47], a[252:255], a[32:35], v[44:47]
    s_waitcnt vmcnt(13)
    v_mfma_f32_16x16x32_bf16 v[48:51], a[240:243], a[36:39], v[48:51]
    buffer_load_dwordx4 a[84:87], v9, s[4:7], s26 offen sc1
    v_mfma_f32_16x16x32_bf16 v[52:55], a[244:247], a[36:39], v[52:55]
    v_mfma_f32_16x16x32_bf16 v[56:59], a[248:251], a[36:39], v[56:59]
    v_mfma_f32_16x16x32_bf16 v[60:63], a[252:255], a[36:39], v[60:63]
    s_waitcnt vmcnt(13)
    v_mfma_f32_16x16x32_bf16 v[64:67], a[240:243], a[40:43], v[64:67]
    buffer_load_dwordx4 a[88:91], v10, s[4:7], s26 offen sc1
    v_mfma_f32_16x16x32_bf16 v[68:71], a[244:247], a[40:43], v[68:71]
    v_mfma_f32_16x16x32_bf16 v[72:75], a[248:251], a[40:43], v[72:75]
    v_mfma_f32_16x16x32_bf16 v[76:79], a[252:255], a[40:43], v[76:79]
    s_waitcnt vmcnt(11)
    v_mfma_f32_16x16x32_bf16 v[16:19], a[240:243], a[44:47], v[16:19]
    buffer_load_dwordx4 a[92:95], v11, s[4:7], s26 offen sc1
    s_waitcnt lgkmcnt(0)
    s_and_b64 s[80:81], s[80:81], s[82:83]
    s_and_b32 s80, s80, s81
    s_cmp_lg_u32 s80, 0x01010101
    s_cbranch_scc1 L_late8
L_back8:
    v_mfma_f32_16x16x32_bf16 v[20:23], a[244:247], a[44:47], v[20:23]
    v_mfma_f32_16x16x32_bf16 v[24:27], a[248:251], a[44:47], v[24:27]
    v_mfma_f32_16x16x32_bf16 v[28:31], a[252:255], a[44:47], v[28:31]
    s_waitcnt vmcnt(11)
    v_mfma_f32_16x16x32_bf16 v[32:35], v[192:195], a[48:51], v[32:35]
    s_mov_b32 s26, 49152
    buffer_load_dwordx4 a[96:99], v8, s[4:7], s26 offen sc1
    s_add_u32 s61, s61, 1
    s_barrier
    s_mov_b64 exec, 1
    buffer_store_byte v241, off, s[4:7], s25 offset:256
    s_mov_b64 exec, -1
    v_mfma_f32_16x16x32_bf16 v[36:39], v[196:199], a[48:51], v[36:39]
    v_mfma_f32_16x16x32_bf16 v[40:43], v[200:203], a[48:51], v[40:43]
    v_mfma_f32_16x16x32_bf16 v[44:47], v[204:207], a[48:51], v[44:47]
    s_waitcnt vmcnt(12)
    v_mfma_f32_16x16x32_bf16 v[48:51], v[192:195], a[52:55], v[48:51]
    buffer_load_dwordx4 a[100:103], v9, s[4:7], s26 offen sc1
    v_mfma_f32_16x16x32_bf16 v[52:55], v[196:199], a[52:55], v[52:55]
    v_mfma_f32_16x16x32_bf16 v[56:59], v[200:203], a[52:55], v[56:59]
    v_mfma_f32_16x16x32_bf16 v[60:63], v[204:207], a[52:55], v[60:63]
    s_waitcnt vmcnt(12)
    v_mfma_f32_16x16x32_bf16 v[64:67], v[192:195], a[56:59], v[64:67]
    buffer_load_dwordx4 a[104:107], v10, s[4:7], s26 offen sc1
    v_mfma_f32_16x16x32_bf16 v[68:71], v[196:199], a[56:59], v[68:71]
    v_mfma_f32_16x16x32_bf16 v[72:75], v[200:203], a[56:59], v[72:75]
    v_mfma_f32_16x16x32_bf16 v[76:79], v[204:207], a[56:59], v[76:79]
    s_waitcnt vmcnt(12)
    v_mfma_f32_16x16x32_bf16 v[16:19], v[192:195], a[60:63], v[16:19]
    buffer_load_dwordx4 a[108:111], v11, s[4:7], s26 offen sc1
    v_mfma_f32_16x16x32_bf16 v[20:23], v[196:199], a[60:63], v[20:23]
    v_mfma_f32_16x16x32_bf16 v[24:27], v[200:203], a[60:63], v[24:27]
    v_mfma_f32_16x16x32_bf16 v[28:31], v[204:207], a[60:63], v[28:31]
    s_waitcnt vmcnt(12)
    v_mfma_f32_16x16x32_bf16 v[32:35], v[144:147], a[64:67], v[32:35]
    s_mov_b32 s26, 57344
    buffer_load_dwordx4 a[112:115], v8, s[4:7], s26 offen sc1
    v_mfma_f32_16x16x32_bf16 v[36:39], v[148:151], a[64:67], v[36:39]
    v_mfma_f32_16x16x32_bf16 v[40:43], v[152:155], a[64:67], v[40:43]
    v_mfma_f32_16x16x32_bf16 v[44:47], v[156:159], a[64:67], v[44:47]
    s_waitcnt vmcnt(12)
    v_mfma_f32_16x16x32_bf16 v[48:51], v[144:147], a[68:71], v[48:51]
    buffer_load_dwordx4 a[116:119], v9, s[4:7], s26 offen sc1
    v_mfma_f32_16x16x32_bf16 v[52:55], v[148:151], a[68:71], v[52:55]
    v_mfma_f32_16x16x32_bf16 v[56:59], v[152:155], a[68:71], v[56:59]
    v_mfma_f32_16x16x32_bf16 v[60:63], v[156:159], a[68:71], v[60:63]
    s_waitcnt vmcnt(12)
    v_mfma_f32_16x16x32_bf16 v[64:67], v[144:147], a[72:75], v[64:67]
    buffer_load_dwordx4 a[120:123], v10, s[4:7], s26 offen sc1
    v_mfma_f32_16x16x32_bf16 v[68:71], v[148:151], a[72:75], v[68:71]
    v_mfma_f32_16x16x32_bf16 v[72:75], v[152:155], a[72:75], v[72:75]
    v_mfma_f32_16x16x32_bf16 v[76:79], v[156:159], a[72:75], v[76:79]
    s_waitcnt vmcnt(12)
    v_mfma_f32_16x16x32_bf16 v[16:19], v[144:147], a[76:79], v[16:19]
    buffer_load_dwordx4 a[124:127], v11, s[4:7], s26 offen sc1
    v_mfma_f32_16x16x32_bf16 v[20:23], v[148:151], a[76:79], v[20:23]
    v_mfma_f32_16x16x32_bf16 v[24:27], v[152:155], a[76:79], v[24:27]
    s_mov_b32 s26, 65536
    buffer_load_dwordx4 a[0:3], v8, s[4:7], s26 offen sc1
    v_mfma_f32_16x16x32_bf16 v[28:31], v[156:159], a[76:79], v[28:31]
    s_waitcnt vmcnt(13)
    v_mfma_f32_16x16x32_bf16 v[32:35], v[160:163], a[80:83], v[32:35]
    buffer_load_dwordx4 a[4:7], v9, s[4:7], s26 offen sc1
    v_mfma_f32_16x16x32_bf16 v[36:39], v[164:167], a[80:83], v[36:39]
    v_mfma_f32_16x16x32_bf16 v[40:43], v[168:171], a[80:83], v[40:43]
    v_mfma_f32_16x16x32_bf16 v[44:47], v[172:175], a[80:83], v[44:47]
    s_waitcnt vmcnt(13)
    v_mfma_f32_16x16x32_bf16 v[48:51], v[160:163], a[84:87], v[48:51]
    buffer_load_dwordx4 a[8:11], v10, s[4:7], s26 offen sc1
    v_mfma_f32_16x16x32_bf16 v[52:55], v[164:167], a[84:87], v[52:55]
    v_mfma_f32_16x16x32_bf16 v[56:59], v[168:171], a[84:87], v[56:59]
    v_mfma_f32_16x16x32_bf16 v[60:63], v[172:175], a[84:87], v[60:63]
    s_waitcnt vmcnt(13)
    v_mfma_f32_16x16x32_bf16 v[64:67], v[160:163], a[88:91], v[64:67]
    v_mfma_f32_16x16x32_bf16 v[68:71], v[164:167], a[88:91], v[68:71]
    v_mfma_f32_16x16x32_bf16 v[72:75], v[168:171], a[88:91], v[72:75]
    v_mfma_f32_16x16x32_bf16 v[76:79], v[172:175], a[88:91], v[76:79]
    s_waitcnt vmcnt(12)
    v_mfma_f32_16x16x32_bf16 v[16:19], v[160:163], a[92:95], v[16:19]
    buffer_load_dwordx4 a[12:15], v11, s[4:7], s26 offen sc1
    v_mfma_f32_16x16x32_bf16 v[20:23], v[164:167], a[92:95], v[20:23]
    v_mfma_f32_16x16x32_bf16 v[24:27], v[168:171], a[92:95], v[24:27]
    s_mov_b32 s26, 73728
    buffer_load_dwordx4 a[16:19], v8, s[4:7], s26 offen sc1
    v_mfma_f32_16x16x32_bf16 v[28:31], v[172:175], a[92:95], v[28:31]
    s_waitcnt vmcnt(13)
    v_mfma_f32_16x16x32_bf16 v[32:35], v[176:179], a[96:99], v[32:35]
    buffer_load_dwordx4 a[20:23], v9, s[4:7], s26 offen sc1
    s_add_u32 s24, s39, 256
    s_load_dwordx4 s[80:83], s[4:5], s24
    v_mfma_f32_16x16x32_bf16 v[36:39], v[180:183], a[96:99], v[36:39]
    v_mfma_f32_16x16x32_bf16 v[40:43], v[184:187], a[96:99], v[40:43]
    buffer_load_dwordx4 a[24:27], v10, s[4:7], s26 offen sc1
    v_mfma_f32_16x16x32_bf16 v[44:47], v[188:191], a[96:99], v[44:47]
    s_waitcnt vmcnt(13)
    v_mfma_f32_16x16x32_bf16 v[48:51], v[176:179], a[100:103], v[48:51]
    v_mfma_f32_16x16x32_bf16 v[52:55], v[180:183], a[100:103], v[52:55]
    v_mfma_f32_16x16x32_bf16 v[56:59], v[184:187], a[100:103], v[56:59]
    v_mfma_f32_16x16x32_bf16 v[60:63], v[188:191], a[100:103], v[60:63]
    s_waitcnt vmcnt(12)
    v_mfma_f32_16x16x32_bf16 v[64:67], v[176:179], a[104:107], v[64:67]
    v_mfma_f32_16x16x32_bf16 v[68:71], v[180:183], a[104:107], v[68:71]
    v_mfma_f32_16x16x32_bf16 v[72:75], v[184:187], a[104:107], v[72:75]
    v_mfma_f32_16x16x32_bf16 v[76:79], v[188:191], a[104:107], v[76:79]
    s_waitcnt vmcnt(11)
    v_mfma_f32_16x16x32_bf16 v[16:19], v[176:179], a[108:111], v[16:19]
    buffer_load_dwordx4 a[28:31], v11, s[4:7], s26 offen sc1
    s_waitcnt lgkmcnt(0)
    s_and_b64 s[80:81], s[80:81], s[82:83]
    s_and_b32 s80, s80, s81
    s_cmp_lg_u32 s80, 0x01010101
    s_cbranch_scc1 L_late9
L_back9:
    v_mfma_f32_16x16x32_bf16 v[20:23], v[180:183], a[108:111], v[20:23]
    v_mfma_f32_16x16x32_bf16 v[24:27], v[184:187], a[108:111], v[24:27]
    s_mov_b32 s26, 81920
    buffer_load_dwordx4 a[32:35], v8, s[4:7], s26 offen sc1
    v_mfma_f32_16x16x32_bf16 v[28:31], v[188:191], a[108:111], v[28:31]
    s_waitcnt vmcnt(12)
    v_mfma_f32_16x16x32_bf16 v[32:35], a[128:131], a[112:115], v[32:35]
    s_mov_b32 s26, 90112
    buffer_load_dwordx4 a[36:39], v8, s[4:7], s26 offen sc1
    v_mfma_f32_16x16x32_bf16 v[36:39], a[132:135], a[112:115], v[36:39]
    v_mfma_f32_16x16x32_bf16 v[40:43], a[136:139], a[112:115], v[40:43]
    s_mov_b32 s26, 98304
    buffer_load_dwordx4 a[40:43], v8, s[4:7], s26 offen sc1
    v_mfma_f32_16x16x32_bf16 v[44:47], a[140:143], a[112:115], v[44:47]
    s_waitcnt vmcnt(13)
    v_mfma_f32_16x16x32_bf16 v[48:51], a[128:131], a[116:119], v[48:51]
    s_mov_b32 s26, 106496
    buffer_load_dwordx4 a[44:47], v8, s[4:7], s26 offen sc1
    v_mfma_f32_16x16x32_bf16 v[52:55], a[132:135], a[116:119], v[52:55]
    v_mfma_f32_16x16x32_bf16 v[56:59], a[136:139], a[116:119], v[56:59]
    s_mov_b32 s26, 81920
    buffer_load_dwordx4 a[48:51], v9, s[4:7], s26 offen sc1
    v_mfma_f32_16x16x32_bf16 v[60:63], a[140:143], a[116:119], v[60:63]
    s_waitcnt vmcnt(14)
    v_mfma_f32_16x16x32_bf16 v[64:67], a[128:131], a[120:123], v[64:67]
    s_mov_b32 s26, 90112
    buffer_load_dwordx4 a[52:55], v9, s[4:7], s26 offen sc1
    v_mfma_f32_16x16x32_bf16 v[68:71], a[132:135], a[120:123], v[68:71]
    v_mfma_f32_16x16x32_bf16 v[72:75], a[136:139], a[120:123], v[72:75]
    v_lshlrev_b32 v128, 2, v0
    buffer_load_dword v242, v128, s[16:19], s99 offen
    v_mfma_f32_16x16x32_bf16 v[76:79], a[140:143], a[120:123], v[76:79]
    s_waitcnt vmcnt(14)
    v_mfma_f32_16x16x32_bf16 v[32:35], a[144:147], a[0:3], v[32:35]
    s_mov_b32 s26, 98304
    buffer_load_dwordx4 a[56:59], v9, s[4:7], s26 offen sc1
    v_mfma_f32_16x16x32_bf16 v[36:39], a[148:151], a[0:3], v[36:39]
    v_mfma_f32_16x16x32_bf16 v[40:43], a[152:155], a[0:3], v[40:43]
    v_mfma_f32_16x16x32_bf16 v[44:47], a[156:159], a[0:3], v[44:47]
    s_waitcnt vmcnt(14)
    v_mfma_f32_16x16x32_bf16 v[48:51], a[144:147], a[4:7], v[48:51]
    s_mov_b32 s26, 106496
    buffer_load_dwordx4 a[60:63], v9, s[4:7], s26 offen sc1
    v_mfma_f32_16x16x32_bf16 v[52:55], a[148:151], a[4:7], v[52:55]
    v_mfma_f32_16x16x32_bf16 v[56:59], a[152:155], a[4:7], v[56:59]
    v_mfma_f32_16x16x32_bf16 v[60:63], a[156:159], a[4:7], v[60:63]
    s_waitcnt vmcnt(14)
    v_mfma_f32_16x16x32_bf16 v[64:67], a[144:147], a[8:11], v[64:67]
    s_mov_b32 s26, 81920
    buffer_load_dwordx4 a[64:67], v10, s[4:7], s26 offen sc1
    v_mfma_f32_16x16x32_bf16 v[68:71], a[148:151], a[8:11], v[68:71]
    v_mfma_f32_16x16x32_bf16 v[72:75], a[152:155], a[8:11], v[72:75]
    v_mfma_f32_16x16x32_bf16 v[76:79], a[156:159], a[8:11], v[76:79]
    s_waitcnt vmcnt(13)
    v_mfma_f32_16x16x32_bf16 v[32:35], a[160:163], a[16:19], v[32:35]
    s_mov_b32 s26, 90112
    buffer_load_dwordx4 a[68:71], v10, s[4:7], s26 offen sc1
    v_mfma_f32_16x16x32_bf16 v[36:39], a[164:167], a[16:19], v[36:39]
    v_mfma_f32_16x16x32_bf16 v[40:43], a[168:171], a[16:19], v[40:43]
    v_mfma_f32_16x16x32_bf16 v[44:47], a[172:175], a[16:19], v[44:47]
    s_waitcnt vmcnt(13)
    v_mfma_f32_16x16x32_bf16 v[48:51], a[160:163], a[20:23], v[48:51]
    s_mov_b32 s26, 98304
    buffer_load_dwordx4 a[72:75], v10, s[4:7], s26 offen sc1
    v_mfma_f32_16x16x32_bf16 v[52:55], a[164:167], a[20:23], v[52:55]
    v_mfma_f32_16x16x32_bf16 v[56:59], a[168:171], a[20:23], v[56:59]
    v_mfma_f32_16x16x32_bf16 v[60:63], a[172:175], a[20:23], v[60:63]
    s_waitcnt vmcnt(13)
    v_mfma_f32_16x16x32_bf16 v[64:67], a[160:163], a[24:27], v[64:67]
    s_mov_b32 s26, 106496
    buffer_load_dwordx4 a[76:79], v10, s[4:7], s26 offen sc1
    v_mfma_f32_16x16x32_bf16 v[68:71], a[164:167], a[24:27], v[68:71]
    v_mfma_f32_16x16x32_bf16 v[72:75], a[168:171], a[24:27], v[72:75]
    v_mfma_f32_16x16x32_bf16 v[76:79], a[172:175], a[24:27], v[76:79]
    s_waitcnt vmcnt(12)
    v_mfma_f32_16x16x32_bf16 v[32:35], a[176:179], a[32:35], v[32:35]
    v_mfma_f32_16x16x32_bf16 v[36:39], a[180:183], a[32:35], v[36:39]
    v_mfma_f32_16x16x32_bf16 v[40:43], a[184:187], a[32:35], v[40:43]
    v_mfma_f32_16x16x32_bf16 v[44:47], a[188:191], a[32:35], v[44:47]
    s_waitcnt vmcnt(11)
    v_mfma_f32_16x16x32_bf16 v[32:35], a[192:195], a[36:39], v[32:35]
    v_mfma_f32_16x16x32_bf16 v[36:39], a[196:199], a[36:39], v[36:39]
    v_mfma_f32_16x16x32_bf16 v[40:43], a[200:203], a[36:39], v[40:43]
    v_mfma_f32_16x16x32_bf16 v[44:47], a[204:207], a[36:39], v[44:47]
    s_waitcnt vmcnt(10)
    v_mfma_f32_16x16x32_bf16 v[32:35], v[208:211], a[40:43], v[32:35]
    v_mfma_f32_16x16x32_bf16 v[36:39], v[212:215], a[40:43], v[36:39]
    v_mfma_f32_16x16x32_bf16 v[40:43], v[216:219], a[40:43], v[40:43]
    v_mfma_f32_16x16x32_bf16 v[44:47], v[220:223], a[40:43], v[44:47]
    s_waitcnt vmcnt(9)
    v_mfma_f32_16x16x32_bf16 v[32:35], v[224:227], a[44:47], v[32:35]
    s_mov_b32 s26, 81920
    buffer_load_dwordx4 a[80:83], v11, s[4:7], s26 offen sc1
    v_mfma_f32_16x16x32_bf16 v[36:39], v[228:231], a[44:47], v[36:39]
    v_mfma_f32_16x16x32_bf16 v[40:43], v[232:235], a[44:47], v[40:43]
    v_mfma_f32_16x16x32_bf16 v[44:47], v[236:239], a[44:47], v[44:47]
    s_waitcnt vmcnt(9)
    v_mfma_f32_16x16x32_bf16 v[48:51], a[176:179], a[48:51], v[48:51]
    s_mov_b32 s26, 90112
    buffer_load_dwordx4 a[84:87], v11, s[4:7], s26 offen sc1
    v_mfma_f32_16x16x32_bf16 v[52:55], a[180:183], a[48:51], v[52:55]
    ds_write_b128 v12, v[32:35] offset:0
    v_mfma_f32_16x16x32_bf16 v[56:59], a[184:187], a[48:51], v[56:59]
    v_mfma_f32_16x16x32_bf16 v[60:63], a[188:191], a[48:51], v[60:63]
    s_waitcnt vmcnt(9)
    v_mfma_f32_16x16x32_bf16 v[48:51], a[192:195], a[52:55], v[48:51]
    s_mov_b32 s26, 98304
    buffer_load_dwordx4 a[88:91], v11, s[4:7], s26 offen sc1
    v_mfma_f32_16x16x32_bf16 v[52:55], a[196:199], a[52:55], v[52:55]
    ds_write_b128 v12, v[36:39] offset:1024
    v_mfma_f32_16x16x32_bf16 v[56:59], a[200:203], a[52:55], v[56:59]
    v_mfma_f32_16x16x32_bf16 v[60:63], a[204:207], a[52:55], v[60:63]
    s_waitcnt vmcnt(8)
    v_mfma_f32_16x16x32_bf16 v[48:51], v[208:211], a[56:59], v[48:51]
    s_mov_b32 s26, 106496
    buffer_load_dwordx4 a[92:95], v11, s[4:7], s26 offen sc1
    v_mfma_f32_16x16x32_bf16 v[52:55], v[212:215], a[56:59], v[52:55]
    ds_write_b128 v12, v[40:43] offset:2048
    v_mfma_f32_16x16x32_bf16 v[56:59], v[216:219], a[56:59], v[56:59]
    v_mfma_f32_16x16x32_bf16 v[60:63], v[220:223], a[56:59], v[60:63]
    s_cmp_lg_u32 s88, 0
    s_cbranch_scc1 L_final
    s_waitcnt vmcnt(8)
    v_mfma_f32_16x16x32_bf16 v[48:51], v[224:227], a[60:63], v[48:51]
    v_mfma_f32_16x16x32_bf16 v[52:55], v[228:231], a[60:63], v[52:55]
    ds_write_b128 v12, v[44:47] offset:3072
    v_mfma_f32_16x16x32_bf16 v[56:59], v[232:235], a[60:63], v[56:59]
    s_add_u32 m0, s49, 49152
    s_add_u32 s54, s53, 0
    v_mfma_f32_16x16x32_bf16 v[60:63], v[236:239], a[60:63], v[60:63]
    buffer_load_dwordx4 v1, s[4:7], s54 offen offset:0 sc1 lds
    s_waitcnt vmcnt(8)
    v_mfma_f32_16x16x32_bf16 v[64:67], a[176:179], a[64:67], v[64:67]
    v_mfma_f32_16x16x32_bf16 v[68:71], a[180:183], a[64:67], v[68:71]
    ds_write_b128 v13, v[48:51] offset:0
    v_mfma_f32_16x16x32_bf16 v[72:75], a[184:187], a[64:67], v[72:75]
    v_mfma_f32_16x16x32_bf16 v[76:79], a[188:191], a[64:67], v[76:79]
    buffer_load_dwordx4 v1, s[4:7], s54 offen offset:1024 sc1 lds
    s_waitcnt vmcnt(8)
    v_mfma_f32_16x16x32_bf16 v[64:67], a[192:195], a[68:71], v[64:67]
    v_mfma_f32_16x16x32_bf16 v[68:71], a[196:199], a[68:71], v[68:71]
    ds_write_b128 v13, v[52:55] offset:1024
    v_mfma_f32_16x16x32_bf16 v[72:75], a[200:203], a[68:71], v[72:75]
    v_mfma_f32_16x16x32_bf16 v[76:79], a[204:207], a[68:71], v[76:79]
    buffer_load_dwordx4 v1, s[4:7], s54 offen offset:2048 sc1 lds
    s_waitcnt vmcnt(8)
    v_mfma_f32_16x16x32_bf16 v[64:67], v[208:211], a[72:75], v[64:67]
    v_mfma_f32_16x16x32_bf16 v[68:71], v[212:215], a[72:75], v[68:71]
    ds_write_b128 v13, v[56:59] offset:2048
    v_mfma_f32_16x16x32_bf16 v[72:75], v[216:219], a[72:75], v[72:75]
    v_mfma_f32_16x16x32_bf16 v[76:79], v[220:223], a[72:75], v[76:79]
    buffer_load_dwordx4 v1, s[4:7], s54 offen offset:3072 sc1 lds
    s_waitcnt vmcnt(8)
    v_mfma_f32_16x16x32_bf16 v[64:67], v[224:227], a[76:79], v[64:67]
    v_mfma_f32_16x16x32_bf16 v[68:71], v[228:231], a[76:79], v[68:71]
    ds_write_b128 v13, v[60:63] offset:3072
    v_mfma_f32_16x16x32_bf16 v[72:75], v[232:235], a[76:79], v[72:75]
    s_add_u32 m0, s49, 65536
    s_add_u32 s54, s53, 16384
    v_mfma_f32_16x16x32_bf16 v[76:79], v[236:239], a[76:79], v[76:79]
    buffer_load_dwordx4 v1, s[4:7], s54 offen offset:0 sc1 lds
    v_mfma_f32_16x16x32_bf16 v[16:19], a[128:131], a[124:127], v[16:19]
    v_mfma_f32_16x16x32_bf16 v[20:23], a[132:135], a[124:127], v[20:23]
    ds_write_b128 v14, v[64:67] offset:0
    v_mfma_f32_16x16x32_bf16 v[24:27], a[136:139], a[124:127], v[24:27]
    v_mfma_f32_16x16x32_bf16 v[28:31], a[140:143], a[124:127], v[28:31]
    buffer_load_dwordx4 v1, s[4:7], s54 offen offset:1024 sc1 lds
    v_mfma_f32_16x16x32_bf16 v[16:19], a[144:147], a[12:15], v[16:19]
    v_mfma_f32_16x16x32_bf16 v[20:23], a[148:151], a[12:15], v[20:23]
    ds_write_b128 v14, v[68:71] offset:1024
    v_mfma_f32_16x16x32_bf16 v[24:27], a[152:155], a[12:15], v[24:27]
    v_mfma_f32_16x16x32_bf16 v[28:31], a[156:159], a[12:15], v[28:31]
    buffer_load_dwordx4 v1, s[4:7], s54 offen offset:2048 sc1 lds
    v_mfma_f32_16x16x32_bf16 v[16:19], a[160:163], a[28:31], v[16:19]
    v_mfma_f32_16x16x32_bf16 v[20:23], a[164:167], a[28:31], v[20:23]
    ds_write_b128 v14, v[72:75] offset:2048
    v_mfma_f32_16x16x32_bf16 v[24:27], a[168:171], a[28:31], v[24:27]
    v_mfma_f32_16x16x32_bf16 v[28:31], a[172:175], a[28:31], v[28:31]
    buffer_load_dwordx4 v1, s[4:7], s54 offen offset:3072 sc1 lds
    s_waitcnt vmcnt(11)
    v_mfma_f32_16x16x32_bf16 v[16:19], a[176:179], a[80:83], v[16:19]
    v_mfma_f32_16x16x32_bf16 v[20:23], a[180:183], a[80:83], v[20:23]
    ds_write_b128 v14, v[76:79] offset:3072
    v_mfma_f32_16x16x32_bf16 v[24:27], a[184:187], a[80:83], v[24:27]
    s_add_u32 m0, s49, 81920
    s_add_u32 s54, s53, 32768
    v_mfma_f32_16x16x32_bf16 v[28:31], a[188:191], a[80:83], v[28:31]
    buffer_load_dwordx4 v1, s[4:7], s54 offen offset:0 sc1 lds
    s_waitcnt vmcnt(11)
    v_mfma_f32_16x16x32_bf16 v[16:19], a[192:195], a[84:87], v[16:19]
    s_waitcnt lgkmcnt(0)
    s_barrier
    v_mfma_f32_16x16x32_bf16 v[20:23], a[196:199], a[84:87], v[20:23]
    ds_read_b128 v[32:35], v15 offset:0
    ds_read_b128 v[48:51], v15 offset:4096
    v_mfma_f32_16x16x32_bf16 v[24:27], a[200:203], a[84:87], v[24:27]
    ds_read_b128 v[64:67], v15 offset:8192
    v_mfma_f32_16x16x32_bf16 v[28:31], a[204:207], a[84:87], v[28:31]
    buffer_load_dwordx4 v1, s[4:7], s54 offen offset:1024 sc1 lds
    ds_read_b128 v[36:39], v15 offset:1024
    s_waitcnt vmcnt(11)
    v_mfma_f32_16x16x32_bf16 v[16:19], v[208:211], a[88:91], v[16:19]
    ds_read_b128 v[52:55], v15 offset:5120
    ds_read_b128 v[68:71], v15 offset:9216
    v_mfma_f32_16x16x32_bf16 v[20:23], v[212:215], a[88:91], v[20:23]
    ds_read_b128 v[40:43], v15 offset:2048
    v_mfma_f32_16x16x32_bf16 v[24:27], v[216:219], a[88:91], v[24:27]
    ds_read_b128 v[56:59], v15 offset:6144
    v_mfma_f32_16x16x32_bf16 v[28:31], v[220:223], a[88:91], v[28:31]
    buffer_load_dwordx4 v1, s[4:7], s54 offen offset:2048 sc1 lds
    ds_read_b128 v[72:75], v15 offset:10240
    ds_read_b128 v[44:47], v15 offset:3072
    s_waitcnt vmcnt(11)
    v_mfma_f32_16x16x32_bf16 v[16:19], v[224:227], a[92:95], v[16:19]
    ds_read_b128 v[60:63], v15 offset:7168
    v_mfma_f32_16x16x32_bf16 v[20:23], v[228:231], a[92:95], v[20:23]
    ds_read_b128 v[76:79], v15 offset:11264
    v_mfma_f32_16x16x32_bf16 v[24:27], v[232:235], a[92:95], v[24:27]
    v_mfma_f32_16x16x32_bf16 v[28:31], v[236:239], a[92:95], v[28:31]
    buffer_load_dwordx4 v1, s[4:7], s54 offen offset:3072 sc1 lds
    s_waitcnt lgkmcnt(9)
    v_pk_add_f32 v[32:33], v[32:33], v[48:49]
    v_pk_add_f32 v[34:35], v[34:35], v[50:51]
    v_pk_add_f32 v[32:33], v[32:33], v[64:65]
    v_pk_add_f32 v[34:35], v[34:35], v[66:67]
    s_waitcnt lgkmcnt(6)
    v_pk_add_f32 v[36:37], v[36:37], v[52:53]
    v_pk_add_f32 v[38:39], v[38:39], v[54:55]
    v_pk_add_f32 v[36:37], v[36:37], v[68:69]
    v_pk_add_f32 v[38:39], v[38:39], v[70:71]
    s_waitcnt lgkmcnt(3)
    v_pk_add_f32 v[40:41], v[40:41], v[56:57]
    v_pk_add_f32 v[42:43], v[42:43], v[58:59]
    v_pk_add_f32 v[40:41], v[40:41], v[72:73]
    v_pk_add_f32 v[42:43], v[42:43], v[74:75]
    s_waitcnt lgkmcnt(0)
    v_pk_add_f32 v[44:45], v[44:45], v[60:61]
    v_pk_add_f32 v[46:47], v[46:47], v[62:63]
    v_pk_add_f32 v[44:45], v[44:45], v[76:77]
    v_pk_add_f32 v[46:47], v[46:47], v[78:79]
    v_pk_add_f32 v[16:17], v[16:17], v[32:33]
    v_pk_add_f32 v[18:19], v[18:19], v[34:35]
    v_pk_add_f32 v[20:21], v[20:21], v[36:37]
    v_pk_add_f32 v[22:23], v[22:23], v[38:39]
    v_pk_add_f32 v[24:25], v[24:25], v[40:41]
    v_pk_add_f32 v[26:27], v[26:27], v[42:43]
    v_pk_add_f32 v[28:29], v[28:29], v[44:45]
    v_pk_add_f32 v[30:31], v[30:31], v[46:47]
    v_cvt_pk_bf16_f32 v248, v16, v17
    v_cvt_pk_bf16_f32 v249, v18, v19
    v_cvt_pk_bf16_f32 v250, v20, v21
    v_cvt_pk_bf16_f32 v251, v22, v23
    v_cvt_pk_bf16_f32 v252, v24, v25
    v_cvt_pk_bf16_f32 v253, v26, v27
    v_cvt_pk_bf16_f32 v254, v28, v29
    v_cvt_pk_bf16_f32 v255, v30, v31
    buffer_store_dwordx4 v[248:251], v6, s[4:7], s33 offen offset:0 sc1
    buffer_store_dwordx4 v[252:255], v6, s[4:7], s33 offen offset:2048 sc1
    v_pk_add_f32 v[8:9], v[16:17], v[18:19]
    v_pk_mul_f32 v[10:11], v[16:17], v[16:17]
    v_pk_fma_f32 v[10:11], v[18:19], v[18:19], v[10:11]
    v_pk_add_f32 v[8:9], v[8:9], v[20:21]
    v_pk_fma_f32 v[10:11], v[20:21], v[20:21], v[10:11]
    v_pk_add_f32 v[8:9], v[8:9], v[22:23]
    v_pk_fma_f32 v[10:11], v[22:23], v[22:23], v[10:11]
    v_pk_add_f32 v[8:9], v[8:9], v[24:25]
    v_pk_fma_f32 v[10:11], v[24:25], v[24:25], v[10:11]
    v_pk_add_f32 v[8:9], v[8:9], v[26:27]
    v_pk_fma_f32 v[10:11], v[26:27], v[26:27], v[10:11]
    v_pk_add_f32 v[8:9], v[8:9], v[28:29]
    v_pk_fma_f32 v[10:11], v[28:29], v[28:29], v[10:11]
    v_pk_add_f32 v[8:9], v[8:9], v[30:31]
    v_pk_fma_f32 v[10:11], v[30:31], v[30:31], v[10:11]
    v_add_f32 v8, v8, v9
    v_add_f32 v9, v10, v11
    s_nop 1
    v_permlane32_swap_b32 v8, v9
    s_nop 1
    v_add_f32 v8, v8, v9
    v_mov_b32 v9, v8
    s_nop 1
    v_permlane16_swap_b32 v8, v9
    s_nop 1
    v_add_f32 v8, v8, v9
    buffer_store_dword v8, v7, s[4:7], s32 offen sc1
    s_add_u32 s48, s48, 25165824
    s_mov_b32 s88, 1
    s_lshl_b32 s26, s56, 15
    s_add_u32 s26, s26, s48
    s_add_u32 s26, s26, 0
    s_lshl_b32 s27, s56, 8
    s_add_u32 s27, s27, s48
    s_add_u32 s27, s27, 4194304
    v_and_b32 v6, 31, v0
    v_lshlrev_b32 v6, 3, v6
    v_lshrrev_b32 v3, 5, v0
    v_lshl_add_u32 v6, v3, 16, v6
    s_mul_i32 s35, s58, 2048
    v_mul_u32_u24 v240, 128, v0
    s_add_u32 s35, s35, 60817408
    s_add_u32 s39, s35, 33984
    s_and_b32 s23, s22, 15
    s_add_u32 s25, s39, s23
    s_cmp_eq_u32 s20, 0
    s_cselect_b32 s25, s25, 1073741824
    v_mov_b32 v241, 1
    s_add_u32 s61, s61, 1
    s_waitcnt vmcnt(0)
    s_barrier
    s_mov_b64 exec, 7
    buffer_store_byte v241, v240, s[4:7], s25 offen
    s_mov_b64 exec, -1
    s_add_u32 m0, s49, 98304
    s_add_u32 s54, s53, 49152
    buffer_load_dwordx4 v1, s[4:7], s54 offen offset:0 sc1 lds
    buffer_load_dwordx4 v1, s[4:7], s54 offen offset:1024 sc1 lds
    buffer_load_dwordx4 v1, s[4:7], s54 offen offset:2048 sc1 lds
    buffer_load_dwordx4 v1, s[4:7], s54 offen offset:3072 sc1 lds
    s_add_u32 m0, s49, 114688
    s_add_u32 s54, s53, 65536
    buffer_load_dwordx4 v1, s[4:7], s54 offen offset:0 sc1 lds
    buffer_load_dwordx4 v1, s[4:7], s54 offen offset:1024 sc1 lds
    buffer_load_dwordx4 v1, s[4:7], s54 offen offset:2048 sc1 lds
    buffer_load_dwordx4 v1, s[4:7], s54 offen offset:3072 sc1 lds
    s_add_u32 s24, s39, 0
    s_load_dwordx4 s[80:83], s[4:5], s24
    s_waitcnt lgkmcnt(0)
    s_and_b64 s[80:81], s[80:81], s[82:83]
    s_and_b32 s80, s80, s81
    s_cmp_eq_u32 s80, 0x01010101
    s_cbranch_scc1 L_go10
    s_add_u32 s24, s39, 128
    s_load_dwordx4 s[80:83], s[4:5], s24
    s_waitcnt lgkmcnt(0)
    s_and_b64 s[80:81], s[80:81], s[82:83]
    s_and_b32 s80, s80, s81
    s_cmp_eq_u32 s80, 0x01010101
    s_cbranch_scc1 L_go10
    s_add_u32 s24, s39, 256
    s_load_dwordx4 s[80:83], s[4:5], s24
    s_waitcnt lgkmcnt(0)
    s_and_b64 s[80:81], s[80:81], s[82:83]
    s_and_b32 s80, s80, s81
    s_cmp_lg_u32 s80, 0x01010101
    s_cbranch_scc1 L_late11
L_back11:
L_go10:
    buffer_load_dwordx4 a[0:3], v1, s[4:7], s26 offen offset:0 sc1
    buffer_load_dwordx4 a[4:7], v1, s[4:7], s26 offen offset:1024 sc1
    buffer_load_dwordx4 a[8:11], v1, s[4:7], s26 offen offset:2048 sc1
    buffer_load_dwordx4 a[12:15], v1, s[4:7], s26 offen offset:3072 sc1
    s_add_u32 s26, s26, 4096
    buffer_load_dwordx4 a[16:19], v1, s[4:7], s26 offen offset:0 sc1
    buffer_load_dwordx4 a[20:23], v1, s[4:7], s26 offen offset:1024 sc1
    buffer_load_dwordx4 a[24:27], v1, s[4:7], s26 offen offset:2048 sc1
    buffer_load_dwordx4 a[28:31], v1, s[4:7], s26 offen offset:3072 sc1
    s_add_u32 s26, s26, 4096
    buffer_load_dwordx4 a[32:35], v1, s[4:7], s26 offen offset:0 sc1
    buffer_load_dwordx4 a[36:39], v1, s[4:7], s26 offen offset:1024 sc1
    ds_read_b128 v[96:99], v1 offset:49152
    ds_read_b128 v[100:103], v1 offset:50176
    ds_read_b128 v[104:107], v1 offset:51200
    ds_read_b128 v[108:111], v1 offset:52224
    ds_read_b128 v[112:115], v1 offset:53248
    ds_read_b128 v[116:119], v1 offset:54272
    s_waitcnt vmcnt(9) lgkmcnt(4)
    v_mfma_f32_32x32x16_bf16 v[48:63], v[96:99], a[0:3], 0
    ds_read_b128 v[120:123], v1 offset:55296
    buffer_load_dwordx4 a[40:43], v1, s[4:7], s26 offen offset:2048 sc1
    v_mfma_f32_32x32x16_bf16 v[64:79], a[0:3], v[100:103], 0
    ds_read_b128 v[124:127], v1 offset:56320
    s_waitcnt vmcnt(9) lgkmcnt(4)
    buffer_load_dwordx2 v[8:9], v6, s[4:7], s27 offen sc1
    v_mfma_f32_32x32x16_bf16 v[32:47], v[104:107], a[0:3], 0
    ds_read_b128 v[96:99], v1 offset:57344
    buffer_load_dwordx4 a[44:47], v1, s[4:7], s26 offen offset:3072 sc1
    v_mfma_f32_32x32x16_bf16 v[48:63], v[108:111], a[4:7], v[48:63]
    ds_read_b128 v[100:103], v1 offset:58368
    s_waitcnt lgkmcnt(4)
    s_and_b32 s24, s22, 15
    s_lshl_b32 s30, s24, 7
    s_add_u32 s30, s30, s56
    v_mfma_f32_32x32x16_bf16 v[64:79], a[4:7], v[112:115], v[64:79]
    ds_read_b128 v[104:107], v1 offset:59392
    s_add_u32 s26, s26, 4096
    buffer_load_dwordx4 a[48:51], v1, s[4:7], s26 offen offset:0 sc1
    s_lshl_b32 s31, s30, 11
    v_mfma_f32_32x32x16_bf16 v[32:47], v[116:119], a[4:7], v[32:47]
    ds_read_b128 v[108:111], v1 offset:60416
    s_waitcnt vmcnt(11) lgkmcnt(4)
    s_add_u32 s27, s27, 16384
    buffer_load_dwordx2 v[10:11], v6, s[4:7], s27 offen sc1
    v_mfma_f32_32x32x16_bf16 v[48:63], v[120:123], a[8:11], v[48:63]
    ds_read_b128 v[112:115], v1 offset:61440
    buffer_load_dwordx4 a[52:55], v1, s[4:7], s26 offen offset:1024 sc1
    s_lshl_b32 s30, s30, 10
    s_add_u32 s30, s30, s48
    v_mfma_f32_32x32x16_bf16 v[64:79], a[8:11], v[124:127], v[64:79]
    ds_read_b128 v[116:119], v1 offset:62464
    s_waitcnt vmcnt(12) lgkmcnt(4)
    s_add_u32 s27, s27, 16384
    buffer_load_dwordx2 v[12:13], v6, s[4:7], s27 offen sc1
    v_mfma_f32_32x32x16_bf16 v[32:47], v[96:99], a[8:11], v[32:47]
    ds_read_b128 v[120:123], v1 offset:63488
    buffer_load_dwordx4 a[56:59], v1, s[4:7], s26 offen offset:2048 sc1
    s_add_u32 s31, s31, s48
    s_add_u32 s30, s30, 5242880
    v_mfma_f32_32x32x16_bf16 v[48:63], v[100:103], a[12:15], v[48:63]
    ds_read_b128 v[124:127], v1 offset:64512
    s_waitcnt lgkmcnt(4)
    s_add_u32 s31, s31, 7340032
    s_add_u32 s32, s30, 65536
    s_add_u32 s33, s31, 131072
    v_mfma_f32_32x32x16_bf16 v[64:79], a[12:15], v[104:107], v[64:79]
    ds_read_b128 v[96:99], v4 offset:0
    s_add_u32 s27, s27, 16384
    buffer_load_dwordx2 v[14:15], v6, s[4:7], s27 offen sc1
    v_and_b32 v24, 0x33, v0
    v_mfma_f32_32x32x16_bf16 v[32:47], v[108:111], a[12:15], v[32:47]
    ds_read_b128 v[100:103], v4 offset:1024
    s_waitcnt vmcnt(14) lgkmcnt(4)
    buffer_load_dwordx4 a[60:63], v1, s[4:7], s26 offen offset:3072 sc1
    v_bfe_u32 v26, v0, 2, 1
    v_mfma_f32_32x32x16_bf16 v[48:63], v[112:115], a[16:19], v[48:63]
    ds_read_b128 v[104:107], v4 offset:2048
    v_lshl_add_u32 v24, v26, 3, v24
    v_bfe_u32 v26, v0, 3, 1
    v_lshl_add_u32 v24, v26, 2, v24
    v_lshlrev_b32 v24, 4, v24
    v_mfma_f32_32x32x16_bf16 v[64:79], a[16:19], v[116:119], v[64:79]
    ds_read_b128 v[108:111], v4 offset:3072
    s_waitcnt vmcnt(14) lgkmcnt(4)
    s_add_u32 s26, s26, 4096
    buffer_load_dwordx4 a[64:67], v1, s[4:7], s26 offen offset:0 sc1
    v_mfma_f32_32x32x16_bf16 v[32:47], v[120:123], a[16:19], v[32:47]
    ds_read_b128 v[112:115], v4 offset:4096
    v_and_b32 v25, 15, v0
    v_lshlrev_b32 v25, 4, v25
    v_lshrrev_b32 v26, 5, v0
    v_lshl_add_u32 v25, v26, 8, v25
    v_mfma_f32_32x32x16_bf16 v[48:63], v[124:127], a[20:23], v[48:63]
    ds_read_b128 v[116:119], v4 offset:5120
    s_waitcnt lgkmcnt(4)
    buffer_load_dwordx4 a[68:71], v1, s[4:7], s26 offen offset:1024 sc1
    v_bfe_u32 v26, v0, 4, 1
    v_mfma_f32_32x32x16_bf16 v[64:79], a[20:23], v[96:99], v[64:79]
    ds_read_b128 v[120:123], v4 offset:6144
    v_lshl_add_u32 v25, v26, 17, v25
    v_mfma_f32_32x32x16_bf16 v[32:47], v[100:103], a[20:23], v[32:47]
    ds_read_b128 v[124:127], v4 offset:7168
    s_waitcnt vmcnt(15) lgkmcnt(4)
    buffer_load_dwordx4 a[72:75], v1, s[4:7], s26 offen offset:2048 sc1
    v_mfma_f32_32x32x16_bf16 v[48:63], v[104:107], a[24:27], v[48:63]
    ds_read_b128 v[96:99], v4 offset:8192
    v_mfma_f32_32x32x16_bf16 v[64:79], a[24:27], v[108:111], v[64:79]
    ds_read_b128 v[100:103], v4 offset:9216
    s_waitcnt vmcnt(15) lgkmcnt(4)
    buffer_load_dwordx4 a[76:79], v1, s[4:7], s26 offen offset:3072 sc1
    v_mfma_f32_32x32x16_bf16 v[32:47], v[112:115], a[24:27], v[32:47]
    ds_read_b128 v[104:107], v4 offset:10240
    v_mfma_f32_32x32x16_bf16 v[48:63], v[116:119], a[28:31], v[48:63]
    ds_read_b128 v[108:111], v4 offset:11264
    s_waitcnt lgkmcnt(4)
    v_mfma_f32_32x32x16_bf16 v[64:79], a[28:31], v[120:123], v[64:79]
    ds_read_b128 v[112:115], v4 offset:12288
    s_add_u32 s26, s26, 4096
    buffer_load_dwordx4 a[80:83], v1, s[4:7], s26 offen offset:0 sc1
    v_mfma_f32_32x32x16_bf16 v[32:47], v[124:127], a[28:31], v[32:47]
    ds_read_b128 v[116:119], v4 offset:13312
    s_waitcnt vmcnt(16) lgkmcnt(4)
    v_mfma_f32_32x32x16_bf16 v[48:63], v[96:99], a[32:35], v[48:63]
    ds_read_b128 v[120:123], v4 offset:14336
    buffer_load_dwordx4 a[84:87], v1, s[4:7], s26 offen offset:1024 sc1
    v_mfma_f32_32x32x16_bf16 v[64:79], a[32:35], v[100:103], v[64:79]
    ds_read_b128 v[124:127], v4 offset:15360
    s_waitcnt vmcnt(16) lgkmcnt(4)
    v_mfma_f32_32x32x16_bf16 v[48:63], v[104:107], a[36:39], v[48:63]
    ds_read_b128 v[96:99], v4 offset:16384
    buffer_load_dwordx4 a[88:91], v1, s[4:7], s26 offen offset:2048 sc1
    v_mfma_f32_32x32x16_bf16 v[64:79], a[36:39], v[108:111], v[64:79]
    ds_read_b128 v[100:103], v4 offset:17408
    s_waitcnt vmcnt(16) lgkmcnt(4)
    v_mfma_f32_32x32x16_bf16 v[48:63], v[112:115], a[40:43], v[48:63]
    ds_read_b128 v[104:107], v4 offset:18432
    buffer_load_dwordx4 a[92:95], v1, s[4:7], s26 offen offset:3072 sc1
    v_mfma_f32_32x32x16_bf16 v[64:79], a[40:43], v[116:119], v[64:79]
    ds_read_b128 v[108:111], v4 offset:19456
    s_waitcnt vmcnt(15) lgkmcnt(4)
    v_mfma_f32_32x32x16_bf16 v[48:63], v[120:123], a[44:47], v[48:63]
    ds_read_b128 v[112:115], v4 offset:20480
    s_add_u32 s26, s26, 4096
    buffer_load_dwordx4 a[96:99], v1, s[4:7], s26 offen offset:0 sc1
    v_mfma_f32_32x32x16_bf16 v[64:79], a[44:47], v[124:127], v[64:79]
    ds_read_b128 v[116:119], v4 offset:21504
    s_waitcnt vmcnt(15) lgkmcnt(4)
    v_mfma_f32_32x32x16_bf16 v[48:63], v[96:99], a[48:51], v[48:63]
    ds_read_b128 v[120:123], v4 offset:22528
    v_mfma_f32_32x32x16_bf16 v[64:79], a[48:51], v[100:103], v[64:79]
    ds_read_b128 v[124:127], v4 offset:23552
    s_waitcnt vmcnt(13) lgkmcnt(4)
    buffer_load_dwordx4 a[100:103], v1, s[4:7], s26 offen offset:1024 sc1
    v_mfma_f32_32x32x16_bf16 v[48:63], v[104:107], a[52:55], v[48:63]
    ds_read_b128 v[96:99], v4 offset:24576
    v_mfma_f32_32x32x16_bf16 v[64:79], a[52:55], v[108:111], v[64:79]
    ds_read_b128 v[100:103], v4 offset:25600
    s_waitcnt vmcnt(12) lgkmcnt(4)
    buffer_load_dwordx4 a[104:107], v1, s[4:7], s26 offen offset:2048 sc1
    v_mfma_f32_32x32x16_bf16 v[48:63], v[112:115], a[56:59], v[48:63]
    ds_read_b128 v[104:107], v4 offset:26624
    v_mfma_f32_32x32x16_bf16 v[64:79], a[56:59], v[116:119], v[64:79]
    ds_read_b128 v[108:111], v4 offset:27648
    s_waitcnt vmcnt(11) lgkmcnt(4)
    buffer_load_dwordx4 a[108:111], v1, s[4:7], s26 offen offset:3072 sc1
    v_mfma_f32_32x32x16_bf16 v[48:63], v[120:123], a[60:63], v[48:63]
    ds_read_b128 v[112:115], v4 offset:28672
    v_mfma_f32_32x32x16_bf16 v[64:79], a[60:63], v[124:127], v[64:79]
    ds_read_b128 v[116:119], v4 offset:29696
    s_waitcnt vmcnt(11) lgkmcnt(4)
    s_add_u32 s26, s26, 4096
    buffer_load_dwordx4 a[112:115], v1, s[4:7], s26 offen offset:0 sc1
    v_mfma_f32_32x32x16_bf16 v[48:63], v[96:99], a[64:67], v[48:63]
    ds_read_b128 v[120:123], v4 offset:30720
    v_add_f32 v8, v8, v10
    v_add_f32 v9, v9, v11
    v_add_f32 v12, v12, v14
    v_mfma_f32_32x32x16_bf16 v[64:79], a[64:67], v[100:103], v[64:79]
    ds_read_b128 v[124:127], v4 offset:31744
    s_waitcnt vmcnt(11) lgkmcnt(4)
    buffer_load_dwordx4 a[116:119], v1, s[4:7], s26 offen offset:1024 sc1
    v_add_f32 v13, v13, v15
    v_mfma_f32_32x32x16_bf16 v[48:63], v[104:107], a[68:71], v[48:63]
    s_barrier
    ds_read_b128 v[96:99], v4 offset:32768
    v_add_f32 v8, v8, v12
    v_add_f32 v9, v9, v13
    v_mov_b32 v10, v8
    v_mfma_f32_32x32x16_bf16 v[64:79], a[68:71], v[108:111], v[64:79]
    ds_read_b128 v[100:103], v4 offset:33792
    s_waitcnt vmcnt(11) lgkmcnt(4)
    v_mov_b32 v11, v9
    s_nop 1
    v_mfma_f32_32x32x16_bf16 v[48:63], v[112:115], a[72:75], v[48:63]
    ds_read_b128 v[104:107], v4 offset:34816
    buffer_load_dwordx4 a[120:123], v1, s[4:7], s26 offen offset:2048 sc1
    v_permlane32_swap_b32 v8, v10
    v_permlane32_swap_b32 v9, v11
    v_mfma_f32_32x32x16_bf16 v[64:79], a[72:75], v[116:119], v[64:79]
    ds_read_b128 v[108:111], v4 offset:35840
    s_waitcnt vmcnt(11) lgkmcnt(4)
    s_nop 1
    v_add_f32 v8, v8, v10
    v_mfma_f32_32x32x16_bf16 v[48:63], v[120:123], a[76:79], v[48:63]
    ds_read_b128 v[112:115], v4 offset:36864
    buffer_load_dwordx4 a[124:127], v1, s[4:7], s26 offen offset:3072 sc1
    v_add_f32 v9, v9, v11
    v_mul_f32 v8, 0xbb000000, v8
    v_mfma_f32_32x32x16_bf16 v[64:79], a[76:79], v[124:127], v[64:79]
    ds_read_b128 v[116:119], v4 offset:37888
    s_waitcnt vmcnt(11) lgkmcnt(4)
    v_mul_f32 v9, 0x3b000000, v9
    v_fma_f32 v9, -v8, v8, v9
    v_max_f32 v9, 0, v9
    v_mfma_f32_32x32x16_bf16 v[48:63], v[96:99], a[80:83], v[48:63]
    ds_read_b128 v[120:123], v4 offset:38912
    v_add_f32 v21, 0x3727c5ac, v9
    v_rsq_f32 v20, v21
    v_mov_b32 v10, 0
    v_mfma_f32_32x32x16_bf16 v[64:79], a[80:83], v[100:103], v[64:79]
    ds_read_b128 v[124:127], v4 offset:39936
    s_waitcnt vmcnt(10) lgkmcnt(4)
    v_cvt_pk_bf16_f32 v17, v8, v10
    v_lshlrev_b32 v11, 16, v17
    v_sub_f32 v11, v8, v11
    v_mfma_f32_32x32x16_bf16 v[48:63], v[104:107], a[84:87], v[48:63]
    ds_read_b128 v[96:99], v4 offset:40960
    s_add_u32 m0, s49, 131072
    s_add_u32 s54, s53, 81920
    v_cvt_pk_bf16_f32 v16, v8, v11
    v_mov_b32 v19, v17
    v_mfma_f32_32x32x16_bf16 v[64:79], a[84:87], v[108:111], v[64:79]
    ds_read_b128 v[100:103], v4 offset:41984
    s_waitcnt vmcnt(9) lgkmcnt(4)
    buffer_load_dwordx4 v1, s[4:7], s54 offen offset:0 sc1 lds
    v_mov_b32 v18, v16
    v_mfma_f32_32x32x16_bf16 v[48:63], v[112:115], a[88:91], v[48:63]
    ds_read_b128 v[104:107], v4 offset:43008
    buffer_load_dwordx4 v1, s[4:7], s54 offen offset:1024 sc1 lds
    s_lshl_b32 s29, s20, 8
    s_add_u32 s29, s29, 155648
    v_mfma_f32_32x32x16_bf16 v[64:79], a[88:91], v[116:119], v[64:79]
    ds_read_b128 v[108:111], v4 offset:44032
    s_waitcnt vmcnt(10) lgkmcnt(4)
    buffer_load_dwordx4 v1, s[4:7], s54 offen offset:2048 sc1 lds
    v_lshl_add_u32 v22, v0, 2, s29
    v_mfma_f32_32x32x16_bf16 v[48:63], v[120:123], a[92:95], v[48:63]
    ds_read_b128 v[112:115], v4 offset:45056
    buffer_load_dwordx4 v1, s[4:7], s54 offen offset:3072 sc1 lds
    ds_write_b32 v22, v20
    v_lshrrev_b32 v22, 5, v0
    v_mfma_f32_32x32x16_bf16 v[64:79], a[92:95], v[124:127], v[64:79]
    ds_read_b128 v[116:119], v4 offset:46080
    s_waitcnt vmcnt(11) lgkmcnt(5)
    s_mul_i32 s54, s20, 1024
    s_add_u32 m0, s54, 147456
    s_sub_u32 s54, s54, s49
    s_add_u32 s54, s54, s53
    s_add_u32 s54, s54, 98304
    v_mfma_f32_32x32x16_bf16 v[48:63], v[96:99], a[96:99], v[48:63]
    ds_read_b128 v[120:123], v4 offset:47104
    buffer_load_dwordx4 v1, s[4:7], s54 offen offset:0 sc1 lds
    v_lshl_add_u32 v22, v22, 4, s29
    ds_read_b128 v[128:131], v22 offset:0
    v_mfma_f32_32x32x16_bf16 v[64:79], a[96:99], v[100:103], v[64:79]
    ds_read_b128 v[124:127], v4 offset:48128
    s_waitcnt vmcnt(11) lgkmcnt(6)
    ds_read_b128 v[132:135], v22 offset:32
    ds_read_b128 v[136:139], v22 offset:64
    ds_read_b128 v[140:143], v22 offset:96
    v_mfma_f32_32x32x16_bf16 v[48:63], v[104:107], a[100:103], v[48:63]
    ds_read_b128 v[96:99], v4 offset:49152
    v_mul_f32 v23, 0x3eb8aa3b, v20
    s_lshr_b32 s35, s100, 1
    s_mul_i32 s35, s35, 128
    v_mul_u32_u24 v240, 2048, v0
    v_mfma_f32_32x32x16_bf16 v[64:79], a[100:103], v[108:111], v[64:79]
    ds_read_b128 v[100:103], v4 offset:50176
    s_waitcnt vmcnt(10) lgkmcnt(8)
    s_add_u32 s35, s35, 60817408
    v_mfma_f32_32x32x16_bf16 v[48:63], v[112:115], a[104:107], v[48:63]
    ds_read_b128 v[104:107], v4 offset:51200
    v_mfma_f32_32x32x16_bf16 v[64:79], a[104:107], v[116:119], v[64:79]
    ds_read_b128 v[108:111], v4 offset:52224
    s_waitcnt vmcnt(9) lgkmcnt(7)
    v_mfma_f32_32x32x16_bf16 v[48:63], v[120:123], a[108:111], v[48:63]
    ds_read_b128 v[112:115], v4 offset:53248
    v_mfma_f32_32x32x16_bf16 v[64:79], a[108:111], v[124:127], v[64:79]
    ds_read_b128 v[116:119], v4 offset:54272
    s_waitcnt vmcnt(8) lgkmcnt(4)
    v_mfma_f32_32x32x16_bf16 v[48:63], v[96:99], a[112:115], v[48:63]
    ds_read_b128 v[120:123], v4 offset:55296
    v_mfma_f32_32x32x16_bf16 v[64:79], a[112:115], v[100:103], v[64:79]
    ds_read_b128 v[124:127], v4 offset:56320
    s_waitcnt vmcnt(7) lgkmcnt(4)
    v_mfma_f32_32x32x16_bf16 v[48:63], v[104:107], a[116:119], v[48:63]
    ds_read_b128 v[96:99], v4 offset:57344
    v_mfma_f32_32x32x16_bf16 v[64:79], a[116:119], v[108:111], v[64:79]
    ds_read_b128 v[100:103], v4 offset:58368
    s_waitcnt vmcnt(6) lgkmcnt(4)
    v_mfma_f32_32x32x16_bf16 v[48:63], v[112:115], a[120:123], v[48:63]
    ds_read_b128 v[104:107], v4 offset:59392
    v_mfma_f32_32x32x16_bf16 v[64:79], a[120:123], v[116:119], v[64:79]
    ds_read_b128 v[108:111], v4 offset:60416
    s_waitcnt vmcnt(5) lgkmcnt(4)
    v_mfma_f32_32x32x16_bf16 v[48:63], v[120:123], a[124:127], v[48:63]
    ds_read_b128 v[112:115], v4 offset:61440
    v_mfma_f32_32x32x16_bf16 v[64:79], a[124:127], v[124:127], v[64:79]
    ds_read_b128 v[116:119], v4 offset:62464
    s_waitcnt lgkmcnt(4)
    v_mfma_f32_32x32x16_bf16 v[48:63], v[96:99], v[16:19], v[48:63]
    ds_read_b128 v[120:123], v4 offset:63488
    v_mfma_f32_32x32x16_bf16 v[64:79], v[16:19], v[100:103], v[64:79]
    ds_read_b128 v[124:127], v4 offset:64512
    s_waitcnt lgkmcnt(4)
    v_mfma_f32_32x32x16_bf16 v[32:47], v[104:107], a[32:35], v[32:47]
    s_waitcnt vmcnt(1)
    s_barrier
    ds_read_b128 v[96:99], v5 offset:0
    v_mfma_f32_32x32x16_bf16 v[32:47], v[108:111], a[36:39], v[32:47]
    ds_read_b128 v[100:103], v5 offset:1024
    s_waitcnt lgkmcnt(4)
    v_mfma_f32_32x32x16_bf16 v[32:47], v[112:115], a[40:43], v[32:47]
    ds_read_b128 v[104:107], v5 offset:2048
    v_mfma_f32_32x32x16_bf16 v[32:47], v[116:119], a[44:47], v[32:47]
    ds_read_b128 v[108:111], v5 offset:3072
    s_waitcnt lgkmcnt(4)
    v_mfma_f32_32x32x16_bf16 v[32:47], v[120:123], a[48:51], v[32:47]
    ds_read_b128 v[112:115], v5 offset:4096
    v_mfma_f32_32x32x16_bf16 v[32:47], v[124:127], a[52:55], v[32:47]
    ds_read_b128 v[116:119], v5 offset:5120
    s_waitcnt lgkmcnt(4)
    v_mul_f32 v48, v20, v48
    v_mul_f32 v49, v20, v49
    v_mul_f32 v50, v20, v50
    v_mul_f32 v51, v20, v51
    v_mfma_f32_32x32x16_bf16 v[32:47], v[96:99], a[56:59], v[32:47]
    ds_read_b128 v[120:123], v5 offset:6144
    v_mul_f32 v52, v20, v52
    v_mul_f32 v53, v20, v53
    v_mul_f32 v54, v20, v54
    v_mul_f32 v55, v20, v55
    v_cvt_pk_bf16_f32 v152, v48, v49
    v_mfma_f32_32x32x16_bf16 v[32:47], v[100:103], a[60:63], v[32:47]
    ds_read_b128 v[124:127], v5 offset:7168
    s_waitcnt lgkmcnt(4)
    v_cvt_pk_bf16_f32 v153, v50, v51
    v_cvt_pk_bf16_f32 v154, v52, v53
    v_cvt_pk_bf16_f32 v155, v54, v55
    buffer_store_dwordx4 v[152:155], v24, s[4:7], s31 offen sc1
    v_mfma_f32_32x32x16_bf16 v[32:47], v[104:107], a[64:67], v[32:47]
    ds_read_b128 v[96:99], v5 offset:8192
    v_mul_f32 v56, v20, v56
    v_mul_f32 v57, v20, v57
    v_mul_f32 v58, v20, v58
    v_mul_f32 v59, v20, v59
    v_mul_f32 v60, v20, v60
    v_mfma_f32_32x32x16_bf16 v[32:47], v[108:111], a[68:71], v[32:47]
    ds_read_b128 v[100:103], v5 offset:9216
    s_waitcnt lgkmcnt(4)
    v_mul_f32 v61, v20, v61
    v_mul_f32 v62, v20, v62
    v_mul_f32 v63, v20, v63
    v_cvt_pk_bf16_f32 v156, v56, v57
    v_mfma_f32_32x32x16_bf16 v[32:47], v[112:115], a[72:75], v[32:47]
    ds_read_b128 v[104:107], v5 offset:10240
    v_cvt_pk_bf16_f32 v157, v58, v59
    v_cvt_pk_bf16_f32 v158, v60, v61
    v_cvt_pk_bf16_f32 v159, v62, v63
    buffer_store_dwordx4 v[156:159], v24, s[4:7], s33 offen sc1
    v_mul_f32 v64, v128, v64
    v_mfma_f32_32x32x16_bf16 v[32:47], v[116:119], a[76:79], v[32:47]
    ds_read_b128 v[108:111], v5 offset:11264
    s_waitcnt lgkmcnt(4)
    v_mul_f32 v65, v129, v65
    v_mul_f32 v66, v130, v66
    v_mul_f32 v67, v131, v67
    v_mul_f32 v68, v132, v68
    v_mfma_f32_32x32x16_bf16 v[32:47], v[120:123], a[80:83], v[32:47]
    ds_read_b128 v[112:115], v5 offset:12288
    v_mul_f32 v69, v133, v69
    v_mul_f32 v70, v134, v70
    v_mul_f32 v71, v135, v71
    v_cvt_pk_bf16_f32 v160, v64, v65
    v_cvt_pk_bf16_f32 v161, v66, v67
    v_mfma_f32_32x32x16_bf16 v[32:47], v[124:127], a[84:87], v[32:47]
    ds_read_b128 v[116:119], v5 offset:13312
    s_waitcnt lgkmcnt(4)
    v_cvt_pk_bf16_f32 v162, v68, v69
    v_cvt_pk_bf16_f32 v163, v70, v71
    buffer_store_dwordx4 v[160:163], v25, s[4:7], s31 offen offset:1024 sc1
    v_mul_f32 v72, v136, v72
    v_mfma_f32_32x32x16_bf16 v[32:47], v[96:99], a[88:91], v[32:47]
    ds_read_b128 v[120:123], v5 offset:14336
    v_mul_f32 v73, v137, v73
    v_mul_f32 v74, v138, v74
    v_mul_f32 v75, v139, v75
    v_mul_f32 v76, v140, v76
    v_mul_f32 v77, v141, v77
    v_mfma_f32_32x32x16_bf16 v[32:47], v[100:103], a[92:95], v[32:47]
    ds_read_b128 v[124:127], v5 offset:15360
    s_waitcnt lgkmcnt(4)
    v_mul_f32 v78, v142, v78
    v_mul_f32 v79, v143, v79
    v_cvt_pk_bf16_f32 v164, v72, v73
    v_cvt_pk_bf16_f32 v165, v74, v75
    v_mfma_f32_32x32x16_bf16 v[32:47], v[104:107], a[96:99], v[32:47]
    s_waitcnt vmcnt(3)
    s_barrier
    ds_read_b128 v[96:99], v5 offset:16384
    v_cvt_pk_bf16_f32 v166, v76, v77
    v_cvt_pk_bf16_f32 v167, v78, v79
    buffer_store_dwordx4 v[164:167], v25, s[4:7], s31 offen offset:1536 sc1
    v_mfma_f32_32x32x16_bf16 v[32:47], v[108:111], a[100:103], v[32:47]
    ds_read_b128 v[100:103], v5 offset:17408
    s_waitcnt lgkmcnt(4)
    v_mfma_f32_32x32x16_bf16 v[32:47], v[112:115], a[104:107], v[32:47]
    ds_read_b128 v[104:107], v5 offset:18432
    v_mfma_f32_32x32x16_bf16 v[32:47], v[116:119], a[108:111], v[32:47]
    s_waitcnt lgkmcnt(3)
    v_mfma_f32_32x32x16_bf16 v[32:47], v[120:123], a[112:115], v[32:47]
    v_mfma_f32_32x32x16_bf16 v[32:47], v[124:127], a[116:119], v[32:47]
    s_waitcnt lgkmcnt(1)
    v_mfma_f32_32x32x16_bf16 v[32:47], v[96:99], a[120:123], v[32:47]
    v_mfma_f32_32x32x16_bf16 v[32:47], v[100:103], a[124:127], v[32:47]
    s_waitcnt lgkmcnt(0)
    v_mfma_f32_32x32x16_bf16 v[32:47], v[104:107], v[16:19], v[32:47]
    s_nop 11
    v_mul_f32 v32, v23, v32
    v_mul_f32 v33, v23, v33
    v_mul_f32 v34, v23, v34
    v_mul_f32 v35, v23, v35
    v_mul_f32 v36, v23, v36
    v_mul_f32 v37, v23, v37
    v_mul_f32 v38, v23, v38
    v_mul_f32 v39, v23, v39
    v_cvt_pk_bf16_f32 v144, v32, v33
    v_cvt_pk_bf16_f32 v145, v34, v35
    v_cvt_pk_bf16_f32 v146, v36, v37
    v_cvt_pk_bf16_f32 v147, v38, v39
    buffer_store_dwordx4 v[144:147], v1, s[4:7], s30 offen sc1
    v_mul_f32 v40, v23, v40
    v_mul_f32 v41, v23, v41
    v_mul_f32 v42, v23, v42
    v_mul_f32 v43, v23, v43
    v_mul_f32 v44, v23, v44
    v_mul_f32 v45, v23, v45
    v_mul_f32 v46, v23, v46
    v_mul_f32 v47, v23, v47
    v_cvt_pk_bf16_f32 v148, v40, v41
    v_cvt_pk_bf16_f32 v149, v42, v43
    v_cvt_pk_bf16_f32 v150, v44, v45
    v_cvt_pk_bf16_f32 v151, v46, v47
    buffer_store_dwordx4 v[148:151], v1, s[4:7], s32 offen sc1
    s_add_u32 s61, s61, 1
    s_add_u32 s34, s55, 32768
    v_mov_b32 v2, s61
    s_waitcnt vmcnt(0)
    s_barrier
    s_mov_b64 exec, 1
    buffer_store_dword v2, off, s[4:7], s55 sc1
    s_mov_b64 exec, -1
    s_lshl_b32 s25, s100, 6
    s_lshl_b32 s26, s101, 3
    s_add_u32 s25, s25, s26
    s_lshl_b32 s25, s25, 10
    s_add_u32 s25, s25, s48
    s_add_u32 s25, s25, 5242880
    s_lshl_b32 s36, s100, 17
    s_add_u32 s36, s36, s48
    s_add_u32 s36, s36, 7340032
    s_lshl_b32 s26, s20, 15
    s_add_u32 s26, s26, s36
    s_add_u32 s26, s26, 4096
    s_add_u32 s86, s4, s26
    s_addc_u32 s87, s5, 0
    s_lshl_b32 s28, s101, 3
    s_lshl_b32 s29, s20, 1
    s_add_u32 s28, s28, s29
    s_lshl_b32 s28, s28, 15
    s_lshl_b32 s29, s100, 10
    s_add_u32 s28, s28, s29
    s_add_u32 s28, s28, s48
    s_add_u32 s28, s28, 11534336
    s_add_u32 s29, s28, 32768
    s_mov_b32 s40, 0x0000ffff
    s_mov_b32 s41, 0x0000ffff
    v_and_b32 v7, 15, v0
    v_lshlrev_b32 v7, 4, v7
    v_lshrrev_b32 v2, 5, v0
    v_lshl_add_u32 v7, v2, 8, v7
    v_mov_b32 v3, 0xdddddddd
    v_and_b32 v2, 27, v0
    v_cmp_eq_u32 vcc, 16, v2
    v_mov_b32 v2, 0
    v_mov_b32 v6, 0x3f803f80
    v_cndmask_b32 v2, v2, v6, vcc
    s_add_u32 s42, s20, 1
    s_and_b32 s42, s42, 3
    s_mul_i32 s37, s42, 13824
    s_add_u32 s37, s37, 106496
    v_add_u32 v8, s37, v1
    v_lshl_add_u32 v9, v0, 2, s37
    s_lshl_b32 s42, s42, 11
    s_add_u32 s42, s42, s25
    s_add_u32 s43, s20, 2
    s_and_b32 s43, s43, 3
    s_mul_i32 s37, s43, 13824
    s_add_u32 s37, s37, 111104
    v_add_u32 v10, s37, v1
    v_lshl_add_u32 v11, v0, 2, s37
    s_lshl_b32 s43, s43, 11
    s_add_u32 s43, s43, s25
    s_add_u32 s44, s20, 3
    s_and_b32 s44, s44, 3
    s_mul_i32 s37, s44, 13824
    s_add_u32 s37, s37, 115712
    v_add_u32 v12, s37, v1
    v_lshl_add_u32 v13, v0, 2, s37
    s_lshl_b32 s44, s44, 11
    s_add_u32 s44, s44, s25
    s_add_u32 s45, s20, 4
    s_and_b32 s45, s45, 3
    s_mul_i32 s37, s20, 13824
    s_add_u32 s37, s37, 106496
    v_add_u32 v14, s37, v1
    v_lshl_add_u32 v15, v0, 2, s37
    s_lshl_b32 s45, s45, 11
    s_add_u32 s45, s45, s25
    v_mov_b32 v16, 0x3afe3f80
    v_mov_b32 v17, 0
    v_mov_b32 v18, 0
    v_mov_b32 v19, 0
    v_mov_b32 v20, 0
    v_mov_b32 v21, 0
    v_cndmask_b32 v16, v17, v16, vcc
    v_cmp_gt_u32 vcc, 32, v0
    v_mov_b32 v22, 0
    v_mov_b32 v23, 0
    v_mov_b32 v24, 0
    v_cndmask_b32 v20, v17, v6, vcc
    v_mov_b32 v25, 0
    v_mov_b32 v26, 0
    v_mov_b32 v27, 0
    s_nop 0
    v_mfma_f32_32x32x16_bf16 a[32:47], v[20:23], v[16:19], 0
    v_mfma_f32_32x32x16_bf16 a[48:63], v[20:23], v[16:19], 0
    v_mfma_f32_32x32x16_bf16 a[64:79], v[20:23], v[16:19], 0
    v_mfma_f32_32x32x16_bf16 v[64:79], v[24:27], v[24:27], 0
    v_mfma_f32_32x32x16_bf16 v[80:95], v[24:27], v[24:27], 0
    v_mfma_f32_32x32x16_bf16 v[96:111], v[24:27], v[24:27], 0
    v_mfma_f32_32x32x16_bf16 v[112:127], v[24:27], v[24:27], 0
    v_mfma_f32_32x32x16_bf16 v[128:143], v[24:27], v[24:27], 0
    v_mfma_f32_32x32x16_bf16 v[144:159], v[24:27], v[24:27], 0
    v_mfma_f32_32x32x16_bf16 v[160:175], v[24:27], v[24:27], 0
    v_mfma_f32_32x32x16_bf16 v[176:191], v[24:27], v[24:27], 0
    s_cmp_lg_u32 s20, 1
    s_cbranch_scc1 L_go12
    s_mov_b32 exec_lo, 0xffff
    s_mov_b32 exec_hi, 0
    buffer_load_dword v241, v240, s[4:7], s35 offen sc1
    s_mov_b64 exec, -1
L_go12:
    s_cmp_lg_u32 s20, 1
    s_cbranch_scc1 L_go13
    s_mov_b32 exec_lo, 0xffff
    s_mov_b32 exec_hi, 0
    s_mov_b32 s60, 0
    s_add_u32 s34, s35, 32768
    s_waitcnt vmcnt(0)
    v_cmp_gt_u32 vcc, s61, v241
    s_cbranch_vccz L_done13
    s_mov_b64 exec, vcc
L_poll13:
    buffer_load_dword v2, v240, s[4:7], s35 offen sc1
    s_add_u32 s60, s60, 1
    s_waitcnt vmcnt(0)
    v_cmp_gt_u32 vcc, s61, v2
    s_cbranch_vccz L_done13
    s_mov_b64 exec, vcc
    s_cmp_lt_u32 s60, 0x20000
    s_cbranch_scc1 L_poll13
L_done13:
    s_mov_b64 exec, -1
L_go13:
    s_barrier
    v_mov_b32 v224, 1073741824
    v_mov_b32 v225, 0
    v_mov_b32 v226, 1073741824
    s_branch L_attn
L_final:
    s_waitcnt vmcnt(8)
    v_mfma_f32_16x16x32_bf16 v[48:51], v[224:227], a[60:63], v[48:51]
    v_mfma_f32_16x16x32_bf16 v[52:55], v[228:231], a[60:63], v[52:55]
    ds_write_b128 v12, v[44:47] offset:3072
    v_mfma_f32_16x16x32_bf16 v[56:59], v[232:235], a[60:63], v[56:59]
    v_mov_b32 v2, s61
    s_mov_b64 exec, 1
    buffer_store_dword v2, off, s[4:7], s55 sc1
    s_mov_b64 exec, -1
    v_mfma_f32_16x16x32_bf16 v[60:63], v[236:239], a[60:63], v[60:63]
    s_waitcnt vmcnt(8)
    v_mfma_f32_16x16x32_bf16 v[64:67], a[176:179], a[64:67], v[64:67]
    v_mfma_f32_16x16x32_bf16 v[68:71], a[180:183], a[64:67], v[68:71]
    ds_write_b128 v13, v[48:51] offset:0
    v_mfma_f32_16x16x32_bf16 v[72:75], a[184:187], a[64:67], v[72:75]
    v_mfma_f32_16x16x32_bf16 v[76:79], a[188:191], a[64:67], v[76:79]
    s_waitcnt vmcnt(7)
    v_mfma_f32_16x16x32_bf16 v[64:67], a[192:195], a[68:71], v[64:67]
    v_mfma_f32_16x16x32_bf16 v[68:71], a[196:199], a[68:71], v[68:71]
    ds_write_b128 v13, v[52:55] offset:1024
    v_mfma_f32_16x16x32_bf16 v[72:75], a[200:203], a[68:71], v[72:75]
    v_mfma_f32_16x16x32_bf16 v[76:79], a[204:207], a[68:71], v[76:79]
    s_waitcnt vmcnt(6)
    v_mfma_f32_16x16x32_bf16 v[64:67], v[208:211], a[72:75], v[64:67]
    v_mfma_f32_16x16x32_bf16 v[68:71], v[212:215], a[72:75], v[68:71]
    ds_write_b128 v13, v[56:59] offset:2048
    v_mfma_f32_16x16x32_bf16 v[72:75], v[216:219], a[72:75], v[72:75]
    v_mfma_f32_16x16x32_bf16 v[76:79], v[220:223], a[72:75], v[76:79]
    s_waitcnt vmcnt(5)
    v_mfma_f32_16x16x32_bf16 v[64:67], v[224:227], a[76:79], v[64:67]
    v_mfma_f32_16x16x32_bf16 v[68:71], v[228:231], a[76:79], v[68:71]
    ds_write_b128 v13, v[60:63] offset:3072
    v_mfma_f32_16x16x32_bf16 v[72:75], v[232:235], a[76:79], v[72:75]
    v_mfma_f32_16x16x32_bf16 v[76:79], v[236:239], a[76:79], v[76:79]
    v_mfma_f32_16x16x32_bf16 v[16:19], a[128:131], a[124:127], v[16:19]
    v_mfma_f32_16x16x32_bf16 v[20:23], a[132:135], a[124:127], v[20:23]
    s_nop 1
    ds_write_b128 v14, v[64:67] offset:0
    v_mfma_f32_16x16x32_bf16 v[24:27], a[136:139], a[124:127], v[24:27]
    v_mfma_f32_16x16x32_bf16 v[28:31], a[140:143], a[124:127], v[28:31]
    v_mfma_f32_16x16x32_bf16 v[16:19], a[144:147], a[12:15], v[16:19]
    v_mfma_f32_16x16x32_bf16 v[20:23], a[148:151], a[12:15], v[20:23]
    ds_write_b128 v14, v[68:71] offset:1024
    v_mfma_f32_16x16x32_bf16 v[24:27], a[152:155], a[12:15], v[24:27]
    v_mfma_f32_16x16x32_bf16 v[28:31], a[156:159], a[12:15], v[28:31]
    v_mfma_f32_16x16x32_bf16 v[16:19], a[160:163], a[28:31], v[16:19]
    v_mfma_f32_16x16x32_bf16 v[20:23], a[164:167], a[28:31], v[20:23]
    ds_write_b128 v14, v[72:75] offset:2048
    v_mfma_f32_16x16x32_bf16 v[24:27], a[168:171], a[28:31], v[24:27]
    v_mfma_f32_16x16x32_bf16 v[28:31], a[172:175], a[28:31], v[28:31]
    s_waitcnt vmcnt(4)
    v_mfma_f32_16x16x32_bf16 v[16:19], a[176:179], a[80:83], v[16:19]
    v_mfma_f32_16x16x32_bf16 v[20:23], a[180:183], a[80:83], v[20:23]
    ds_write_b128 v14, v[76:79] offset:3072
    v_mfma_f32_16x16x32_bf16 v[24:27], a[184:187], a[80:83], v[24:27]
    v_mfma_f32_16x16x32_bf16 v[28:31], a[188:191], a[80:83], v[28:31]
    s_waitcnt vmcnt(3)
    v_mfma_f32_16x16x32_bf16 v[16:19], a[192:195], a[84:87], v[16:19]
    s_waitcnt lgkmcnt(0)
    s_barrier
    v_mfma_f32_16x16x32_bf16 v[20:23], a[196:199], a[84:87], v[20:23]
    ds_read_b128 v[32:35], v15 offset:0
    ds_read_b128 v[48:51], v15 offset:4096
    v_mfma_f32_16x16x32_bf16 v[24:27], a[200:203], a[84:87], v[24:27]
    ds_read_b128 v[64:67], v15 offset:8192
    v_mfma_f32_16x16x32_bf16 v[28:31], a[204:207], a[84:87], v[28:31]
    ds_read_b128 v[36:39], v15 offset:1024
    s_waitcnt vmcnt(2)
    v_mfma_f32_16x16x32_bf16 v[16:19], v[208:211], a[88:91], v[16:19]
    ds_read_b128 v[52:55], v15 offset:5120
    ds_read_b128 v[68:71], v15 offset:9216
    v_mfma_f32_16x16x32_bf16 v[20:23], v[212:215], a[88:91], v[20:23]
    ds_read_b128 v[40:43], v15 offset:2048
    v_mfma_f32_16x16x32_bf16 v[24:27], v[216:219], a[88:91], v[24:27]
    ds_read_b128 v[56:59], v15 offset:6144
    v_mfma_f32_16x16x32_bf16 v[28:31], v[220:223], a[88:91], v[28:31]
    ds_read_b128 v[72:75], v15 offset:10240
    ds_read_b128 v[44:47], v15 offset:3072
    s_waitcnt vmcnt(1)
    v_mfma_f32_16x16x32_bf16 v[16:19], v[224:227], a[92:95], v[16:19]
    ds_read_b128 v[60:63], v15 offset:7168
    v_mfma_f32_16x16x32_bf16 v[20:23], v[228:231], a[92:95], v[20:23]
    ds_read_b128 v[76:79], v15 offset:11264
    v_mfma_f32_16x16x32_bf16 v[24:27], v[232:235], a[92:95], v[24:27]
    v_mfma_f32_16x16x32_bf16 v[28:31], v[236:239], a[92:95], v[28:31]
    s_lshl_b32 s31, s57, 14
    s_and_b32 s23, s22, 7
    s_lshl_b32 s23, s23, 7
    s_add_u32 s31, s31, s23
    v_and_b32 v2, 15, v0
    v_lshrrev_b32 v3, 4, v0
    v_lshlrev_b32 v7, 10, v2
    v_lshl_add_u32 v7, v3, 4, v7
    v_mul_u32_u24 v8, 144, v2
    v_lshl_add_u32 v8, v3, 4, v8
    s_add_u32 s23, s49, 65536
    v_add_u32 v8, s23, v8
    v_lshrrev_b32 v2, 3, v0
    v_and_b32 v3, 0x70, v1
    v_lshl_add_u32 v7, v2, 10, v3
    v_mul_u32_u24 v9, 144, v2
    v_add3_u32 v9, v9, v3, s23
    s_add_u32 s30, s31, 8192
    s_waitcnt lgkmcnt(9)
    v_pk_add_f32 v[32:33], v[32:33], v[48:49]
    v_pk_add_f32 v[34:35], v[34:35], v[50:51]
    v_pk_add_f32 v[32:33], v[32:33], v[64:65]
    v_pk_add_f32 v[34:35], v[34:35], v[66:67]
    s_waitcnt lgkmcnt(6)
    v_pk_add_f32 v[36:37], v[36:37], v[52:53]
    v_pk_add_f32 v[38:39], v[38:39], v[54:55]
    v_pk_add_f32 v[36:37], v[36:37], v[68:69]
    v_pk_add_f32 v[38:39], v[38:39], v[70:71]
    s_waitcnt lgkmcnt(3)
    v_pk_add_f32 v[40:41], v[40:41], v[56:57]
    v_pk_add_f32 v[42:43], v[42:43], v[58:59]
    v_pk_add_f32 v[40:41], v[40:41], v[72:73]
    v_pk_add_f32 v[42:43], v[42:43], v[74:75]
    s_waitcnt lgkmcnt(0)
    v_pk_add_f32 v[44:45], v[44:45], v[60:61]
    v_pk_add_f32 v[46:47], v[46:47], v[62:63]
    v_pk_add_f32 v[44:45], v[44:45], v[76:77]
    v_pk_add_f32 v[46:47], v[46:47], v[78:79]
    v_pk_add_f32 v[16:17], v[16:17], v[32:33]
    v_pk_add_f32 v[18:19], v[18:19], v[34:35]
    v_pk_add_f32 v[20:21], v[20:21], v[36:37]
    v_pk_add_f32 v[22:23], v[22:23], v[38:39]
    v_cvt_pk_bf16_f32 v248, v16, v17
    v_cvt_pk_bf16_f32 v249, v18, v19
    v_cvt_pk_bf16_f32 v250, v20, v21
    v_cvt_pk_bf16_f32 v251, v22, v23
    ds_write_b128 v8, v[248:251] offset:0
    v_pk_add_f32 v[24:25], v[24:25], v[40:41]
    v_pk_add_f32 v[26:27], v[26:27], v[42:43]
    v_pk_add_f32 v[28:29], v[28:29], v[44:45]
    v_pk_add_f32 v[30:31], v[30:31], v[46:47]
    v_cvt_pk_bf16_f32 v252, v24, v25
    v_cvt_pk_bf16_f32 v253, v26, v27
    v_cvt_pk_bf16_f32 v254, v28, v29
    v_cvt_pk_bf16_f32 v255, v30, v31
    ds_write_b128 v8, v[252:255] offset:64
    ds_read_b128 v[32:35], v9 offset:0
    ds_read_b128 v[36:39], v9 offset:1152
    s_waitcnt lgkmcnt(1)
    buffer_store_dwordx4 v[32:35], v7, s[8:11], s31 offen sc1
    s_waitcnt lgkmcnt(0)
    buffer_store_dwordx4 v[36:39], v7, s[8:11], s30 offen sc1
    s_endpgm
L_bsig:
    v_mov_b32 v2, 1
    s_waitcnt vmcnt(3)
    s_barrier
    s_mov_b64 exec, 1
    buffer_store_dword v2, off, s[4:7], s55 offset:4 sc1
    s_mov_b64 exec, -1
    s_branch L_bsig_ret
L_bld:
    s_mul_i32 s23, s20, 8192
    s_add_u32 s23, s23, 60817408
    v_mul_u32_u24 v233, 128, v0
    buffer_load_dword v232, v233, s[4:7], s23 offen offset:4 sc1
    s_branch L_bld_ret
L_bchk:
    s_mov_b32 s60, 0
    s_waitcnt vmcnt(3)
L_bchk_loop:
    v_cmp_eq_u32 vcc, 0, v232
    s_cbranch_vccz L_bchk_ok
    buffer_load_dword v232, v233, s[4:7], s23 offen offset:4 sc1
    s_add_u32 s60, s60, 1
    s_waitcnt vmcnt(0)
    s_cmp_lt_u32 s60, 0x8000
    s_cbranch_scc1 L_bchk_loop
L_bchk_ok:
    s_barrier
    s_branch L_bchk_ret
L_late6:
    s_mov_b32 s60, 0
L_lp6:
    s_mov_b32 exec_lo, 0xffff
    s_mov_b32 exec_hi, 0
    buffer_load_ubyte v2, v0, s[4:7], s24 offen sc1
    s_add_u32 s60, s60, 1
    s_waitcnt vmcnt(0)
    v_cmp_eq_u32 vcc, 0, v2
    s_cbranch_vccz L_ld6
    s_cmp_lt_u32 s60, s1
    s_cbranch_scc1 L_lp6
    s_cmp_gt_u32 s60, s1
    s_cbranch_scc1 L_lq6
    s_lshl_b32 s34, s21, 5
    s_add_u32 s34, s34, s22
    s_mul_i32 s34, s34, 128
    s_add_u32 s34, s34, 60817408
    v_mov_b32 v2, s61
    s_mov_b64 exec, 1
    buffer_store_dword v2, off, s[4:7], s34 sc1
    s_mov_b32 exec_lo, 0xffff
L_lq6:
    buffer_load_dword v2, v240, s[4:7], s35 offen sc1
    s_waitcnt vmcnt(0)
    v_cmp_gt_u32 vcc, s61, v2
    s_cbranch_vccz L_lf6
    s_cmp_lt_u32 s60, 0x10000
    s_cbranch_scc1 L_lp6
L_lf6:
    s_mov_b32 s1, 1
L_ld6:
    s_mov_b64 exec, -1
    s_branch L_back6
L_late7:
    s_mov_b32 s60, 0
L_lp7:
    s_mov_b32 exec_lo, 0xffff
    s_mov_b32 exec_hi, 0
    buffer_load_ubyte v2, v0, s[4:7], s24 offen sc1
    s_add_u32 s60, s60, 1
    s_waitcnt vmcnt(0)
    v_cmp_eq_u32 vcc, 0, v2
    s_cbranch_vccz L_ld7
    s_cmp_lt_u32 s60, s1
    s_cbranch_scc1 L_lp7
    s_cmp_gt_u32 s60, s1
    s_cbranch_scc1 L_lq7
    s_lshl_b32 s34, s21, 5
    s_add_u32 s34, s34, s22
    s_mul_i32 s34, s34, 128
    s_add_u32 s34, s34, 60817408
    v_mov_b32 v2, s61
    s_mov_b64 exec, 1
    buffer_store_dword v2, off, s[4:7], s34 sc1
    s_mov_b32 exec_lo, 0xffff
L_lq7:
    buffer_load_dword v2, v240, s[4:7], s35 offen sc1
    s_waitcnt vmcnt(0)
    v_cmp_gt_u32 vcc, s61, v2
    s_cbranch_vccz L_lf7
    s_cmp_lt_u32 s60, 0x10000
    s_cbranch_scc1 L_lp7
L_lf7:
    s_mov_b32 s1, 1
L_ld7:
    s_mov_b64 exec, -1
    s_branch L_back7
L_late8:
    s_mov_b32 s60, 0
L_lp8:
    s_mov_b32 exec_lo, 0xffff
    s_mov_b32 exec_hi, 0
    buffer_load_ubyte v2, v0, s[4:7], s24 offen sc1
    s_add_u32 s60, s60, 1
    s_waitcnt vmcnt(0)
    v_cmp_eq_u32 vcc, 0, v2
    s_cbranch_vccz L_ld8
    s_cmp_lt_u32 s60, s1
    s_cbranch_scc1 L_lp8
    s_cmp_gt_u32 s60, s1
    s_cbranch_scc1 L_lq8
    s_lshl_b32 s34, s21, 5
    s_add_u32 s34, s34, s22
    s_mul_i32 s34, s34, 128
    s_add_u32 s34, s34, 60817408
    v_mov_b32 v2, s61
    s_mov_b64 exec, 1
    buffer_store_dword v2, off, s[4:7], s34 sc1
    s_mov_b32 exec_lo, 0xffff
L_lq8:
    buffer_load_dword v2, v240, s[4:7], s35 offen sc1
    s_waitcnt vmcnt(0)
    v_cmp_gt_u32 vcc, s61, v2
    s_cbranch_vccz L_lf8
    s_cmp_lt_u32 s60, 0x10000
    s_cbranch_scc1 L_lp8
L_lf8:
    s_mov_b32 s1, 1
L_ld8:
    s_mov_b64 exec, -1
    s_branch L_back8
L_late9:
    s_mov_b32 s60, 0
L_lp9:
    s_mov_b32 exec_lo, 0xffff
    s_mov_b32 exec_hi, 0
    buffer_load_ubyte v2, v0, s[4:7], s24 offen sc1
    s_add_u32 s60, s60, 1
    s_waitcnt vmcnt(0)
    v_cmp_eq_u32 vcc, 0, v2
    s_cbranch_vccz L_ld9
    s_cmp_lt_u32 s60, s1
    s_cbranch_scc1 L_lp9
    s_cmp_gt_u32 s60, s1
    s_cbranch_scc1 L_lq9
    s_lshl_b32 s34, s21, 5
    s_add_u32 s34, s34, s22
    s_mul_i32 s34, s34, 128
    s_add_u32 s34, s34, 60817408
    v_mov_b32 v2, s61
    s_mov_b64 exec, 1
    buffer_store_dword v2, off, s[4:7], s34 sc1
    s_mov_b32 exec_lo, 0xffff
L_lq9:
    buffer_load_dword v2, v240, s[4:7], s35 offen sc1
    s_waitcnt vmcnt(0)
    v_cmp_gt_u32 vcc, s61, v2
    s_cbranch_vccz L_lf9
    s_cmp_lt_u32 s60, 0x10000
    s_cbranch_scc1 L_lp9
L_lf9:
    s_mov_b32 s1, 1
L_ld9:
    s_mov_b64 exec, -1
    s_branch L_back9
L_late11:
    s_mov_b32 s60, 0
L_lp11:
    s_mov_b32 exec_lo, 0xffff
    s_mov_b32 exec_hi, 0
    buffer_load_ubyte v2, v0, s[4:7], s24 offen sc1
    s_add_u32 s60, s60, 1
    s_waitcnt vmcnt(0)
    v_cmp_eq_u32 vcc, 0, v2
    s_cbranch_vccz L_ld11
    s_cmp_lt_u32 s60, s1
    s_cbranch_scc1 L_lp11
    s_cmp_gt_u32 s60, s1
    s_cbranch_scc1 L_lq11
    s_lshl_b32 s34, s21, 5
    s_add_u32 s34, s34, s22
    s_mul_i32 s34, s34, 128
    s_add_u32 s34, s34, 60817408
    v_mov_b32 v2, s61
    s_mov_b64 exec, 1
    buffer_store_dword v2, off, s[4:7], s34 sc1
    s_mov_b32 exec_lo, 0xffff
L_lq11:
    buffer_load_dword v2, v240, s[4:7], s35 offen sc1
    s_waitcnt vmcnt(0)
    v_cmp_gt_u32 vcc, s61, v2
    s_cbranch_vccz L_lf11
    s_cmp_lt_u32 s60, 0x10000
    s_cbranch_scc1 L_lp11
L_lf11:
    s_mov_b32 s1, 1
L_ld11:
    s_mov_b64 exec, -1
    s_branch L_back11
L_code_end:
L_slow:
    v_mov_b32 v2, 0xff7fffff
    s_mov_b32 s46, 0
L_slow_a0:
    s_add_u32 s47, s46, s36
    buffer_load_dwordx4 a[32:35], v1, s[4:7], s47 offen sc1
    s_waitcnt vmcnt(0)
    v_mfma_f32_32x32x16_bf16 v[32:47], a[32:35], a[24:27], 0
    s_nop 15
    v_max3_f32 v2, v2, v32, v33
    v_max3_f32 v2, v2, v34, v35
    v_max3_f32 v2, v2, v36, v37
    v_max3_f32 v2, v2, v38, v39
    v_max3_f32 v2, v2, v40, v41
    v_max3_f32 v2, v2, v42, v43
    v_max3_f32 v2, v2, v44, v45
    v_max3_f32 v2, v2, v46, v47
    s_add_u32 s46, s46, 2048
    s_cmp_lt_u32 s46, 131072
    s_cbranch_scc1 L_slow_a0
    v_mov_b32 v6, v2
    s_nop 1
    v_permlane32_swap_b32 v2, v6
    s_nop 1
    v_max_f32 v2, v2, v6
    v_sub_f32 v48, 0, v2
    v_mov_b32 v160, 0
    v_sub_f32 v49, 0, v2
    v_mov_b32 v161, 0
    v_sub_f32 v50, 0, v2
    v_mov_b32 v162, 0
    v_sub_f32 v51, 0, v2
    v_mov_b32 v163, 0
    v_sub_f32 v52, 0, v2
    v_mov_b32 v164, 0
    v_sub_f32 v53, 0, v2
    v_mov_b32 v165, 0
    v_sub_f32 v54, 0, v2
    v_mov_b32 v166, 0
    v_sub_f32 v55, 0, v2
    v_mov_b32 v167, 0
    v_sub_f32 v56, 0, v2
    v_mov_b32 v168, 0
    v_sub_f32 v57, 0, v2
    v_mov_b32 v169, 0
    v_sub_f32 v58, 0, v2
    v_mov_b32 v170, 0
    v_sub_f32 v59, 0, v2
    v_mov_b32 v171, 0
    v_sub_f32 v60, 0, v2
    v_mov_b32 v172, 0
    v_sub_f32 v61, 0, v2
    v_mov_b32 v173, 0
    v_sub_f32 v62, 0, v2
    v_mov_b32 v174, 0
    v_sub_f32 v63, 0, v2
    v_mov_b32 v175, 0
    s_mov_b32 s46, 0
L_slow_b0:
    s_add_u32 s47, s46, s36
    buffer_load_dwordx4 a[32:35], v1, s[4:7], s47 offen sc1
    s_mov_b64 exec, s[40:41]
    buffer_load_dwordx4 a[36:39], v7, s[4:7], s47 offen offset:1024 sc1
    buffer_load_dwordx4 a[40:43], v7, s[4:7], s47 offen offset:1536 sc1
    s_mov_b64 exec, -1
    s_waitcnt vmcnt(0)
    v_mfma_f32_32x32x16_bf16 v[32:47], a[32:35], a[24:27], v[48:63]
    s_nop 15
    v_exp_f32 v32, v32
    v_exp_f32 v33, v33
    v_exp_f32 v34, v34
    v_exp_f32 v35, v35
    v_exp_f32 v36, v36
    v_exp_f32 v37, v37
    v_exp_f32 v38, v38
    v_exp_f32 v39, v39
    v_exp_f32 v40, v40
    v_exp_f32 v41, v41
    v_exp_f32 v42, v42
    v_exp_f32 v43, v43
    v_exp_f32 v44, v44
    v_exp_f32 v45, v45
    v_exp_f32 v46, v46
    v_exp_f32 v47, v47
    s_nop 1
    v_smfmac_f32_32x32x32_bf16 v[160:175], a[36:39], v[32:39], v3
    v_smfmac_f32_32x32x32_bf16 v[160:175], a[40:43], v[40:47], v3
    s_nop 15
    s_add_u32 s46, s46, 2048
    s_cmp_lt_u32 s46, 131072
    s_cbranch_scc1 L_slow_b0
    v_rcp_f32 v169, v168
    s_nop 0
    v_pk_mul_f32 v[160:161], v[160:161], v[168:169] op_sel:[0,1] op_sel_hi:[1,1]
    v_pk_mul_f32 v[162:163], v[162:163], v[168:169] op_sel:[0,1] op_sel_hi:[1,1]
    v_pk_mul_f32 v[164:165], v[164:165], v[168:169] op_sel:[0,1] op_sel_hi:[1,1]
    v_pk_mul_f32 v[166:167], v[166:167], v[168:169] op_sel:[0,1] op_sel_hi:[1,1]
    v_cvt_pk_bf16_f32 v172, v160, v161
    v_cvt_pk_bf16_f32 v173, v162, v163
    v_cvt_pk_bf16_f32 v174, v164, v165
    v_cvt_pk_bf16_f32 v175, v166, v167
    buffer_store_dwordx4 v[172:175], v1, s[4:7], s28 offen sc1
    v_mov_b32 v2, 0xff7fffff
    s_mov_b32 s46, 0
L_slow_a1:
    s_add_u32 s47, s46, s36
    buffer_load_dwordx4 a[32:35], v1, s[4:7], s47 offen sc1
    s_waitcnt vmcnt(0)
    v_mfma_f32_32x32x16_bf16 v[32:47], a[32:35], a[28:31], 0
    s_nop 15
    v_max3_f32 v2, v2, v32, v33
    v_max3_f32 v2, v2, v34, v35
    v_max3_f32 v2, v2, v36, v37
    v_max3_f32 v2, v2, v38, v39
    v_max3_f32 v2, v2, v40, v41
    v_max3_f32 v2, v2, v42, v43
    v_max3_f32 v2, v2, v44, v45
    v_max3_f32 v2, v2, v46, v47
    s_add_u32 s46, s46, 2048
    s_cmp_lt_u32 s46, 131072
    s_cbranch_scc1 L_slow_a1
    v_mov_b32 v6, v2
    s_nop 1
    v_permlane32_swap_b32 v2, v6
    s_nop 1
    v_max_f32 v2, v2, v6
    v_sub_f32 v48, 0, v2
    v_mov_b32 v176, 0
    v_sub_f32 v49, 0, v2
    v_mov_b32 v177, 0
    v_sub_f32 v50, 0, v2
    v_mov_b32 v178, 0
    v_sub_f32 v51, 0, v2
    v_mov_b32 v179, 0
    v_sub_f32 v52, 0, v2
    v_mov_b32 v180, 0
    v_sub_f32 v53, 0, v2
    v_mov_b32 v181, 0
    v_sub_f32 v54, 0, v2
    v_mov_b32 v182, 0
    v_sub_f32 v55, 0, v2
    v_mov_b32 v183, 0
    v_sub_f32 v56, 0, v2
    v_mov_b32 v184, 0
    v_sub_f32 v57, 0, v2
    v_mov_b32 v185, 0
    v_sub_f32 v58, 0, v2
    v_mov_b32 v186, 0
    v_sub_f32 v59, 0, v2
    v_mov_b32 v187, 0
    v_sub_f32 v60, 0, v2
    v_mov_b32 v188, 0
    v_sub_f32 v61, 0, v2
    v_mov_b32 v189, 0
    v_sub_f32 v62, 0, v2
    v_mov_b32 v190, 0
    v_sub_f32 v63, 0, v2
    v_mov_b32 v191, 0
    s_mov_b32 s46, 0
L_slow_b1:
    s_add_u32 s47, s46, s36
    buffer_load_dwordx4 a[32:35], v1, s[4:7], s47 offen sc1
    s_mov_b64 exec, s[40:41]
    buffer_load_dwordx4 a[36:39], v7, s[4:7], s47 offen offset:1024 sc1
    buffer_load_dwordx4 a[40:43], v7, s[4:7], s47 offen offset:1536 sc1
    s_mov_b64 exec, -1
    s_waitcnt vmcnt(0)
    v_mfma_f32_32x32x16_bf16 v[32:47], a[32:35], a[28:31], v[48:63]
    s_nop 15
    v_exp_f32 v32, v32
    v_exp_f32 v33, v33
    v_exp_f32 v34, v34
    v_exp_f32 v35, v35
    v_exp_f32 v36, v36
    v_exp_f32 v37, v37
    v_exp_f32 v38, v38
    v_exp_f32 v39, v39
    v_exp_f32 v40, v40
    v_exp_f32 v41, v41
    v_exp_f32 v42, v42
    v_exp_f32 v43, v43
    v_exp_f32 v44, v44
    v_exp_f32 v45, v45
    v_exp_f32 v46, v46
    v_exp_f32 v47, v47
    s_nop 1
    v_smfmac_f32_32x32x32_bf16 v[176:191], a[36:39], v[32:39], v3
    v_smfmac_f32_32x32x32_bf16 v[176:191], a[40:43], v[40:47], v3
    s_nop 15
    s_add_u32 s46, s46, 2048
    s_cmp_lt_u32 s46, 131072
    s_cbranch_scc1 L_slow_b1
    v_rcp_f32 v185, v184
    s_nop 0
    v_pk_mul_f32 v[176:177], v[176:177], v[184:185] op_sel:[0,1] op_sel_hi:[1,1]
    v_pk_mul_f32 v[178:179], v[178:179], v[184:185] op_sel:[0,1] op_sel_hi:[1,1]
    v_pk_mul_f32 v[180:181], v[180:181], v[184:185] op_sel:[0,1] op_sel_hi:[1,1]
    v_pk_mul_f32 v[182:183], v[182:183], v[184:185] op_sel:[0,1] op_sel_hi:[1,1]
    v_cvt_pk_bf16_f32 v188, v176, v177
    v_cvt_pk_bf16_f32 v189, v178, v179
    v_cvt_pk_bf16_f32 v190, v180, v181
    v_cvt_pk_bf16_f32 v191, v182, v183
    buffer_store_dwordx4 v[188:191], v1, s[4:7], s29 offen sc1
    s_waitcnt vmcnt(0)
    s_branch L_fin
interleave_layers__softmax_full_mha__glu_gated_swiglu__prompt_kernel_end:
    s_endpgm
.section .rodata,"a"
.p2align 6
.amdhsa_kernel interleave_layers__softmax_full_mha__glu_gated_swiglu__prompt_kernel
  .amdhsa_next_free_vgpr 512
  .amdhsa_next_free_sgpr 102
  .amdhsa_accum_offset 256
  .amdhsa_group_segment_fixed_size 0
  .amdhsa_kernarg_size 80
  .amdhsa_user_sgpr_count 2
  .amdhsa_user_sgpr_kernarg_segment_ptr 1
  .amdhsa_system_sgpr_workgroup_id_x 1
.end_amdhsa_kernel
.text
```
